```python
import torch

def _softmax(x, axis=-1):
    return torch.softmax(x, dim=axis)
def _gelu(x):
    return torch.nn.functional.gelu(x, approximate="tanh")
def _silu(x):
    return torch.nn.functional.silu(x)
def _sigmoid(x):
    return torch.sigmoid(x)
def _layernorm(x, axis=-1, eps=1e-5):
    m = x.mean(dim=axis, keepdim=True)
    v = x.var(dim=axis, keepdim=True, unbiased=False)
    return (x - m) / torch.sqrt(v + eps)
def _scatter_add(tgt, idx, src, axis=0):
    return tgt.clone().index_add_(axis, idx, src)
def _segment_sum(src, seg, n):
    out = torch.zeros((n,) + src.shape[1:], dtype=src.dtype)
    return out.index_add_(0, seg, src)
def _pad(x, pw):
    flat = tuple(v for pair in reversed(pw) for v in pair)
    return torch.nn.functional.pad(x, flat)

kernel_name = 'standalone__gqa_softmax__near_ridge'

def setup_inputs():

    _w = (lambda a: (lambda t: t.to(torch.bfloat16) if t.is_floating_point() else t)(torch.as_tensor(a)))
    B, Hq, Hkv, Sq, Sk, D = 16, 32, 32, 624, 624, 128
    return {
        "q": _w((lambda *s: torch.randn(*s, dtype=torch.bfloat16) * 0.8)(B, Hq, Sq, D)),
        "k": _w((lambda *s: torch.randn(*s, dtype=torch.bfloat16) * 0.8)(B, Hkv, Sk, D)),
        "v": _w((lambda *s: torch.randn(*s, dtype=torch.bfloat16) * 0.05)(B, Hkv, Sk, D)),
    }

def reference(q, k, v):
    B, Hq, Sq, D = q.shape
    Hkv = k.shape[1]
    rep = Hq // Hkv
    k = (lambda x, n, axis: torch.repeat_interleave(x, n, dim=axis))(k, rep, axis=1)
    v = (lambda x, n, axis: torch.repeat_interleave(x, n, dim=axis))(v, rep, axis=1)
    scale = D ** -0.5
    scores = torch.einsum("bhqd,bhkd->bhqk", q, k) * scale
    p = _softmax(scores, axis=-1)
    return torch.einsum("bhqk,bhkd->bhqd", p, v)
```

```asm
; @launch grid=(256,1,1) block=(256,1,1) lds=163840
.amdgcn_target "amdgcn-amd-amdhsa--gfx950"
.text
.globl standalone__gqa_softmax__near_ridge_kernel
.p2align 8
.type standalone__gqa_softmax__near_ridge_kernel,@function
standalone__gqa_softmax__near_ridge_kernel:
s_cmp_ge_u32 s2, 256
s_cbranch_scc1 END
s_load_dwordx8 s[40:47], s[0:1], 0
s_getpc_b64 s[82:83]
PCREF:
s_bfe_u32 s84, s2, 0x40003
s_lshl_b32 s84, s84, 12
v_lshl_add_u32 v28, v0, 4, s84
s_mov_b32 s85, CODE_END-PCREF-16
v_min_u32 v28, s85, v28
v_mov_b32 v31, s83
v_add_co_u32 v30, vcc, s82, v28
s_nop 1
v_addc_co_u32 v31, vcc, 0, v31, vcc
v_and_b32 v30, -16, v30
global_load_dwordx4 a[240:243], v[30:31], off
v_lshrrev_b32 v1, 6, v0
v_and_b32 v0, 63, v0
v_readfirstlane_b32 s48, v1
v_lshrrev_b32 v1, 4, v0
v_and_b32 v2, 15, v0
s_and_b32 s49, s2, 7
s_lshr_b32 s50, s2, 4
s_lshl4_add_u32 s49, s49, s50
s_mul_i32 s20, s49, 159744
s_bfe_u32 s50, s2, 0x10003
s_lshl2_add_u32 s50, s50, s48
s_mul_i32 s51, s50, 20480
s_add_u32 s22, s20, s51
v_xor_b32 v29, v2, v1
v_lshlrev_b32 v29, 4, v29
v_lshl_add_u32 v18, v1, 8, v29
v_xor_b32 v19, 64, v18
v_xor_b32 v20, 0x80, v18
v_xor_b32 v21, 0xc0, v18
s_waitcnt lgkmcnt(0)
s_mov_b32 s4, s40
s_mov_b32 s5, s41
s_mov_b32 s6, 81788928
s_mov_b32 s7, 0x20000
s_add_u32 s36, s22, 0
buffer_load_dwordx4 v[176:179], v18, s[4:7], s36 offen offset:0 nt
buffer_load_dwordx4 v[180:183], v19, s[4:7], s36 offen offset:1024 nt
buffer_load_dwordx4 v[184:187], v20, s[4:7], s36 offen offset:2048 nt
buffer_load_dwordx4 v[188:191], v21, s[4:7], s36 offen offset:3072 nt
s_add_u32 s36, s22, 4096
buffer_load_dwordx4 v[192:195], v18, s[4:7], s36 offen offset:0 nt
buffer_load_dwordx4 v[196:199], v19, s[4:7], s36 offen offset:1024 nt
buffer_load_dwordx4 v[200:203], v20, s[4:7], s36 offen offset:2048 nt
buffer_load_dwordx4 v[204:207], v21, s[4:7], s36 offen offset:3072 nt
s_lshl_b32 s21, s48, 10
s_lshl_b32 s51, s48, 2
v_add_u32 v3, s51, v1
v_xor_b32 v28, v2, v3
v_lshlrev_b32 v28, 4, v28
v_lshl_add_u32 v16, v3, 8, v28
v_and_b32 v28, 7, v3
v_lshlrev_b32 v28, 1, v28
v_xor_b32 v28, v2, v28
v_lshlrev_b32 v28, 4, v28
v_lshl_add_u32 v17, v3, 8, v28
s_mov_b32 s53, s20
s_cmp_eq_u32 s50, 7
s_cselect_b32 s24, 0x80000000, 0
s_cselect_b32 s25, 0xf149f2ca, 0
s_add_u32 s37, s22, s24
s_mov_b32 s8, s42
s_mov_b32 s9, s43
s_mov_b32 s10, s6
s_mov_b32 s11, 0x20000
s_mov_b32 s12, s44
s_mov_b32 s13, s45
s_mov_b32 s14, s6
s_mov_b32 s15, 0x20000
s_add_u32 m0, s21, 0
s_nop 0
buffer_load_dwordx4 v16, s[8:11], s20 offen nt lds
s_add_u32 m0, s21, 40960
s_nop 0
buffer_load_dwordx4 v17, s[12:15], s20 offen nt lds
s_add_u32 s20, s20, 4096
s_add_u32 m0, s21, 4096
s_nop 0
buffer_load_dwordx4 v16, s[8:11], s20 offen nt lds
s_add_u32 m0, s21, 45056
s_nop 0
buffer_load_dwordx4 v17, s[12:15], s20 offen nt lds
s_add_u32 s20, s20, 4096
s_add_u32 m0, s21, 8192
s_nop 0
buffer_load_dwordx4 v16, s[8:11], s20 offen nt lds
s_add_u32 m0, s21, 49152
s_nop 0
buffer_load_dwordx4 v17, s[12:15], s20 offen nt lds
s_add_u32 s20, s20, 4096
s_add_u32 s36, s22, 8192
buffer_load_dwordx4 v[208:211], v18, s[4:7], s36 offen offset:0 nt
buffer_load_dwordx4 v[212:215], v19, s[4:7], s36 offen offset:1024 nt
buffer_load_dwordx4 v[216:219], v20, s[4:7], s36 offen offset:2048 nt
buffer_load_dwordx4 v[220:223], v21, s[4:7], s36 offen offset:3072 nt
s_add_u32 s36, s22, 12288
buffer_load_dwordx4 v[224:227], v18, s[4:7], s36 offen offset:0 nt
buffer_load_dwordx4 v[228:231], v19, s[4:7], s36 offen offset:1024 nt
buffer_load_dwordx4 v[232:235], v20, s[4:7], s36 offen offset:2048 nt
buffer_load_dwordx4 v[236:239], v21, s[4:7], s36 offen offset:3072 nt
s_add_u32 s36, s37, 16384
buffer_load_dwordx4 v[240:243], v18, s[4:7], s36 offen offset:0 nt
buffer_load_dwordx4 v[244:247], v19, s[4:7], s36 offen offset:1024 nt
buffer_load_dwordx4 v[248:251], v20, s[4:7], s36 offen offset:2048 nt
buffer_load_dwordx4 v[252:255], v21, s[4:7], s36 offen offset:3072 nt
s_mov_b32 s16, s46
s_mov_b32 s17, s47
s_mov_b32 s18, s6
s_mov_b32 s19, 0x20000
s_mov_b32 s33, s22
s_mov_b32 s23, 0x80000000
s_mov_b32 s39, s22
s_mov_b32 s38, s23
s_mov_b32 s26, 1040356334
s_mov_b32 s30, 0xffff0000
s_mov_b32 s31, 1266679808
s_mov_b32 s27, 0
s_mov_b32 s28, 0
s_mov_b64 s[34:35], 0
s_mul_i32 s52, s48, 20480
s_add_u32 s52, s52, 81920
v_lshl_add_u32 v22, v0, 4, s52
v_lshl_add_u32 v4, v2, 8, v29
v_xor_b32 v5, 64, v4
v_xor_b32 v6, 0x80, v4
v_xor_b32 v7, 0xc0, v4
v_lshrrev_b32 v3, 2, v0
v_and_b32 v28, 7, v3
v_lshlrev_b32 v28, 5, v28
v_and_b32 v30, 3, v0
v_cmp_gt_u32 vcc, 2, v30
v_cmp_eq_u32 s[84:85], 1, v30
v_lshl_add_u32 v28, v30, 3, v28
v_lshl_add_u32 v28, v3, 8, v28
v_add_u32 v8, 40960, v28
v_and_b32 v28, 1, v1
v_lshl_add_u32 v28, v28, 3, s52
v_lshrrev_b32 v30, 1, v1
v_xor_b32 v30, v30, v2
v_lshl_add_u32 v28, v30, 4, v28
v_lshl_add_u32 v27, v2, 8, v28
v_mov_b32 v30, 0x3f803f80
v_cndmask_b32 v30, 0, v30, vcc
v_mov_b32 v0, 0x44444444
v_mov_b32 v31, 0xeeeeeeee
v_cndmask_b32 v0, v0, v31, s[84:85]
v_accvgpr_write_b32 a208, 0
v_accvgpr_write_b32 a209, 0
v_accvgpr_write_b32 a210, 0
v_accvgpr_write_b32 a211, 0
v_accvgpr_write_b32 a212, 0
v_accvgpr_write_b32 a213, 0
v_accvgpr_write_b32 a214, 0
v_accvgpr_write_b32 a215, 0
v_accvgpr_write_b32 a216, 0
v_accvgpr_write_b32 a217, 0
v_accvgpr_write_b32 a218, 0
v_accvgpr_write_b32 a219, 0
v_accvgpr_write_b32 a220, 0
v_accvgpr_write_b32 a221, 0
v_accvgpr_write_b32 a222, 0
v_accvgpr_write_b32 a223, 0
v_accvgpr_write_b32 a224, 0
v_accvgpr_write_b32 a225, 0
v_accvgpr_write_b32 a226, 0
v_accvgpr_write_b32 a227, 0
v_add_u32 v23, s52, v4
v_add_u32 v24, s52, v5
v_add_u32 v25, s52, v6
v_add_u32 v26, s52, v7
v_xor_b32 v9, 32, v8
v_xor_b32 v10, 64, v8
v_xor_b32 v11, 96, v8
v_xor_b32 v12, 128, v8
v_xor_b32 v13, 160, v8
v_xor_b32 v14, 192, v8
v_xor_b32 v15, 224, v8
v_accvgpr_write_b32 a228, v30
v_accvgpr_write_b32 a229, v30
v_accvgpr_write_b32 a230, v30
v_accvgpr_write_b32 a231, v30
s_waitcnt vmcnt(25)
s_add_u32 s22, s22, 20447232
s_add_u32 s37, s22, s24
v_lshlrev_b32 v28, 16, v176
v_and_b32 v29, s30, v176
v_lshlrev_b32 v30, 16, v177
v_and_b32 v31, s30, v177
v_mul_f32 v28, s26, v28
v_mul_f32 v29, s26, v29
v_mul_f32 v30, s26, v30
v_mul_f32 v31, s26, v31
v_cvt_pk_bf16_f32 v176, v28, v29
v_cvt_pk_bf16_f32 v177, v30, v31
v_lshlrev_b32 v28, 16, v178
v_and_b32 v29, s30, v178
v_lshlrev_b32 v30, 16, v179
v_and_b32 v31, s30, v179
v_mul_f32 v28, s26, v28
v_mul_f32 v29, s26, v29
v_mul_f32 v30, s26, v30
v_mul_f32 v31, s26, v31
v_cvt_pk_bf16_f32 v178, v28, v29
v_cvt_pk_bf16_f32 v179, v30, v31
ds_write_b128 v22, v[176:179] offset:0
s_waitcnt vmcnt(24)
v_lshlrev_b32 v28, 16, v180
v_and_b32 v29, s30, v180
v_lshlrev_b32 v30, 16, v181
v_and_b32 v31, s30, v181
v_mul_f32 v28, s26, v28
v_mul_f32 v29, s26, v29
v_mul_f32 v30, s26, v30
v_mul_f32 v31, s26, v31
v_cvt_pk_bf16_f32 v180, v28, v29
v_cvt_pk_bf16_f32 v181, v30, v31
v_lshlrev_b32 v28, 16, v182
v_and_b32 v29, s30, v182
v_lshlrev_b32 v30, 16, v183
v_and_b32 v31, s30, v183
v_mul_f32 v28, s26, v28
v_mul_f32 v29, s26, v29
v_mul_f32 v30, s26, v30
v_mul_f32 v31, s26, v31
v_cvt_pk_bf16_f32 v182, v28, v29
v_cvt_pk_bf16_f32 v183, v30, v31
ds_write_b128 v22, v[180:183] offset:1024
s_waitcnt vmcnt(23)
v_lshlrev_b32 v28, 16, v184
v_and_b32 v29, s30, v184
v_lshlrev_b32 v30, 16, v185
v_and_b32 v31, s30, v185
v_mul_f32 v28, s26, v28
v_mul_f32 v29, s26, v29
v_mul_f32 v30, s26, v30
v_mul_f32 v31, s26, v31
v_cvt_pk_bf16_f32 v184, v28, v29
v_cvt_pk_bf16_f32 v185, v30, v31
v_lshlrev_b32 v28, 16, v186
v_and_b32 v29, s30, v186
v_lshlrev_b32 v30, 16, v187
v_and_b32 v31, s30, v187
v_mul_f32 v28, s26, v28
v_mul_f32 v29, s26, v29
v_mul_f32 v30, s26, v30
v_mul_f32 v31, s26, v31
v_cvt_pk_bf16_f32 v186, v28, v29
v_cvt_pk_bf16_f32 v187, v30, v31
ds_write_b128 v22, v[184:187] offset:2048
s_waitcnt vmcnt(22)
v_lshlrev_b32 v28, 16, v188
v_and_b32 v29, s30, v188
v_lshlrev_b32 v30, 16, v189
v_and_b32 v31, s30, v189
v_mul_f32 v28, s26, v28
v_mul_f32 v29, s26, v29
v_mul_f32 v30, s26, v30
v_mul_f32 v31, s26, v31
v_cvt_pk_bf16_f32 v188, v28, v29
v_cvt_pk_bf16_f32 v189, v30, v31
v_lshlrev_b32 v28, 16, v190
v_and_b32 v29, s30, v190
v_lshlrev_b32 v30, 16, v191
v_and_b32 v31, s30, v191
v_mul_f32 v28, s26, v28
v_mul_f32 v29, s26, v29
v_mul_f32 v30, s26, v30
v_mul_f32 v31, s26, v31
v_cvt_pk_bf16_f32 v190, v28, v29
v_cvt_pk_bf16_f32 v191, v30, v31
ds_write_b128 v22, v[188:191] offset:3072
ds_read_b128 a[0:3], v23 offset:0
ds_read_b128 a[4:7], v24 offset:0
ds_read_b128 a[8:11], v25 offset:0
ds_read_b128 a[12:15], v26 offset:0
s_waitcnt vmcnt(21)
v_lshlrev_b32 v28, 16, v192
v_and_b32 v29, s30, v192
v_lshlrev_b32 v30, 16, v193
v_and_b32 v31, s30, v193
v_mul_f32 v28, s26, v28
v_mul_f32 v29, s26, v29
v_mul_f32 v30, s26, v30
v_mul_f32 v31, s26, v31
v_cvt_pk_bf16_f32 v192, v28, v29
v_cvt_pk_bf16_f32 v193, v30, v31
v_lshlrev_b32 v28, 16, v194
v_and_b32 v29, s30, v194
v_lshlrev_b32 v30, 16, v195
v_and_b32 v31, s30, v195
v_mul_f32 v28, s26, v28
v_mul_f32 v29, s26, v29
v_mul_f32 v30, s26, v30
v_mul_f32 v31, s26, v31
v_cvt_pk_bf16_f32 v194, v28, v29
v_cvt_pk_bf16_f32 v195, v30, v31
ds_write_b128 v22, v[192:195] offset:4096
s_waitcnt vmcnt(20)
v_lshlrev_b32 v28, 16, v196
v_and_b32 v29, s30, v196
v_lshlrev_b32 v30, 16, v197
v_and_b32 v31, s30, v197
v_mul_f32 v28, s26, v28
v_mul_f32 v29, s26, v29
v_mul_f32 v30, s26, v30
v_mul_f32 v31, s26, v31
v_cvt_pk_bf16_f32 v196, v28, v29
v_cvt_pk_bf16_f32 v197, v30, v31
v_lshlrev_b32 v28, 16, v198
v_and_b32 v29, s30, v198
v_lshlrev_b32 v30, 16, v199
v_and_b32 v31, s30, v199
v_mul_f32 v28, s26, v28
v_mul_f32 v29, s26, v29
v_mul_f32 v30, s26, v30
v_mul_f32 v31, s26, v31
v_cvt_pk_bf16_f32 v198, v28, v29
v_cvt_pk_bf16_f32 v199, v30, v31
ds_write_b128 v22, v[196:199] offset:5120
s_waitcnt vmcnt(19)
v_lshlrev_b32 v28, 16, v200
v_and_b32 v29, s30, v200
v_lshlrev_b32 v30, 16, v201
v_and_b32 v31, s30, v201
v_mul_f32 v28, s26, v28
v_mul_f32 v29, s26, v29
v_mul_f32 v30, s26, v30
v_mul_f32 v31, s26, v31
v_cvt_pk_bf16_f32 v200, v28, v29
v_cvt_pk_bf16_f32 v201, v30, v31
v_lshlrev_b32 v28, 16, v202
v_and_b32 v29, s30, v202
v_lshlrev_b32 v30, 16, v203
v_and_b32 v31, s30, v203
v_mul_f32 v28, s26, v28
v_mul_f32 v29, s26, v29
v_mul_f32 v30, s26, v30
v_mul_f32 v31, s26, v31
v_cvt_pk_bf16_f32 v202, v28, v29
v_cvt_pk_bf16_f32 v203, v30, v31
ds_write_b128 v22, v[200:203] offset:6144
s_waitcnt vmcnt(18)
v_lshlrev_b32 v28, 16, v204
v_and_b32 v29, s30, v204
v_lshlrev_b32 v30, 16, v205
v_and_b32 v31, s30, v205
v_mul_f32 v28, s26, v28
v_mul_f32 v29, s26, v29
v_mul_f32 v30, s26, v30
v_mul_f32 v31, s26, v31
v_cvt_pk_bf16_f32 v204, v28, v29
v_cvt_pk_bf16_f32 v205, v30, v31
v_lshlrev_b32 v28, 16, v206
v_and_b32 v29, s30, v206
v_lshlrev_b32 v30, 16, v207
v_and_b32 v31, s30, v207
v_mul_f32 v28, s26, v28
v_mul_f32 v29, s26, v29
v_mul_f32 v30, s26, v30
v_mul_f32 v31, s26, v31
v_cvt_pk_bf16_f32 v206, v28, v29
v_cvt_pk_bf16_f32 v207, v30, v31
ds_write_b128 v22, v[204:207] offset:7168
ds_read_b128 a[16:19], v23 offset:4096
ds_read_b128 a[20:23], v24 offset:4096
ds_read_b128 a[24:27], v25 offset:4096
ds_read_b128 a[28:31], v26 offset:4096
s_waitcnt vmcnt(11)
v_lshlrev_b32 v28, 16, v208
v_and_b32 v29, s30, v208
v_lshlrev_b32 v30, 16, v209
v_and_b32 v31, s30, v209
v_mul_f32 v28, s26, v28
v_mul_f32 v29, s26, v29
v_mul_f32 v30, s26, v30
v_mul_f32 v31, s26, v31
v_cvt_pk_bf16_f32 v208, v28, v29
v_cvt_pk_bf16_f32 v209, v30, v31
v_lshlrev_b32 v28, 16, v210
v_and_b32 v29, s30, v210
v_lshlrev_b32 v30, 16, v211
v_and_b32 v31, s30, v211
v_mul_f32 v28, s26, v28
v_mul_f32 v29, s26, v29
v_mul_f32 v30, s26, v30
v_mul_f32 v31, s26, v31
v_cvt_pk_bf16_f32 v210, v28, v29
v_cvt_pk_bf16_f32 v211, v30, v31
ds_write_b128 v22, v[208:211] offset:8192
s_waitcnt vmcnt(10)
v_lshlrev_b32 v28, 16, v212
v_and_b32 v29, s30, v212
v_lshlrev_b32 v30, 16, v213
v_and_b32 v31, s30, v213
v_mul_f32 v28, s26, v28
v_mul_f32 v29, s26, v29
v_mul_f32 v30, s26, v30
v_mul_f32 v31, s26, v31
v_cvt_pk_bf16_f32 v212, v28, v29
v_cvt_pk_bf16_f32 v213, v30, v31
v_lshlrev_b32 v28, 16, v214
v_and_b32 v29, s30, v214
v_lshlrev_b32 v30, 16, v215
v_and_b32 v31, s30, v215
v_mul_f32 v28, s26, v28
v_mul_f32 v29, s26, v29
v_mul_f32 v30, s26, v30
v_mul_f32 v31, s26, v31
v_cvt_pk_bf16_f32 v214, v28, v29
v_cvt_pk_bf16_f32 v215, v30, v31
ds_write_b128 v22, v[212:215] offset:9216
s_waitcnt vmcnt(9)
v_lshlrev_b32 v28, 16, v216
v_and_b32 v29, s30, v216
v_lshlrev_b32 v30, 16, v217
v_and_b32 v31, s30, v217
v_mul_f32 v28, s26, v28
v_mul_f32 v29, s26, v29
v_mul_f32 v30, s26, v30
v_mul_f32 v31, s26, v31
v_cvt_pk_bf16_f32 v216, v28, v29
v_cvt_pk_bf16_f32 v217, v30, v31
v_lshlrev_b32 v28, 16, v218
v_and_b32 v29, s30, v218
v_lshlrev_b32 v30, 16, v219
v_and_b32 v31, s30, v219
v_mul_f32 v28, s26, v28
v_mul_f32 v29, s26, v29
v_mul_f32 v30, s26, v30
v_mul_f32 v31, s26, v31
v_cvt_pk_bf16_f32 v218, v28, v29
v_cvt_pk_bf16_f32 v219, v30, v31
ds_write_b128 v22, v[216:219] offset:10240
s_waitcnt vmcnt(8)
v_lshlrev_b32 v28, 16, v220
v_and_b32 v29, s30, v220
v_lshlrev_b32 v30, 16, v221
v_and_b32 v31, s30, v221
v_mul_f32 v28, s26, v28
v_mul_f32 v29, s26, v29
v_mul_f32 v30, s26, v30
v_mul_f32 v31, s26, v31
v_cvt_pk_bf16_f32 v220, v28, v29
v_cvt_pk_bf16_f32 v221, v30, v31
v_lshlrev_b32 v28, 16, v222
v_and_b32 v29, s30, v222
v_lshlrev_b32 v30, 16, v223
v_and_b32 v31, s30, v223
v_mul_f32 v28, s26, v28
v_mul_f32 v29, s26, v29
v_mul_f32 v30, s26, v30
v_mul_f32 v31, s26, v31
v_cvt_pk_bf16_f32 v222, v28, v29
v_cvt_pk_bf16_f32 v223, v30, v31
ds_write_b128 v22, v[220:223] offset:11264
s_barrier
ds_read_b128 a[80:83], v4 offset:0
ds_read_b128 a[84:87], v5 offset:0
ds_read_b128 a[88:91], v6 offset:0
ds_read_b128 a[92:95], v7 offset:0
ds_read_b128 a[108:111], v7 offset:4096
ds_read_b128 a[104:107], v6 offset:4096
ds_read_b128 a[100:103], v5 offset:4096
ds_read_b128 a[96:99], v4 offset:4096
ds_read_b128 a[112:115], v4 offset:8192
ds_read_b128 a[116:119], v5 offset:8192
ds_read_b128 a[120:123], v6 offset:8192
ds_read_b128 a[124:127], v7 offset:8192
ds_read_b64_tr_b16 a[144:145], v8 offset:0
ds_read_b64_tr_b16 a[146:147], v8 offset:4096
ds_read_b64_tr_b16 a[148:149], v8 offset:8192
ds_read_b64_tr_b16 a[150:151], v8 offset:8192
ds_read_b64_tr_b16 a[152:153], v9 offset:0
ds_read_b64_tr_b16 a[154:155], v9 offset:4096
ds_read_b64_tr_b16 a[156:157], v9 offset:8192
ds_read_b64_tr_b16 a[158:159], v9 offset:8192
ds_read_b64_tr_b16 a[160:161], v10 offset:0
ds_read_b64_tr_b16 a[162:163], v10 offset:4096
ds_read_b64_tr_b16 a[164:165], v10 offset:8192
ds_read_b64_tr_b16 a[166:167], v10 offset:8192
ds_read_b64_tr_b16 a[168:169], v11 offset:0
ds_read_b64_tr_b16 a[170:171], v11 offset:4096
ds_read_b64_tr_b16 a[172:173], v11 offset:8192
ds_read_b64_tr_b16 a[174:175], v11 offset:8192
ds_read_b64_tr_b16 a[176:177], v12 offset:0
ds_read_b64_tr_b16 a[178:179], v12 offset:4096
ds_read_b64_tr_b16 a[180:181], v12 offset:8192
ds_read_b64_tr_b16 a[182:183], v12 offset:8192
ds_read_b64_tr_b16 a[184:185], v13 offset:0
ds_read_b64_tr_b16 a[186:187], v13 offset:4096
ds_read_b64_tr_b16 a[188:189], v13 offset:8192
ds_read_b64_tr_b16 a[190:191], v13 offset:8192
ds_read_b64_tr_b16 a[192:193], v14 offset:0
ds_read_b64_tr_b16 a[194:195], v14 offset:4096
ds_read_b64_tr_b16 a[196:197], v14 offset:8192
ds_read_b64_tr_b16 a[198:199], v14 offset:8192
ds_read_b64_tr_b16 a[200:201], v15 offset:0
ds_read_b64_tr_b16 a[202:203], v15 offset:4096
ds_read_b64_tr_b16 a[204:205], v15 offset:8192
ds_read_b64_tr_b16 a[206:207], v15 offset:8192
s_add_u32 m0, s21, 16384
s_nop 0
buffer_load_dwordx4 v16, s[8:11], s20 offen nt lds
s_add_u32 m0, s21, 57344
s_nop 0
buffer_load_dwordx4 v17, s[12:15], s20 offen nt lds
s_add_u32 s20, s20, 4096
s_add_u32 m0, s21, 20480
s_nop 0
buffer_load_dwordx4 v16, s[8:11], s20 offen nt lds
s_add_u32 m0, s21, 61440
s_nop 0
buffer_load_dwordx4 v17, s[12:15], s20 offen nt lds
s_add_u32 s20, s20, 4096
s_add_u32 m0, s21, 24576
s_nop 0
buffer_load_dwordx4 v16, s[8:11], s20 offen nt lds
s_add_u32 m0, s21, 65536
s_nop 0
buffer_load_dwordx4 v17, s[12:15], s20 offen nt lds
s_add_u32 s20, s20, 4096
s_add_u32 m0, s21, 28672
s_nop 0
buffer_load_dwordx4 v16, s[8:11], s20 offen nt lds
ds_read_b128 a[32:35], v23 offset:8192
ds_read_b128 a[36:39], v24 offset:8192
ds_read_b128 a[40:43], v25 offset:8192
ds_read_b128 a[44:47], v26 offset:8192
s_waitcnt lgkmcnt(0)
v_mfma_f32_16x16x32_bf16 v[80:83], a[80:83], a[0:3], 0
v_mfma_f32_16x16x32_bf16 v[80:83], a[84:87], a[4:7], v[80:83]
v_mfma_f32_16x16x32_bf16 v[80:83], a[88:91], a[8:11], v[80:83]
v_mfma_f32_16x16x32_bf16 v[80:83], a[92:95], a[12:15], v[80:83]
v_mfma_f32_16x16x32_bf16 v[84:87], a[108:111], a[12:15], 0
v_mfma_f32_16x16x32_bf16 v[84:87], a[104:107], a[8:11], v[84:87]
s_add_u32 s36, s22, 0
v_mfma_f32_16x16x32_bf16 v[84:87], a[100:103], a[4:7], v[84:87]
buffer_load_dwordx4 v[32:35], v18, s[4:7], s36 offen nt
v_mfma_f32_16x16x32_bf16 v[84:87], a[96:99], a[0:3], v[84:87]
s_nop 1
v_max3_f32 v1, v80, v81, v82
v_max_f32 v1, v1, v83
v_mov_b32 v2, v1
v_mfma_f32_16x16x32_bf16 v[88:91], a[112:115], a[0:3], 0
s_nop 0
v_permlane16_swap_b32 v1, v2
v_max_f32 v1, v1, v2
v_mfma_f32_16x16x32_bf16 v[88:91], a[116:119], a[4:7], v[88:91]
v_mov_b32 v2, v1
s_nop 1
v_permlane32_swap_b32 v1, v2
v_mfma_f32_16x16x32_bf16 v[88:91], a[120:123], a[8:11], v[88:91]
v_max_f32 v1, v1, v2
v_sub_f32 v52, 0, v1
v_mfma_f32_16x16x32_bf16 v[88:91], a[124:127], a[12:15], v[88:91]
v_add_f32 v80, v80, v52
v_add_f32 v81, v81, v52
v_add_f32 v82, v82, v52
v_add_f32 v83, v83, v52
v_mov_b32 v53, v52
v_exp_f32 v80, v80
v_exp_f32 v81, v81
s_add_u32 m0, s21, 69632
s_nop 0
buffer_load_dwordx4 v17, s[12:15], s20 offen nt lds
s_add_u32 s20, s20, 4096
v_exp_f32 v82, v82
v_exp_f32 v83, v83
v_add_f32 v84, v84, v52
v_add_f32 v85, v85, v52
v_add_f32 v86, v86, v52
v_add_f32 v87, v87, v52
v_mov_b32 v54, v52
v_exp_f32 v84, v84
v_exp_f32 v85, v85
v_exp_f32 v86, v86
v_exp_f32 v87, v87
v_add_f32 v88, v88, v52
v_add_f32 v89, v89, v52
v_add_f32 v90, v90, v52
v_add_f32 v91, v91, v52
v_mov_b32 v55, v52
v_exp_f32 v88, v88
v_exp_f32 v89, v89
v_exp_f32 v90, v90
v_exp_f32 v91, v91
s_waitcnt vmcnt(16)
v_lshlrev_b32 v28, 16, v224
v_and_b32 v29, s30, v224
v_lshlrev_b32 v30, 16, v225
v_and_b32 v31, s30, v225
v_mul_f32 v28, s26, v28
v_mul_f32 v29, s26, v29
v_mul_f32 v30, s26, v30
v_mul_f32 v31, s26, v31
v_cvt_pk_bf16_f32 v224, v28, v29
v_cvt_pk_bf16_f32 v225, v30, v31
v_lshlrev_b32 v28, 16, v226
v_and_b32 v29, s30, v226
v_lshlrev_b32 v30, 16, v227
v_and_b32 v31, s30, v227
v_mul_f32 v28, s26, v28
v_mul_f32 v29, s26, v29
v_mul_f32 v30, s26, v30
v_mul_f32 v31, s26, v31
v_cvt_pk_bf16_f32 v226, v28, v29
v_cvt_pk_bf16_f32 v227, v30, v31
ds_write_b128 v22, v[224:227] offset:12288
s_waitcnt vmcnt(15)
v_lshlrev_b32 v28, 16, v228
v_and_b32 v29, s30, v228
v_lshlrev_b32 v30, 16, v229
v_and_b32 v31, s30, v229
v_mul_f32 v28, s26, v28
v_mul_f32 v29, s26, v29
v_mul_f32 v30, s26, v30
v_mul_f32 v31, s26, v31
v_cvt_pk_bf16_f32 v228, v28, v29
v_cvt_pk_bf16_f32 v229, v30, v31
v_lshlrev_b32 v28, 16, v230
v_and_b32 v29, s30, v230
v_lshlrev_b32 v30, 16, v231
v_and_b32 v31, s30, v231
v_mul_f32 v28, s26, v28
v_mul_f32 v29, s26, v29
v_mul_f32 v30, s26, v30
v_mul_f32 v31, s26, v31
v_cvt_pk_bf16_f32 v230, v28, v29
v_cvt_pk_bf16_f32 v231, v30, v31
ds_write_b128 v22, v[228:231] offset:13312
s_waitcnt vmcnt(14)
v_lshlrev_b32 v28, 16, v232
v_and_b32 v29, s30, v232
v_lshlrev_b32 v30, 16, v233
v_and_b32 v31, s30, v233
v_mul_f32 v28, s26, v28
v_mul_f32 v29, s26, v29
v_mul_f32 v30, s26, v30
v_mul_f32 v31, s26, v31
v_cvt_pk_bf16_f32 v232, v28, v29
v_cvt_pk_bf16_f32 v233, v30, v31
v_lshlrev_b32 v28, 16, v234
v_and_b32 v29, s30, v234
v_lshlrev_b32 v30, 16, v235
v_and_b32 v31, s30, v235
v_mul_f32 v28, s26, v28
v_mul_f32 v29, s26, v29
v_mul_f32 v30, s26, v30
v_mul_f32 v31, s26, v31
v_cvt_pk_bf16_f32 v234, v28, v29
v_cvt_pk_bf16_f32 v235, v30, v31
ds_write_b128 v22, v[232:235] offset:14336
s_waitcnt vmcnt(13)
v_lshlrev_b32 v28, 16, v236
v_and_b32 v29, s30, v236
v_lshlrev_b32 v30, 16, v237
v_and_b32 v31, s30, v237
v_mul_f32 v28, s26, v28
v_mul_f32 v29, s26, v29
v_mul_f32 v30, s26, v30
v_mul_f32 v31, s26, v31
v_cvt_pk_bf16_f32 v236, v28, v29
v_cvt_pk_bf16_f32 v237, v30, v31
v_lshlrev_b32 v28, 16, v238
v_and_b32 v29, s30, v238
v_lshlrev_b32 v30, 16, v239
v_and_b32 v31, s30, v239
v_mul_f32 v28, s26, v28
v_mul_f32 v29, s26, v29
v_mul_f32 v30, s26, v30
v_mul_f32 v31, s26, v31
v_cvt_pk_bf16_f32 v238, v28, v29
v_cvt_pk_bf16_f32 v239, v30, v31
ds_write_b128 v22, v[236:239] offset:15360
ds_read_b128 a[48:51], v23 offset:12288
ds_read_b128 a[52:55], v24 offset:12288
ds_read_b128 a[56:59], v25 offset:12288
ds_read_b128 a[60:63], v26 offset:12288
v_cvt_pk_bf16_f32 v72, v80, v81
v_cvt_pk_bf16_f32 v73, v82, v83
v_cvt_pk_bf16_f32 v74, v84, v85
v_cvt_pk_bf16_f32 v75, v86, v87
s_waitcnt lgkmcnt(0)
v_mfma_f32_16x16x32_bf16 v[80:83], a[80:83], a[16:19], 0
v_cvt_pk_bf16_f32 v76, v88, v89
v_cvt_pk_bf16_f32 v77, v90, v91
v_mfma_f32_16x16x32_bf16 v[80:83], a[84:87], a[20:23], v[80:83]
v_mov_b32 v78, 0
v_mov_b32 v79, 0
v_mfma_f32_16x16x32_bf16 v[80:83], a[88:91], a[24:27], v[80:83]
s_add_u32 m0, s21, 32768
v_mfma_f32_16x16x32_bf16 v[80:83], a[92:95], a[28:31], v[80:83]
buffer_load_dwordx4 v16, s[8:11], s20 offen nt lds
v_mfma_f32_16x16x32_bf16 v[84:87], a[108:111], a[28:31], 0
v_mfma_f32_16x16x32_bf16 v[84:87], a[104:107], a[24:27], v[84:87]
v_mfma_f32_16x16x32_bf16 v[84:87], a[100:103], a[20:23], v[84:87]
v_mfma_f32_16x16x32_bf16 v[84:87], a[96:99], a[16:19], v[84:87]
s_nop 2
v_max3_f32 v1, v80, v81, v82
v_max_f32 v1, v1, v83
v_mov_b32 v2, v1
v_mfma_f32_16x16x32_bf16 v[88:91], a[112:115], a[16:19], 0
s_nop 0
v_permlane16_swap_b32 v1, v2
v_max_f32 v1, v1, v2
v_mfma_f32_16x16x32_bf16 v[88:91], a[116:119], a[20:23], v[88:91]
s_add_u32 s36, s22, 1024
v_mfma_f32_16x16x32_bf16 v[88:91], a[120:123], a[24:27], v[88:91]
buffer_load_dwordx4 v[36:39], v19, s[4:7], s36 offen nt
v_mfma_f32_16x16x32_bf16 v[88:91], a[124:127], a[28:31], v[88:91]
v_mov_b32 v2, v1
s_nop 1
v_permlane32_swap_b32 v1, v2
v_smfmac_f32_16x16x64_bf16 a[208:211], a[228:231], v[72:79], v0
v_max_f32 v1, v1, v2
v_sub_f32 v56, 0, v1
v_add_f32 v80, v80, v56
v_add_f32 v81, v81, v56
v_mfma_f32_16x16x32_bf16 v[96:99], a[148:151], v[76:79], 0
v_add_f32 v82, v82, v56
v_add_f32 v83, v83, v56
v_mov_b32 v57, v56
v_mfma_f32_16x16x32_bf16 v[96:99], a[144:147], v[72:75], v[96:99]
v_exp_f32 v80, v80
v_mfma_f32_16x16x32_bf16 v[100:103], a[152:155], v[72:75], 0
v_exp_f32 v81, v81
v_exp_f32 v82, v82
v_mfma_f32_16x16x32_bf16 v[100:103], a[156:159], v[76:79], v[100:103]
v_exp_f32 v83, v83
v_add_f32 v84, v84, v56
v_mfma_f32_16x16x32_bf16 v[104:107], a[164:167], v[76:79], 0
v_add_f32 v85, v85, v56
v_add_f32 v86, v86, v56
v_add_f32 v87, v87, v56
v_mfma_f32_16x16x32_bf16 v[104:107], a[160:163], v[72:75], v[104:107]
s_add_u32 m0, s21, 73728
v_mfma_f32_16x16x32_bf16 v[108:111], a[168:171], v[72:75], 0
buffer_load_dwordx4 v17, s[12:15], s20 offen nt lds
v_mfma_f32_16x16x32_bf16 v[108:111], a[172:175], v[76:79], v[108:111]
s_add_u32 s20, s20, 4096
v_mov_b32 v58, v56
v_exp_f32 v84, v84
v_mfma_f32_16x16x32_bf16 v[112:115], a[180:183], v[76:79], 0
v_exp_f32 v85, v85
v_exp_f32 v86, v86
v_mfma_f32_16x16x32_bf16 v[112:115], a[176:179], v[72:75], v[112:115]
v_exp_f32 v87, v87
v_add_f32 v88, v88, v56
v_mfma_f32_16x16x32_bf16 v[116:119], a[184:187], v[72:75], 0
v_add_f32 v89, v89, v56
v_add_f32 v90, v90, v56
v_add_f32 v91, v91, v56
v_mfma_f32_16x16x32_bf16 v[116:119], a[188:191], v[76:79], v[116:119]
v_mov_b32 v59, v56
v_exp_f32 v88, v88
v_mfma_f32_16x16x32_bf16 v[120:123], a[196:199], v[76:79], 0
v_exp_f32 v89, v89
v_mfma_f32_16x16x32_bf16 v[120:123], a[192:195], v[72:75], v[120:123]
v_exp_f32 v90, v90
v_exp_f32 v91, v91
s_waitcnt vmcnt(15)
v_lshlrev_b32 v28, 16, v240
v_and_b32 v29, s30, v240
v_lshlrev_b32 v30, 16, v241
v_and_b32 v31, s30, v241
v_mul_f32 v28, s26, v28
v_mul_f32 v29, s26, v29
v_mul_f32 v30, s26, v30
v_mul_f32 v31, s26, v31
v_cvt_pk_bf16_f32 v240, v28, v29
v_cvt_pk_bf16_f32 v241, v30, v31
v_lshlrev_b32 v28, 16, v242
v_and_b32 v29, s30, v242
v_lshlrev_b32 v30, 16, v243
v_and_b32 v31, s30, v243
v_mul_f32 v28, s26, v28
v_mul_f32 v29, s26, v29
v_mul_f32 v30, s26, v30
v_mul_f32 v31, s26, v31
v_cvt_pk_bf16_f32 v242, v28, v29
v_cvt_pk_bf16_f32 v243, v30, v31
ds_write_b128 v22, v[240:243] offset:16384
s_waitcnt vmcnt(14)
v_lshlrev_b32 v28, 16, v244
v_and_b32 v29, s30, v244
v_lshlrev_b32 v30, 16, v245
v_and_b32 v31, s30, v245
v_mul_f32 v28, s26, v28
v_mul_f32 v29, s26, v29
v_mul_f32 v30, s26, v30
v_mul_f32 v31, s26, v31
v_cvt_pk_bf16_f32 v244, v28, v29
v_cvt_pk_bf16_f32 v245, v30, v31
v_lshlrev_b32 v28, 16, v246
v_and_b32 v29, s30, v246
v_lshlrev_b32 v30, 16, v247
v_and_b32 v31, s30, v247
v_mul_f32 v28, s26, v28
v_mul_f32 v29, s26, v29
v_mul_f32 v30, s26, v30
v_mul_f32 v31, s26, v31
v_cvt_pk_bf16_f32 v246, v28, v29
v_cvt_pk_bf16_f32 v247, v30, v31
ds_write_b128 v22, v[244:247] offset:17408
s_waitcnt vmcnt(13)
v_lshlrev_b32 v28, 16, v248
v_and_b32 v29, s30, v248
v_lshlrev_b32 v30, 16, v249
v_and_b32 v31, s30, v249
v_mul_f32 v28, s26, v28
v_mul_f32 v29, s26, v29
v_mul_f32 v30, s26, v30
v_mul_f32 v31, s26, v31
v_cvt_pk_bf16_f32 v248, v28, v29
v_cvt_pk_bf16_f32 v249, v30, v31
v_lshlrev_b32 v28, 16, v250
v_and_b32 v29, s30, v250
v_lshlrev_b32 v30, 16, v251
v_and_b32 v31, s30, v251
v_mul_f32 v28, s26, v28
v_mul_f32 v29, s26, v29
v_mul_f32 v30, s26, v30
v_mul_f32 v31, s26, v31
v_cvt_pk_bf16_f32 v250, v28, v29
v_cvt_pk_bf16_f32 v251, v30, v31
ds_write_b128 v22, v[248:251] offset:18432
s_waitcnt vmcnt(12)
v_lshlrev_b32 v28, 16, v252
v_and_b32 v29, s30, v252
v_lshlrev_b32 v30, 16, v253
v_and_b32 v31, s30, v253
v_mul_f32 v28, s26, v28
v_mul_f32 v29, s26, v29
v_mul_f32 v30, s26, v30
v_mul_f32 v31, s26, v31
v_cvt_pk_bf16_f32 v252, v28, v29
v_cvt_pk_bf16_f32 v253, v30, v31
v_lshlrev_b32 v28, 16, v254
v_and_b32 v29, s30, v254
v_lshlrev_b32 v30, 16, v255
v_and_b32 v31, s30, v255
v_mul_f32 v28, s26, v28
v_mul_f32 v29, s26, v29
v_mul_f32 v30, s26, v30
v_mul_f32 v31, s26, v31
v_cvt_pk_bf16_f32 v254, v28, v29
v_cvt_pk_bf16_f32 v255, v30, v31
ds_write_b128 v22, v[252:255] offset:19456
ds_read_b128 a[64:67], v23 offset:16384
ds_read_b128 a[68:71], v24 offset:16384
ds_read_b128 a[72:75], v25 offset:16384
ds_read_b128 a[76:79], v26 offset:16384
v_mfma_f32_16x16x32_bf16 v[124:127], a[200:203], v[72:75], 0
v_cvt_pk_bf16_f32 v72, v80, v81
v_cvt_pk_bf16_f32 v73, v82, v83
v_mfma_f32_16x16x32_bf16 v[124:127], a[204:207], v[76:79], v[124:127]
v_cvt_pk_bf16_f32 v74, v84, v85
v_cvt_pk_bf16_f32 v75, v86, v87
s_waitcnt lgkmcnt(0)
v_mfma_f32_16x16x32_bf16 v[80:83], a[80:83], a[32:35], 0
v_cvt_pk_bf16_f32 v76, v88, v89
v_cvt_pk_bf16_f32 v77, v90, v91
v_mfma_f32_16x16x32_bf16 v[80:83], a[84:87], a[36:39], v[80:83]
v_mfma_f32_16x16x32_bf16 v[80:83], a[88:91], a[40:43], v[80:83]
s_add_u32 m0, s21, 36864
v_mfma_f32_16x16x32_bf16 v[80:83], a[92:95], a[44:47], v[80:83]
buffer_load_dwordx4 v16, s[8:11], s20 offen nt lds
v_mfma_f32_16x16x32_bf16 v[84:87], a[108:111], a[44:47], 0
v_mfma_f32_16x16x32_bf16 v[84:87], a[104:107], a[40:43], v[84:87]
s_add_u32 s36, s22, 2048
v_mfma_f32_16x16x32_bf16 v[84:87], a[100:103], a[36:39], v[84:87]
buffer_load_dwordx4 v[40:43], v20, s[4:7], s36 offen nt
v_mfma_f32_16x16x32_bf16 v[84:87], a[96:99], a[32:35], v[84:87]
s_nop 0
v_max3_f32 v1, v80, v81, v82
v_max_f32 v1, v1, v83
v_mov_b32 v2, v1
v_mfma_f32_16x16x32_bf16 v[88:91], a[112:115], a[32:35], 0
s_nop 0
v_permlane16_swap_b32 v1, v2
v_mfma_f32_16x16x32_bf16 v[88:91], a[116:119], a[36:39], v[88:91]
v_max_f32 v1, v1, v2
v_mov_b32 v2, v1
v_mfma_f32_16x16x32_bf16 v[88:91], a[120:123], a[40:43], v[88:91]
s_nop 0
v_permlane32_swap_b32 v1, v2
v_max_f32 v1, v1, v2
v_mfma_f32_16x16x32_bf16 v[88:91], a[124:127], a[44:47], v[88:91]
v_sub_f32 v60, 0, v1
v_add_f32 v80, v80, v60
v_add_f32 v81, v81, v60
v_smfmac_f32_16x16x64_bf16 a[212:215], a[228:231], v[72:79], v0
v_add_f32 v82, v82, v60
v_add_f32 v83, v83, v60
v_mfma_f32_16x16x32_bf16 v[128:131], a[148:151], v[76:79], 0
v_mov_b32 v61, v60
v_exp_f32 v80, v80
v_mfma_f32_16x16x32_bf16 v[128:131], a[144:147], v[72:75], v[128:131]
v_exp_f32 v81, v81
v_mfma_f32_16x16x32_bf16 v[132:135], a[152:155], v[72:75], 0
v_exp_f32 v82, v82
v_mfma_f32_16x16x32_bf16 v[132:135], a[156:159], v[76:79], v[132:135]
v_exp_f32 v83, v83
v_add_f32 v84, v84, v60
v_mfma_f32_16x16x32_bf16 v[136:139], a[164:167], v[76:79], 0
v_add_f32 v85, v85, v60
v_add_f32 v86, v86, v60
v_add_f32 v87, v87, v60
v_mfma_f32_16x16x32_bf16 v[136:139], a[160:163], v[72:75], v[136:139]
v_mov_b32 v62, v60
v_exp_f32 v84, v84
v_mfma_f32_16x16x32_bf16 v[140:143], a[168:171], v[72:75], 0
v_exp_f32 v85, v85
v_mfma_f32_16x16x32_bf16 v[140:143], a[172:175], v[76:79], v[140:143]
v_exp_f32 v86, v86
v_mfma_f32_16x16x32_bf16 v[144:147], a[180:183], v[76:79], 0
v_exp_f32 v87, v87
v_add_f32 v88, v88, v60
v_mfma_f32_16x16x32_bf16 v[144:147], a[176:179], v[72:75], v[144:147]
v_add_f32 v89, v89, v60
v_add_f32 v90, v90, v60
v_mfma_f32_16x16x32_bf16 v[148:151], a[184:187], v[72:75], 0
v_add_f32 v91, v91, v60
v_mov_b32 v63, v60
v_mfma_f32_16x16x32_bf16 v[148:151], a[188:191], v[76:79], v[148:151]
v_exp_f32 v88, v88
v_exp_f32 v89, v89
v_mfma_f32_16x16x32_bf16 v[152:155], a[196:199], v[76:79], 0
v_exp_f32 v90, v90
v_mfma_f32_16x16x32_bf16 v[152:155], a[192:195], v[72:75], v[152:155]
v_exp_f32 v91, v91
v_mfma_f32_16x16x32_bf16 v[156:159], a[200:203], v[72:75], 0
v_cvt_pk_bf16_f32 v72, v80, v81
v_cvt_pk_bf16_f32 v73, v82, v83
v_mfma_f32_16x16x32_bf16 v[156:159], a[204:207], v[76:79], v[156:159]
v_cvt_pk_bf16_f32 v74, v84, v85
v_cvt_pk_bf16_f32 v75, v86, v87
v_mfma_f32_16x16x32_bf16 v[80:83], a[80:83], a[48:51], 0
v_cvt_pk_bf16_f32 v76, v88, v89
v_cvt_pk_bf16_f32 v77, v90, v91
v_mfma_f32_16x16x32_bf16 v[80:83], a[84:87], a[52:55], v[80:83]
v_mfma_f32_16x16x32_bf16 v[80:83], a[88:91], a[56:59], v[80:83]
s_add_u32 m0, s21, 77824
v_mfma_f32_16x16x32_bf16 v[80:83], a[92:95], a[60:63], v[80:83]
buffer_load_dwordx4 v17, s[12:15], s20 offen nt lds
v_mfma_f32_16x16x32_bf16 v[84:87], a[108:111], a[60:63], 0
s_add_u32 s20, s20, 4096
v_mfma_f32_16x16x32_bf16 v[84:87], a[104:107], a[56:59], v[84:87]
s_add_u32 s36, s22, 3072
v_mfma_f32_16x16x32_bf16 v[84:87], a[100:103], a[52:55], v[84:87]
buffer_load_dwordx4 v[44:47], v21, s[4:7], s36 offen nt
v_mfma_f32_16x16x32_bf16 v[84:87], a[96:99], a[48:51], v[84:87]
v_max3_f32 v1, v80, v81, v82
v_max_f32 v1, v1, v83
v_mov_b32 v2, v1
v_mfma_f32_16x16x32_bf16 v[88:91], a[112:115], a[48:51], 0
s_nop 0
v_permlane16_swap_b32 v1, v2
v_mfma_f32_16x16x32_bf16 v[88:91], a[116:119], a[52:55], v[88:91]
v_max_f32 v1, v1, v2
v_mov_b32 v2, v1
v_mfma_f32_16x16x32_bf16 v[88:91], a[120:123], a[56:59], v[88:91]
s_nop 0
v_permlane32_swap_b32 v1, v2
v_max_f32 v1, v1, v2
v_mfma_f32_16x16x32_bf16 v[88:91], a[124:127], a[60:63], v[88:91]
v_sub_f32 v64, 0, v1
v_add_f32 v80, v80, v64
v_add_f32 v81, v81, v64
v_smfmac_f32_16x16x64_bf16 a[216:219], a[228:231], v[72:79], v0
v_add_f32 v82, v82, v64
v_add_f32 v83, v83, v64
v_mfma_f32_16x16x32_bf16 v[160:163], a[148:151], v[76:79], 0
v_mov_b32 v65, v64
v_exp_f32 v80, v80
v_mfma_f32_16x16x32_bf16 v[160:163], a[144:147], v[72:75], v[160:163]
v_exp_f32 v81, v81
v_mfma_f32_16x16x32_bf16 v[164:167], a[152:155], v[72:75], 0
v_exp_f32 v82, v82
v_mfma_f32_16x16x32_bf16 v[164:167], a[156:159], v[76:79], v[164:167]
v_exp_f32 v83, v83
v_add_f32 v84, v84, v64
v_mfma_f32_16x16x32_bf16 v[168:171], a[164:167], v[76:79], 0
v_add_f32 v85, v85, v64
v_add_f32 v86, v86, v64
v_add_f32 v87, v87, v64
v_mfma_f32_16x16x32_bf16 v[168:171], a[160:163], v[72:75], v[168:171]
v_mov_b32 v66, v64
v_exp_f32 v84, v84
v_mfma_f32_16x16x32_bf16 v[172:175], a[168:171], v[72:75], 0
v_exp_f32 v85, v85
v_mfma_f32_16x16x32_bf16 v[172:175], a[172:175], v[76:79], v[172:175]
v_exp_f32 v86, v86
v_mfma_f32_16x16x32_bf16 v[176:179], a[180:183], v[76:79], 0
v_exp_f32 v87, v87
v_add_f32 v88, v88, v64
v_mfma_f32_16x16x32_bf16 v[176:179], a[176:179], v[72:75], v[176:179]
v_add_f32 v89, v89, v64
v_add_f32 v90, v90, v64
v_mfma_f32_16x16x32_bf16 v[180:183], a[184:187], v[72:75], 0
v_add_f32 v91, v91, v64
v_mov_b32 v67, v64
v_mfma_f32_16x16x32_bf16 v[180:183], a[188:191], v[76:79], v[180:183]
v_exp_f32 v88, v88
v_exp_f32 v89, v89
v_mfma_f32_16x16x32_bf16 v[184:187], a[196:199], v[76:79], 0
v_exp_f32 v90, v90
v_mfma_f32_16x16x32_bf16 v[184:187], a[192:195], v[72:75], v[184:187]
s_waitcnt vmcnt(7)
v_exp_f32 v91, v91
v_mfma_f32_16x16x32_bf16 v[188:191], a[200:203], v[72:75], 0
s_barrier
v_cvt_pk_bf16_f32 v72, v80, v81
v_cvt_pk_bf16_f32 v73, v82, v83
v_mfma_f32_16x16x32_bf16 v[188:191], a[204:207], v[76:79], v[188:191]
v_cvt_pk_bf16_f32 v74, v84, v85
v_cvt_pk_bf16_f32 v75, v86, v87
v_mfma_f32_16x16x32_bf16 v[80:83], a[80:83], a[64:67], 0
v_cvt_pk_bf16_f32 v76, v88, v89
v_cvt_pk_bf16_f32 v77, v90, v91
v_mfma_f32_16x16x32_bf16 v[80:83], a[84:87], a[68:71], v[80:83]
v_mfma_f32_16x16x32_bf16 v[80:83], a[88:91], a[72:75], v[80:83]
s_add_u32 m0, s21, 0
ds_read_b128 a[80:83], v4 offset:16384
ds_read_b128 a[84:87], v5 offset:16384
v_mfma_f32_16x16x32_bf16 v[80:83], a[92:95], a[76:79], v[80:83]
buffer_load_dwordx4 v16, s[8:11], s20 offen nt lds
v_mfma_f32_16x16x32_bf16 v[84:87], a[108:111], a[76:79], 0
ds_read_b128 a[88:91], v6 offset:16384
ds_read_b128 a[92:95], v7 offset:16384
v_mfma_f32_16x16x32_bf16 v[84:87], a[104:107], a[72:75], v[84:87]
v_mfma_f32_16x16x32_bf16 v[84:87], a[100:103], a[68:71], v[84:87]
ds_read_b128 a[108:111], v7 offset:20480
ds_read_b128 a[104:107], v6 offset:20480
v_mfma_f32_16x16x32_bf16 v[84:87], a[96:99], a[64:67], v[84:87]
v_max3_f32 v1, v80, v81, v82
v_max_f32 v1, v1, v83
v_mov_b32 v2, v1
v_mfma_f32_16x16x32_bf16 v[88:91], a[112:115], a[64:67], 0
s_nop 0
v_permlane16_swap_b32 v1, v2
v_max_f32 v1, v1, v2
v_mov_b32 v2, v1
v_mfma_f32_16x16x32_bf16 v[88:91], a[116:119], a[68:71], v[88:91]
s_add_u32 s36, s22, 4096
ds_read_b128 a[100:103], v5 offset:20480
ds_read_b128 a[96:99], v4 offset:20480
v_mfma_f32_16x16x32_bf16 v[88:91], a[120:123], a[72:75], v[88:91]
buffer_load_dwordx4 v[48:51], v18, s[4:7], s36 offen nt
v_mfma_f32_16x16x32_bf16 v[88:91], a[124:127], a[76:79], v[88:91]
v_permlane32_swap_b32 v1, v2
v_max_f32 v1, v1, v2
v_sub_f32 v68, s25, v1
v_add_f32 v80, v80, v68
v_smfmac_f32_16x16x64_bf16 a[220:223], a[228:231], v[72:79], v0
v_add_f32 v81, v81, v68
v_add_f32 v82, v82, v68
v_add_f32 v83, v83, v68
v_mfma_f32_16x16x32_bf16 v[192:195], a[148:151], v[76:79], 0
s_add_u32 m0, s21, 40960
ds_read_b128 a[112:115], v4 offset:24576
ds_read_b128 a[116:119], v5 offset:24576
v_mfma_f32_16x16x32_bf16 v[192:195], a[144:147], v[72:75], v[192:195]
buffer_load_dwordx4 v17, s[12:15], s20 offen nt lds
v_mfma_f32_16x16x32_bf16 v[196:199], a[152:155], v[72:75], 0
s_add_u32 s20, s20, 4096
v_mov_b32 v69, v68
v_exp_f32 v80, v80
v_exp_f32 v81, v81
v_mfma_f32_16x16x32_bf16 v[196:199], a[156:159], v[76:79], v[196:199]
v_exp_f32 v82, v82
v_exp_f32 v83, v83
v_mfma_f32_16x16x32_bf16 v[200:203], a[164:167], v[76:79], 0
ds_read_b128 a[120:123], v6 offset:24576
ds_read_b128 a[124:127], v7 offset:24576
v_add_f32 v84, v84, v68
v_mfma_f32_16x16x32_bf16 v[200:203], a[160:163], v[72:75], v[200:203]
v_add_f32 v85, v85, v68
v_add_f32 v86, v86, v68
v_add_f32 v87, v87, v68
v_mov_b32 v70, v68
v_mfma_f32_16x16x32_bf16 v[204:207], a[168:171], v[72:75], 0
v_exp_f32 v84, v84
v_exp_f32 v85, v85
v_mfma_f32_16x16x32_bf16 v[204:207], a[172:175], v[76:79], v[204:207]
ds_read_b128 a[140:143], v7 offset:28672
ds_read_b128 a[136:139], v6 offset:28672
v_exp_f32 v86, v86
v_mfma_f32_16x16x32_bf16 v[208:211], a[180:183], v[76:79], 0
v_exp_f32 v87, v87
v_add_f32 v88, v88, v68
v_mfma_f32_16x16x32_bf16 v[208:211], a[176:179], v[72:75], v[208:211]
v_add_f32 v89, v89, v68
v_add_f32 v90, v90, v68
v_add_f32 v91, v91, v68
v_mov_b32 v71, v68
v_mfma_f32_16x16x32_bf16 v[212:215], a[184:187], v[72:75], 0
s_add_u32 m0, s21, 4096
ds_read_b128 a[132:135], v5 offset:28672
ds_read_b128 a[128:131], v4 offset:28672
v_mfma_f32_16x16x32_bf16 v[212:215], a[188:191], v[76:79], v[212:215]
buffer_load_dwordx4 v16, s[8:11], s20 offen nt lds
v_mfma_f32_16x16x32_bf16 v[216:219], a[196:199], v[76:79], 0
v_exp_f32 v88, v88
v_exp_f32 v89, v89
v_mfma_f32_16x16x32_bf16 v[216:219], a[192:195], v[72:75], v[216:219]
s_waitcnt lgkmcnt(0)
v_exp_f32 v90, v90
v_exp_f32 v91, v91
v_mfma_f32_16x16x32_bf16 v[220:223], a[200:203], v[72:75], 0
v_cvt_pk_bf16_f32 v72, v80, v81
v_cvt_pk_bf16_f32 v73, v82, v83
v_mfma_f32_16x16x32_bf16 v[220:223], a[204:207], v[76:79], v[220:223]
v_cvt_pk_bf16_f32 v74, v84, v85
v_cvt_pk_bf16_f32 v75, v86, v87
s_branch MAIN
.p2align 3
REST:
v_mfma_f32_16x16x32_bf16 v[80:83], a[80:83], a[32:35], v[60:63]
v_cvt_pk_bf16_f32 v76, v88, v89
v_cvt_pk_bf16_f32 v77, v90, v91
v_mfma_f32_16x16x32_bf16 v[80:83], a[84:87], a[36:39], v[80:83]
v_cvt_pk_bf16_f32 v78, v92, v93
v_cvt_pk_bf16_f32 v79, v94, v95
v_mfma_f32_16x16x32_bf16 v[80:83], a[88:91], a[40:43], v[80:83]
s_add_u32 m0, s21, 20480
ds_read_b128 a[0:3], v23 offset:0
ds_read_b128 a[4:7], v24 offset:0
v_mfma_f32_16x16x32_bf16 v[80:83], a[92:95], a[44:47], v[80:83]
buffer_load_dwordx4 v16, s[8:11], s20 offen nt lds
v_mfma_f32_16x16x32_bf16 v[84:87], a[108:111], a[44:47], v[60:63]
ds_read_b128 a[8:11], v25 offset:0
ds_read_b128 a[12:15], v26 offset:0
v_mfma_f32_16x16x32_bf16 v[84:87], a[104:107], a[40:43], v[84:87]
ds_read_b128 a[16:19], v23 offset:4096
ds_read_b128 a[20:23], v24 offset:4096
v_mfma_f32_16x16x32_bf16 v[84:87], a[100:103], a[36:39], v[84:87]
ds_read_b128 a[24:27], v25 offset:4096
ds_read_b128 a[28:31], v26 offset:4096
v_mfma_f32_16x16x32_bf16 v[84:87], a[96:99], a[32:35], v[84:87]
v_mul_f32 v28, s26, v28
v_mul_f32 v29, s26, v29
v_mfma_f32_16x16x32_bf16 v[88:91], a[112:115], a[32:35], v[60:63]
v_mul_f32 v30, s26, v30
v_mul_f32 v31, s26, v31
v_mfma_f32_16x16x32_bf16 v[88:91], a[116:119], a[36:39], v[88:91]
v_cvt_pk_bf16_f32 v46, v28, v29
v_cvt_pk_bf16_f32 v47, v30, v31
v_mfma_f32_16x16x32_bf16 v[88:91], a[120:123], a[40:43], v[88:91]
ds_write_b128 v22, v[44:47] offset:18432
v_mfma_f32_16x16x32_bf16 v[88:91], a[124:127], a[44:47], v[88:91]
v_lshlrev_b32 v28, 16, v48
v_and_b32 v29, s30, v48
v_lshlrev_b32 v30, 16, v49
v_mfma_f32_16x16x32_bf16 v[92:95], a[140:143], a[44:47], v[60:63]
v_and_b32 v31, s30, v49
v_mul_f32 v28, s26, v28
v_mfma_f32_16x16x32_bf16 v[92:95], a[136:139], a[40:43], v[92:95]
v_mul_f32 v29, s26, v29
v_mul_f32 v30, s26, v30
v_mfma_f32_16x16x32_bf16 v[92:95], a[132:135], a[36:39], v[92:95]
v_exp_f32 v80, v80
v_mfma_f32_16x16x32_bf16 v[92:95], a[128:131], a[32:35], v[92:95]
v_exp_f32 v81, v81
v_smfmac_f32_16x16x64_bf16 a[212:215], a[228:231], v[72:79], v0
v_mul_f32 v31, s26, v31
v_mfma_f32_16x16x32_bf16 v[128:131], a[148:151], v[76:79], v[128:131]
v_exp_f32 v82, v82
v_mfma_f32_16x16x32_bf16 v[128:131], a[144:147], v[72:75], v[128:131]
v_exp_f32 v83, v83
v_mfma_f32_16x16x32_bf16 v[132:135], a[152:155], v[72:75], v[132:135]
v_exp_f32 v84, v84
v_mfma_f32_16x16x32_bf16 v[132:135], a[156:159], v[76:79], v[132:135]
v_exp_f32 v85, v85
v_mfma_f32_16x16x32_bf16 v[136:139], a[164:167], v[76:79], v[136:139]
v_exp_f32 v86, v86
v_mfma_f32_16x16x32_bf16 v[136:139], a[160:163], v[72:75], v[136:139]
v_exp_f32 v87, v87
v_mfma_f32_16x16x32_bf16 v[140:143], a[168:171], v[72:75], v[140:143]
v_exp_f32 v88, v88
v_mfma_f32_16x16x32_bf16 v[140:143], a[172:175], v[76:79], v[140:143]
v_exp_f32 v89, v89
v_mfma_f32_16x16x32_bf16 v[144:147], a[180:183], v[76:79], v[144:147]
v_exp_f32 v90, v90
v_mfma_f32_16x16x32_bf16 v[144:147], a[176:179], v[72:75], v[144:147]
v_exp_f32 v91, v91
v_mfma_f32_16x16x32_bf16 v[148:151], a[184:187], v[72:75], v[148:151]
v_exp_f32 v92, v92
v_mfma_f32_16x16x32_bf16 v[148:151], a[188:191], v[76:79], v[148:151]
v_exp_f32 v93, v93
v_mfma_f32_16x16x32_bf16 v[152:155], a[196:199], v[76:79], v[152:155]
v_exp_f32 v94, v94
v_mfma_f32_16x16x32_bf16 v[152:155], a[192:195], v[72:75], v[152:155]
v_exp_f32 v95, v95
v_mfma_f32_16x16x32_bf16 v[156:159], a[200:203], v[72:75], v[156:159]
v_cvt_pk_bf16_f32 v72, v80, v81
v_cvt_pk_bf16_f32 v73, v82, v83
v_mfma_f32_16x16x32_bf16 v[156:159], a[204:207], v[76:79], v[156:159]
v_cvt_pk_bf16_f32 v74, v84, v85
v_cvt_pk_bf16_f32 v75, v86, v87
v_mfma_f32_16x16x32_bf16 v[80:83], a[80:83], a[48:51], v[64:67]
v_cvt_pk_bf16_f32 v76, v88, v89
v_cvt_pk_bf16_f32 v77, v90, v91
v_mfma_f32_16x16x32_bf16 v[80:83], a[84:87], a[52:55], v[80:83]
v_cvt_pk_bf16_f32 v78, v92, v93
v_cvt_pk_bf16_f32 v79, v94, v95
v_mfma_f32_16x16x32_bf16 v[80:83], a[88:91], a[56:59], v[80:83]
s_add_u32 m0, s21, 61440
ds_read_b128 a[32:35], v23 offset:8192
ds_read_b128 a[36:39], v24 offset:8192
v_mfma_f32_16x16x32_bf16 v[80:83], a[92:95], a[60:63], v[80:83]
buffer_load_dwordx4 v17, s[12:15], s20 offen nt lds
v_mfma_f32_16x16x32_bf16 v[84:87], a[108:111], a[60:63], v[64:67]
s_add_u32 s20, s20, 4096
ds_read_b128 a[40:43], v25 offset:8192
ds_read_b128 a[44:47], v26 offset:8192
v_mfma_f32_16x16x32_bf16 v[84:87], a[104:107], a[56:59], v[84:87]
v_cvt_pk_bf16_f32 v48, v28, v29
v_cvt_pk_bf16_f32 v49, v30, v31
v_mfma_f32_16x16x32_bf16 v[84:87], a[100:103], a[52:55], v[84:87]
s_add_u32 s29, s38, 19456
v_mfma_f32_16x16x32_bf16 v[84:87], a[96:99], a[48:51], v[84:87]
buffer_store_dwordx4 a[236:239], v21, s[16:19], s29 offen nt
v_mfma_f32_16x16x32_bf16 v[88:91], a[112:115], a[48:51], v[64:67]
v_lshlrev_b32 v28, 16, v50
v_and_b32 v29, s30, v50
v_mfma_f32_16x16x32_bf16 v[88:91], a[116:119], a[52:55], v[88:91]
v_lshlrev_b32 v30, 16, v51
v_and_b32 v31, s30, v51
v_mfma_f32_16x16x32_bf16 v[88:91], a[120:123], a[56:59], v[88:91]
v_mul_f32 v28, s26, v28
v_mul_f32 v29, s26, v29
v_mfma_f32_16x16x32_bf16 v[88:91], a[124:127], a[60:63], v[88:91]
v_mul_f32 v30, s26, v30
v_mul_f32 v31, s26, v31
v_mfma_f32_16x16x32_bf16 v[92:95], a[140:143], a[60:63], v[64:67]
v_cvt_pk_bf16_f32 v50, v28, v29
v_cvt_pk_bf16_f32 v51, v30, v31
v_mfma_f32_16x16x32_bf16 v[92:95], a[136:139], a[56:59], v[92:95]
ds_write_b128 v22, v[48:51] offset:19456
v_mfma_f32_16x16x32_bf16 v[92:95], a[132:135], a[52:55], v[92:95]
v_exp_f32 v80, v80
v_mfma_f32_16x16x32_bf16 v[92:95], a[128:131], a[48:51], v[92:95]
v_exp_f32 v81, v81
v_smfmac_f32_16x16x64_bf16 a[216:219], a[228:231], v[72:79], v0
v_mfma_f32_16x16x32_bf16 v[160:163], a[148:151], v[76:79], v[160:163]
v_exp_f32 v82, v82
v_mfma_f32_16x16x32_bf16 v[160:163], a[144:147], v[72:75], v[160:163]
v_exp_f32 v83, v83
v_mfma_f32_16x16x32_bf16 v[164:167], a[152:155], v[72:75], v[164:167]
v_exp_f32 v84, v84
v_mfma_f32_16x16x32_bf16 v[164:167], a[156:159], v[76:79], v[164:167]
v_exp_f32 v85, v85
v_mfma_f32_16x16x32_bf16 v[168:171], a[164:167], v[76:79], v[168:171]
v_exp_f32 v86, v86
v_mfma_f32_16x16x32_bf16 v[168:171], a[160:163], v[72:75], v[168:171]
v_exp_f32 v87, v87
v_mfma_f32_16x16x32_bf16 v[172:175], a[168:171], v[72:75], v[172:175]
v_exp_f32 v88, v88
v_mfma_f32_16x16x32_bf16 v[172:175], a[172:175], v[76:79], v[172:175]
v_exp_f32 v89, v89
v_mfma_f32_16x16x32_bf16 v[176:179], a[180:183], v[76:79], v[176:179]
v_exp_f32 v90, v90
v_mfma_f32_16x16x32_bf16 v[176:179], a[176:179], v[72:75], v[176:179]
v_exp_f32 v91, v91
v_mfma_f32_16x16x32_bf16 v[180:183], a[184:187], v[72:75], v[180:183]
v_exp_f32 v92, v92
v_mfma_f32_16x16x32_bf16 v[180:183], a[188:191], v[76:79], v[180:183]
v_exp_f32 v93, v93
v_mfma_f32_16x16x32_bf16 v[184:187], a[196:199], v[76:79], v[184:187]
v_exp_f32 v94, v94
v_mfma_f32_16x16x32_bf16 v[184:187], a[192:195], v[72:75], v[184:187]
s_waitcnt vmcnt(6) lgkmcnt(0)
v_exp_f32 v95, v95
v_mfma_f32_16x16x32_bf16 v[188:191], a[200:203], v[72:75], v[188:191]
s_barrier
v_cvt_pk_bf16_f32 v72, v80, v81
v_cvt_pk_bf16_f32 v73, v82, v83
v_mfma_f32_16x16x32_bf16 v[188:191], a[204:207], v[76:79], v[188:191]
v_cvt_pk_bf16_f32 v74, v84, v85
v_cvt_pk_bf16_f32 v75, v86, v87
v_mfma_f32_16x16x32_bf16 v[80:83], a[80:83], a[64:67], v[68:71]
v_cvt_pk_bf16_f32 v76, v88, v89
v_cvt_pk_bf16_f32 v77, v90, v91
v_mfma_f32_16x16x32_bf16 v[80:83], a[84:87], a[68:71], v[80:83]
v_cvt_pk_bf16_f32 v78, v92, v93
v_cvt_pk_bf16_f32 v79, v94, v95
v_mfma_f32_16x16x32_bf16 v[80:83], a[88:91], a[72:75], v[80:83]
s_add_u32 m0, s21, 24576
ds_read_b128 a[80:83], v4 offset:0
ds_read_b128 a[84:87], v5 offset:0
v_mfma_f32_16x16x32_bf16 v[80:83], a[92:95], a[76:79], v[80:83]
buffer_load_dwordx4 v16, s[8:11], s20 offen nt lds
v_mfma_f32_16x16x32_bf16 v[84:87], a[108:111], a[76:79], v[68:71]
ds_read_b128 a[88:91], v6 offset:0
ds_read_b128 a[92:95], v7 offset:0
v_mfma_f32_16x16x32_bf16 v[84:87], a[104:107], a[72:75], v[84:87]
ds_read_b128 a[48:51], v23 offset:12288
ds_read_b128 a[52:55], v24 offset:12288
v_mfma_f32_16x16x32_bf16 v[84:87], a[100:103], a[68:71], v[84:87]
ds_read_b128 a[108:111], v7 offset:4096
ds_read_b128 a[104:107], v6 offset:4096
v_mfma_f32_16x16x32_bf16 v[84:87], a[96:99], a[64:67], v[84:87]
ds_read_b128 a[56:59], v25 offset:12288
ds_read_b128 a[60:63], v26 offset:12288
v_mfma_f32_16x16x32_bf16 v[88:91], a[112:115], a[64:67], v[68:71]
v_mfma_f32_16x16x32_bf16 v[88:91], a[116:119], a[68:71], v[88:91]
ds_read_b128 a[100:103], v5 offset:4096
ds_read_b128 a[96:99], v4 offset:4096
v_mfma_f32_16x16x32_bf16 v[88:91], a[120:123], a[72:75], v[88:91]
v_exp_f32 v80, v80
v_mfma_f32_16x16x32_bf16 v[88:91], a[124:127], a[76:79], v[88:91]
v_exp_f32 v81, v81
v_mfma_f32_16x16x32_bf16 v[92:95], a[140:143], a[76:79], v[68:71]
v_exp_f32 v82, v82
v_mfma_f32_16x16x32_bf16 v[92:95], a[136:139], a[72:75], v[92:95]
s_add_u32 m0, s21, 65536
ds_read_b128 a[112:115], v4 offset:8192
ds_read_b128 a[116:119], v5 offset:8192
v_mfma_f32_16x16x32_bf16 v[92:95], a[132:135], a[68:71], v[92:95]
buffer_load_dwordx4 v17, s[12:15], s20 offen nt lds
v_mfma_f32_16x16x32_bf16 v[92:95], a[128:131], a[64:67], v[92:95]
s_add_u32 s20, s20, 4096
v_exp_f32 v83, v83
v_smfmac_f32_16x16x64_bf16 a[220:223], a[228:231], v[72:79], v0
v_mfma_f32_16x16x32_bf16 v[192:195], a[148:151], v[76:79], v[192:195]
ds_read_b128 a[120:123], v6 offset:8192
ds_read_b128 a[124:127], v7 offset:8192
v_mfma_f32_16x16x32_bf16 v[192:195], a[144:147], v[72:75], v[192:195]
v_exp_f32 v84, v84
v_mfma_f32_16x16x32_bf16 v[196:199], a[152:155], v[72:75], v[196:199]
v_exp_f32 v85, v85
v_mfma_f32_16x16x32_bf16 v[196:199], a[156:159], v[76:79], v[196:199]
v_exp_f32 v86, v86
v_mfma_f32_16x16x32_bf16 v[200:203], a[164:167], v[76:79], v[200:203]
v_exp_f32 v87, v87
v_mfma_f32_16x16x32_bf16 v[200:203], a[160:163], v[72:75], v[200:203]
v_exp_f32 v88, v88
v_mfma_f32_16x16x32_bf16 v[204:207], a[168:171], v[72:75], v[204:207]
s_add_u32 m0, s21, 28672
v_exp_f32 v89, v89
v_mfma_f32_16x16x32_bf16 v[204:207], a[172:175], v[76:79], v[204:207]
buffer_load_dwordx4 v16, s[8:11], s20 offen nt lds
v_mfma_f32_16x16x32_bf16 v[208:211], a[180:183], v[76:79], v[208:211]
v_exp_f32 v90, v90
v_mfma_f32_16x16x32_bf16 v[208:211], a[176:179], v[72:75], v[208:211]
v_exp_f32 v91, v91
v_mfma_f32_16x16x32_bf16 v[212:215], a[184:187], v[72:75], v[212:215]
v_exp_f32 v92, v92
v_mfma_f32_16x16x32_bf16 v[212:215], a[188:191], v[76:79], v[212:215]
v_exp_f32 v93, v93
v_mfma_f32_16x16x32_bf16 v[216:219], a[196:199], v[76:79], v[216:219]
v_exp_f32 v94, v94
v_mfma_f32_16x16x32_bf16 v[216:219], a[192:195], v[72:75], v[216:219]
s_waitcnt lgkmcnt(0)
v_exp_f32 v95, v95
v_mfma_f32_16x16x32_bf16 v[220:223], a[200:203], v[72:75], v[220:223]
v_cvt_pk_bf16_f32 v72, v80, v81
v_cvt_pk_bf16_f32 v73, v82, v83
v_mfma_f32_16x16x32_bf16 v[220:223], a[204:207], v[76:79], v[220:223]
v_cvt_pk_bf16_f32 v74, v84, v85
v_cvt_pk_bf16_f32 v75, v86, v87
v_mfma_f32_16x16x32_bf16 v[80:83], a[80:83], a[0:3], 0
v_cvt_pk_bf16_f32 v76, v88, v89
v_cvt_pk_bf16_f32 v77, v90, v91
v_mfma_f32_16x16x32_bf16 v[80:83], a[84:87], a[4:7], v[80:83]
v_cvt_pk_bf16_f32 v78, v92, v93
v_cvt_pk_bf16_f32 v79, v94, v95
v_xor_b32 v28, 0, v27
v_xor_b32 v29, 32, v27
v_xor_b32 v30, 64, v27
v_xor_b32 v31, 96, v27
v_xor_b32 v92, 128, v27
v_xor_b32 v93, 160, v27
v_xor_b32 v94, 192, v27
v_xor_b32 v95, 224, v27
s_mov_b32 s23, s33
v_mfma_f32_16x16x32_bf16 v[80:83], a[88:91], a[8:11], v[80:83]
ds_read_b128 a[64:67], v23 offset:16384
ds_read_b128 a[68:71], v24 offset:16384
s_or_b32 s38, s33, s24
s_add_u32 s33, s33, 20447232
v_accvgpr_read_b32 v3, a208
v_accvgpr_read_b32 v2, a209
v_accvgpr_write_b32 a208, 0
v_add_f32 v3, v3, v2
v_accvgpr_write_b32 a209, 0
v_cmp_ngt_f32 vcc, s31, v3
v_rcp_f32 v3, v3
v_mfma_f32_16x16x32_bf16 v[80:83], a[92:95], a[12:15], v[80:83]
v_pk_mul_f32 v[96:97], v[96:97], v[2:3] op_sel:[0,1] op_sel_hi:[1,1]
v_pk_mul_f32 v[98:99], v[98:99], v[2:3] op_sel:[0,1] op_sel_hi:[1,1]
v_pk_mul_f32 v[100:101], v[100:101], v[2:3] op_sel:[0,1] op_sel_hi:[1,1]
v_pk_mul_f32 v[102:103], v[102:103], v[2:3] op_sel:[0,1] op_sel_hi:[1,1]
v_pk_mul_f32 v[104:105], v[104:105], v[2:3] op_sel:[0,1] op_sel_hi:[1,1]
v_pk_mul_f32 v[106:107], v[106:107], v[2:3] op_sel:[0,1] op_sel_hi:[1,1]
v_pk_mul_f32 v[108:109], v[108:109], v[2:3] op_sel:[0,1] op_sel_hi:[1,1]
v_pk_mul_f32 v[110:111], v[110:111], v[2:3] op_sel:[0,1] op_sel_hi:[1,1]
v_pk_mul_f32 v[112:113], v[112:113], v[2:3] op_sel:[0,1] op_sel_hi:[1,1]
v_pk_mul_f32 v[114:115], v[114:115], v[2:3] op_sel:[0,1] op_sel_hi:[1,1]
v_pk_mul_f32 v[116:117], v[116:117], v[2:3] op_sel:[0,1] op_sel_hi:[1,1]
v_pk_mul_f32 v[118:119], v[118:119], v[2:3] op_sel:[0,1] op_sel_hi:[1,1]
v_pk_mul_f32 v[120:121], v[120:121], v[2:3] op_sel:[0,1] op_sel_hi:[1,1]
v_pk_mul_f32 v[122:123], v[122:123], v[2:3] op_sel:[0,1] op_sel_hi:[1,1]
v_pk_mul_f32 v[124:125], v[124:125], v[2:3] op_sel:[0,1] op_sel_hi:[1,1]
v_pk_mul_f32 v[126:127], v[126:127], v[2:3] op_sel:[0,1] op_sel_hi:[1,1]
v_mfma_f32_16x16x32_bf16 v[84:87], a[108:111], a[12:15], 0
ds_read_b128 a[72:75], v25 offset:16384
ds_read_b128 a[76:79], v26 offset:16384
v_mfma_f32_16x16x32_bf16 v[84:87], a[104:107], a[8:11], v[84:87]
s_add_u32 s36, s22, 0
v_mfma_f32_16x16x32_bf16 v[84:87], a[100:103], a[4:7], v[84:87]
buffer_load_dwordx4 v[32:35], v18, s[4:7], s36 offen nt
v_mfma_f32_16x16x32_bf16 v[84:87], a[96:99], a[0:3], v[84:87]
v_max3_f32 v1, v80, v81, v82
v_cvt_pk_bf16_f32 v96, v96, v97
v_max_f32 v1, v1, v83
v_cvt_pk_bf16_f32 v97, v98, v99
v_mov_b32 v2, v1
v_mfma_f32_16x16x32_bf16 v[88:91], a[112:115], a[0:3], 0
ds_write_b64 v28, v[96:97] offset:0
v_permlane16_swap_b32 v1, v2
v_max_f32 v1, v1, v2
v_mfma_f32_16x16x32_bf16 v[88:91], a[116:119], a[4:7], v[88:91]
s_or_b64 s[34:35], s[34:35], vcc
v_mov_b32 v2, v1
v_cvt_pk_bf16_f32 v100, v100, v101
s_nop 0
v_permlane32_swap_b32 v1, v2
v_max_f32 v1, v1, v2
v_cvt_pk_bf16_f32 v101, v102, v103
v_mfma_f32_16x16x32_bf16 v[88:91], a[120:123], a[8:11], v[88:91]
v_sub_f32 v52, 0, v1
v_add_f32 v80, v80, v52
v_mfma_f32_16x16x32_bf16 v[88:91], a[124:127], a[12:15], v[88:91]
ds_write_b64 v29, v[100:101] offset:0
v_add_f32 v81, v81, v52
v_cvt_pk_bf16_f32 v104, v104, v105
v_add_f32 v82, v82, v52
v_cvt_pk_bf16_f32 v105, v106, v107
v_add_f32 v83, v83, v52
v_smfmac_f32_16x16x64_bf16 a[224:227], a[228:231], v[72:79], v0
ds_write_b64 v30, v[104:105] offset:0
v_mov_b32 v53, v52
v_exp_f32 v80, v80
v_cvt_pk_bf16_f32 v108, v108, v109
v_mfma_f32_16x16x32_bf16 v[224:227], a[148:151], v[76:79], v[224:227]
v_exp_f32 v81, v81
v_cvt_pk_bf16_f32 v109, v110, v111
v_exp_f32 v82, v82
v_mfma_f32_16x16x32_bf16 v[224:227], a[144:147], v[72:75], v[224:227]
s_add_u32 m0, s21, 69632
ds_read_b64_tr_b16 a[144:145], v8 offset:0
ds_read_b64_tr_b16 a[146:147], v8 offset:4096
v_mfma_f32_16x16x32_bf16 v[228:231], a[152:155], v[72:75], v[228:231]
buffer_load_dwordx4 v17, s[12:15], s20 offen nt lds
v_mfma_f32_16x16x32_bf16 v[228:231], a[156:159], v[76:79], v[228:231]
s_add_u32 s20, s20, 4096
v_exp_f32 v83, v83
v_add_f32 v84, v84, v52
v_mfma_f32_16x16x32_bf16 v[232:235], a[164:167], v[76:79], v[232:235]
ds_read_b64_tr_b16 a[148:149], v8 offset:8192
ds_read_b64_tr_b16 a[150:151], v8 offset:8192
ds_write_b64 v31, v[108:109] offset:0
v_cvt_pk_bf16_f32 v112, v112, v113
v_add_f32 v85, v85, v52
v_add_f32 v86, v86, v52
v_cvt_pk_bf16_f32 v113, v114, v115
v_mfma_f32_16x16x32_bf16 v[232:235], a[160:163], v[72:75], v[232:235]
v_add_f32 v87, v87, v52
v_mov_b32 v54, v52
v_mfma_f32_16x16x32_bf16 v[236:239], a[168:171], v[72:75], v[236:239]
ds_read_b64_tr_b16 a[152:153], v9 offset:0
ds_read_b64_tr_b16 a[154:155], v9 offset:4096
ds_write_b64 v92, v[112:113] offset:0
v_exp_f32 v84, v84
v_cvt_pk_bf16_f32 v116, v116, v117
v_mfma_f32_16x16x32_bf16 v[236:239], a[172:175], v[76:79], v[236:239]
v_exp_f32 v85, v85
v_cvt_pk_bf16_f32 v117, v118, v119
v_exp_f32 v86, v86
v_mfma_f32_16x16x32_bf16 v[240:243], a[180:183], v[76:79], v[240:243]
ds_read_b64_tr_b16 a[156:157], v9 offset:8192
ds_read_b64_tr_b16 a[158:159], v9 offset:8192
ds_write_b64 v93, v[116:117] offset:0
v_exp_f32 v87, v87
v_mfma_f32_16x16x32_bf16 v[240:243], a[176:179], v[72:75], v[240:243]
v_add_f32 v88, v88, v52
v_cvt_pk_bf16_f32 v120, v120, v121
v_add_f32 v89, v89, v52
v_cvt_pk_bf16_f32 v121, v122, v123
v_add_f32 v90, v90, v52
v_add_f32 v91, v91, v52
v_mfma_f32_16x16x32_bf16 v[244:247], a[184:187], v[72:75], v[244:247]
ds_read_b64_tr_b16 a[160:161], v10 offset:0
ds_read_b64_tr_b16 a[162:163], v10 offset:4096
ds_write_b64 v94, v[120:121] offset:0
v_mfma_f32_16x16x32_bf16 v[244:247], a[188:191], v[76:79], v[244:247]
v_mov_b32 v55, v52
v_cvt_pk_bf16_f32 v124, v124, v125
v_exp_f32 v88, v88
v_exp_f32 v89, v89
v_mfma_f32_16x16x32_bf16 v[248:251], a[196:199], v[76:79], v[248:251]
ds_read_b64_tr_b16 a[164:165], v10 offset:8192
ds_read_b64_tr_b16 a[166:167], v10 offset:8192
v_cvt_pk_bf16_f32 v125, v126, v127
v_exp_f32 v90, v90
v_mfma_f32_16x16x32_bf16 v[248:251], a[192:195], v[72:75], v[248:251]
ds_write_b64 v95, v[124:125] offset:0
v_exp_f32 v91, v91
v_mfma_f32_16x16x32_bf16 v[252:255], a[200:203], v[72:75], v[252:255]
v_cvt_pk_bf16_f32 v72, v80, v81
v_cvt_pk_bf16_f32 v73, v82, v83
v_mfma_f32_16x16x32_bf16 v[252:255], a[204:207], v[76:79], v[252:255]
v_cvt_pk_bf16_f32 v74, v84, v85
v_cvt_pk_bf16_f32 v75, v86, v87
v_mfma_f32_16x16x32_bf16 v[80:83], a[80:83], a[16:19], 0
v_cvt_pk_bf16_f32 v76, v88, v89
v_cvt_pk_bf16_f32 v77, v90, v91
v_mfma_f32_16x16x32_bf16 v[80:83], a[84:87], a[20:23], v[80:83]
v_mov_b32 v78, 0
v_mov_b32 v79, 0
v_accvgpr_read_b32 v3, a212
v_accvgpr_read_b32 v2, a213
v_accvgpr_write_b32 a212, 0
v_add_f32 v3, v3, v2
v_accvgpr_write_b32 a213, 0
v_cmp_ngt_f32 vcc, s31, v3
v_mfma_f32_16x16x32_bf16 v[80:83], a[88:91], a[24:27], v[80:83]
s_add_u32 m0, s21, 32768
ds_read_b64_tr_b16 a[168:169], v11 offset:0
ds_read_b64_tr_b16 a[170:171], v11 offset:4096
v_mfma_f32_16x16x32_bf16 v[80:83], a[92:95], a[28:31], v[80:83]
buffer_load_dwordx4 v16, s[8:11], s20 offen nt lds
v_mfma_f32_16x16x32_bf16 v[84:87], a[108:111], a[28:31], 0
ds_read_b64_tr_b16 a[172:173], v11 offset:8192
ds_read_b64_tr_b16 a[174:175], v11 offset:8192
v_rcp_f32 v3, v3
v_mfma_f32_16x16x32_bf16 v[84:87], a[104:107], a[24:27], v[84:87]
ds_read_b64_tr_b16 a[176:177], v12 offset:0
ds_read_b64_tr_b16 a[178:179], v12 offset:4096
v_pk_mul_f32 v[128:129], v[128:129], v[2:3] op_sel:[0,1] op_sel_hi:[1,1]
v_pk_mul_f32 v[130:131], v[130:131], v[2:3] op_sel:[0,1] op_sel_hi:[1,1]
v_pk_mul_f32 v[132:133], v[132:133], v[2:3] op_sel:[0,1] op_sel_hi:[1,1]
v_pk_mul_f32 v[134:135], v[134:135], v[2:3] op_sel:[0,1] op_sel_hi:[1,1]
v_pk_mul_f32 v[136:137], v[136:137], v[2:3] op_sel:[0,1] op_sel_hi:[1,1]
v_pk_mul_f32 v[138:139], v[138:139], v[2:3] op_sel:[0,1] op_sel_hi:[1,1]
v_pk_mul_f32 v[140:141], v[140:141], v[2:3] op_sel:[0,1] op_sel_hi:[1,1]
v_pk_mul_f32 v[142:143], v[142:143], v[2:3] op_sel:[0,1] op_sel_hi:[1,1]
v_pk_mul_f32 v[144:145], v[144:145], v[2:3] op_sel:[0,1] op_sel_hi:[1,1]
v_pk_mul_f32 v[146:147], v[146:147], v[2:3] op_sel:[0,1] op_sel_hi:[1,1]
v_pk_mul_f32 v[148:149], v[148:149], v[2:3] op_sel:[0,1] op_sel_hi:[1,1]
v_pk_mul_f32 v[150:151], v[150:151], v[2:3] op_sel:[0,1] op_sel_hi:[1,1]
v_pk_mul_f32 v[152:153], v[152:153], v[2:3] op_sel:[0,1] op_sel_hi:[1,1]
v_pk_mul_f32 v[154:155], v[154:155], v[2:3] op_sel:[0,1] op_sel_hi:[1,1]
v_pk_mul_f32 v[156:157], v[156:157], v[2:3] op_sel:[0,1] op_sel_hi:[1,1]
v_pk_mul_f32 v[158:159], v[158:159], v[2:3] op_sel:[0,1] op_sel_hi:[1,1]
v_mfma_f32_16x16x32_bf16 v[84:87], a[100:103], a[20:23], v[84:87]
ds_read_b64_tr_b16 a[180:181], v12 offset:8192
ds_read_b64_tr_b16 a[182:183], v12 offset:8192
v_mfma_f32_16x16x32_bf16 v[84:87], a[96:99], a[16:19], v[84:87]
v_max3_f32 v1, v80, v81, v82
v_cvt_pk_bf16_f32 v128, v128, v129
v_max_f32 v1, v1, v83
v_cvt_pk_bf16_f32 v129, v130, v131
v_mov_b32 v2, v1
v_mfma_f32_16x16x32_bf16 v[88:91], a[112:115], a[16:19], 0
ds_write_b64 v28, v[128:129] offset:4096
v_permlane16_swap_b32 v1, v2
v_max_f32 v1, v1, v2
s_or_b64 s[34:35], s[34:35], vcc
v_mfma_f32_16x16x32_bf16 v[88:91], a[116:119], a[20:23], v[88:91]
s_add_u32 s36, s22, 1024
ds_read_b64_tr_b16 a[184:185], v13 offset:0
ds_read_b64_tr_b16 a[186:187], v13 offset:4096
v_mfma_f32_16x16x32_bf16 v[88:91], a[120:123], a[24:27], v[88:91]
buffer_load_dwordx4 v[36:39], v19, s[4:7], s36 offen nt
v_mfma_f32_16x16x32_bf16 v[88:91], a[124:127], a[28:31], v[88:91]
v_mov_b32 v2, v1
v_cvt_pk_bf16_f32 v132, v132, v133
s_nop 0
v_permlane32_swap_b32 v1, v2
v_max_f32 v1, v1, v2
v_cvt_pk_bf16_f32 v133, v134, v135
v_sub_f32 v56, 0, v1
v_smfmac_f32_16x16x64_bf16 a[208:211], a[228:231], v[72:79], v0
s_waitcnt lgkmcnt(12)
ds_read_b64_tr_b16 a[188:189], v13 offset:8192
ds_read_b64_tr_b16 a[190:191], v13 offset:8192
ds_write_b64 v29, v[132:133] offset:4096
v_add_f32 v80, v80, v56
v_mfma_f32_16x16x32_bf16 v[96:99], a[148:151], v[76:79], 0
v_add_f32 v81, v81, v56
v_cvt_pk_bf16_f32 v136, v136, v137
v_add_f32 v82, v82, v56
v_cvt_pk_bf16_f32 v137, v138, v139
v_add_f32 v83, v83, v56
v_mfma_f32_16x16x32_bf16 v[96:99], a[144:147], v[72:75], v[96:99]
ds_write_b64 v30, v[136:137] offset:4096
v_mov_b32 v57, v56
v_exp_f32 v80, v80
v_cvt_pk_bf16_f32 v140, v140, v141
v_mfma_f32_16x16x32_bf16 v[100:103], a[152:155], v[72:75], 0
ds_read_b64_tr_b16 a[192:193], v14 offset:0
ds_read_b64_tr_b16 a[194:195], v14 offset:4096
v_exp_f32 v81, v81
v_cvt_pk_bf16_f32 v141, v142, v143
v_exp_f32 v82, v82
v_mfma_f32_16x16x32_bf16 v[100:103], a[156:159], v[76:79], v[100:103]
v_exp_f32 v83, v83
v_add_f32 v84, v84, v56
v_mfma_f32_16x16x32_bf16 v[104:107], a[164:167], v[76:79], 0
ds_write_b64 v31, v[140:141] offset:4096
v_cvt_pk_bf16_f32 v144, v144, v145
v_add_f32 v85, v85, v56
v_add_f32 v86, v86, v56
v_cvt_pk_bf16_f32 v145, v146, v147
v_add_f32 v87, v87, v56
v_mfma_f32_16x16x32_bf16 v[104:107], a[160:163], v[72:75], v[104:107]
s_add_u32 m0, s21, 73728
s_waitcnt lgkmcnt(1)
ds_read_b64_tr_b16 a[196:197], v14 offset:8192
ds_read_b64_tr_b16 a[198:199], v14 offset:8192
v_mfma_f32_16x16x32_bf16 v[108:111], a[168:171], v[72:75], 0
buffer_load_dwordx4 v17, s[12:15], s20 offen nt lds
v_mfma_f32_16x16x32_bf16 v[108:111], a[172:175], v[76:79], v[108:111]
s_add_u32 s20, s20, 4096
ds_read_b64_tr_b16 a[200:201], v15 offset:0
ds_read_b64_tr_b16 a[202:203], v15 offset:4096
ds_write_b64 v92, v[144:145] offset:4096
v_mov_b32 v58, v56
v_mfma_f32_16x16x32_bf16 v[112:115], a[180:183], v[76:79], 0
v_exp_f32 v84, v84
v_cvt_pk_bf16_f32 v148, v148, v149
v_exp_f32 v85, v85
v_cvt_pk_bf16_f32 v149, v150, v151
v_exp_f32 v86, v86
v_mfma_f32_16x16x32_bf16 v[112:115], a[176:179], v[72:75], v[112:115]
ds_write_b64 v93, v[148:149] offset:4096
v_exp_f32 v87, v87
v_mfma_f32_16x16x32_bf16 v[116:119], a[184:187], v[72:75], 0
ds_read_b64_tr_b16 a[204:205], v15 offset:8192
ds_read_b64_tr_b16 a[206:207], v15 offset:8192
v_add_f32 v88, v88, v56
v_cvt_pk_bf16_f32 v152, v152, v153
v_add_f32 v89, v89, v56
v_cvt_pk_bf16_f32 v153, v154, v155
v_mfma_f32_16x16x32_bf16 v[116:119], a[188:191], v[76:79], v[116:119]
s_waitcnt lgkmcnt(0)
v_add_f32 v90, v90, v56
v_add_f32 v91, v91, v56
v_mov_b32 v59, v56
v_cvt_pk_bf16_f32 v156, v156, v157
v_mfma_f32_16x16x32_bf16 v[120:123], a[196:199], v[76:79], 0
ds_write_b64 v94, v[152:153] offset:4096
v_exp_f32 v88, v88
v_exp_f32 v89, v89
v_cvt_pk_bf16_f32 v157, v158, v159
v_mfma_f32_16x16x32_bf16 v[120:123], a[192:195], v[72:75], v[120:123]
v_exp_f32 v90, v90
v_exp_f32 v91, v91
v_mfma_f32_16x16x32_bf16 v[124:127], a[200:203], v[72:75], 0
ds_write_b64 v95, v[156:157] offset:4096
v_cvt_pk_bf16_f32 v72, v80, v81
v_cvt_pk_bf16_f32 v73, v82, v83
v_mfma_f32_16x16x32_bf16 v[124:127], a[204:207], v[76:79], v[124:127]
v_cvt_pk_bf16_f32 v74, v84, v85
v_cvt_pk_bf16_f32 v75, v86, v87
v_mfma_f32_16x16x32_bf16 v[80:83], a[80:83], a[32:35], 0
v_cvt_pk_bf16_f32 v76, v88, v89
v_cvt_pk_bf16_f32 v77, v90, v91
v_mfma_f32_16x16x32_bf16 v[80:83], a[84:87], a[36:39], v[80:83]
v_accvgpr_read_b32 v3, a216
v_accvgpr_read_b32 v2, a217
v_accvgpr_write_b32 a216, 0
v_add_f32 v3, v3, v2
v_accvgpr_write_b32 a217, 0
v_cmp_ngt_f32 vcc, s31, v3
v_rcp_f32 v3, v3
v_mfma_f32_16x16x32_bf16 v[80:83], a[88:91], a[40:43], v[80:83]
s_add_u32 m0, s21, 36864
v_mfma_f32_16x16x32_bf16 v[80:83], a[92:95], a[44:47], v[80:83]
buffer_load_dwordx4 v16, s[8:11], s20 offen nt lds
v_mfma_f32_16x16x32_bf16 v[84:87], a[108:111], a[44:47], 0
v_pk_mul_f32 v[160:161], v[160:161], v[2:3] op_sel:[0,1] op_sel_hi:[1,1]
v_pk_mul_f32 v[162:163], v[162:163], v[2:3] op_sel:[0,1] op_sel_hi:[1,1]
v_pk_mul_f32 v[164:165], v[164:165], v[2:3] op_sel:[0,1] op_sel_hi:[1,1]
v_pk_mul_f32 v[166:167], v[166:167], v[2:3] op_sel:[0,1] op_sel_hi:[1,1]
v_pk_mul_f32 v[168:169], v[168:169], v[2:3] op_sel:[0,1] op_sel_hi:[1,1]
v_pk_mul_f32 v[170:171], v[170:171], v[2:3] op_sel:[0,1] op_sel_hi:[1,1]
v_pk_mul_f32 v[172:173], v[172:173], v[2:3] op_sel:[0,1] op_sel_hi:[1,1]
v_pk_mul_f32 v[174:175], v[174:175], v[2:3] op_sel:[0,1] op_sel_hi:[1,1]
v_pk_mul_f32 v[176:177], v[176:177], v[2:3] op_sel:[0,1] op_sel_hi:[1,1]
v_pk_mul_f32 v[178:179], v[178:179], v[2:3] op_sel:[0,1] op_sel_hi:[1,1]
v_pk_mul_f32 v[180:181], v[180:181], v[2:3] op_sel:[0,1] op_sel_hi:[1,1]
v_pk_mul_f32 v[182:183], v[182:183], v[2:3] op_sel:[0,1] op_sel_hi:[1,1]
v_pk_mul_f32 v[184:185], v[184:185], v[2:3] op_sel:[0,1] op_sel_hi:[1,1]
v_pk_mul_f32 v[186:187], v[186:187], v[2:3] op_sel:[0,1] op_sel_hi:[1,1]
v_pk_mul_f32 v[188:189], v[188:189], v[2:3] op_sel:[0,1] op_sel_hi:[1,1]
v_pk_mul_f32 v[190:191], v[190:191], v[2:3] op_sel:[0,1] op_sel_hi:[1,1]
v_mfma_f32_16x16x32_bf16 v[84:87], a[104:107], a[40:43], v[84:87]
s_add_u32 s36, s22, 2048
v_mfma_f32_16x16x32_bf16 v[84:87], a[100:103], a[36:39], v[84:87]
buffer_load_dwordx4 v[40:43], v20, s[4:7], s36 offen nt
v_mfma_f32_16x16x32_bf16 v[84:87], a[96:99], a[32:35], v[84:87]
v_max3_f32 v1, v80, v81, v82
v_cvt_pk_bf16_f32 v160, v160, v161
v_max_f32 v1, v1, v83
v_cvt_pk_bf16_f32 v161, v162, v163
v_mov_b32 v2, v1
v_mfma_f32_16x16x32_bf16 v[88:91], a[112:115], a[32:35], 0
ds_write_b64 v28, v[160:161] offset:8192
v_permlane16_swap_b32 v1, v2
v_mfma_f32_16x16x32_bf16 v[88:91], a[116:119], a[36:39], v[88:91]
v_max_f32 v1, v1, v2
s_or_b64 s[34:35], s[34:35], vcc
v_mov_b32 v2, v1
v_cvt_pk_bf16_f32 v164, v164, v165
v_mfma_f32_16x16x32_bf16 v[88:91], a[120:123], a[40:43], v[88:91]
v_permlane32_swap_b32 v1, v2
v_max_f32 v1, v1, v2
v_cvt_pk_bf16_f32 v165, v166, v167
v_mfma_f32_16x16x32_bf16 v[88:91], a[124:127], a[44:47], v[88:91]
v_sub_f32 v60, 0, v1
v_add_f32 v80, v80, v60
v_smfmac_f32_16x16x64_bf16 a[212:215], a[228:231], v[72:79], v0
ds_write_b64 v29, v[164:165] offset:8192
v_add_f32 v81, v81, v60
v_cvt_pk_bf16_f32 v168, v168, v169
v_add_f32 v82, v82, v60
v_cvt_pk_bf16_f32 v169, v170, v171
v_mfma_f32_16x16x32_bf16 v[128:131], a[148:151], v[76:79], 0
v_add_f32 v83, v83, v60
v_mov_b32 v61, v60
v_mfma_f32_16x16x32_bf16 v[128:131], a[144:147], v[72:75], v[128:131]
ds_write_b64 v30, v[168:169] offset:8192
v_exp_f32 v80, v80
v_cvt_pk_bf16_f32 v172, v172, v173
v_exp_f32 v81, v81
v_mfma_f32_16x16x32_bf16 v[132:135], a[152:155], v[72:75], 0
v_cvt_pk_bf16_f32 v173, v174, v175
v_exp_f32 v82, v82
v_mfma_f32_16x16x32_bf16 v[132:135], a[156:159], v[76:79], v[132:135]
v_exp_f32 v83, v83
v_add_f32 v84, v84, v60
v_mfma_f32_16x16x32_bf16 v[136:139], a[164:167], v[76:79], 0
ds_write_b64 v31, v[172:173] offset:8192
v_cvt_pk_bf16_f32 v176, v176, v177
v_add_f32 v85, v85, v60
v_add_f32 v86, v86, v60
v_cvt_pk_bf16_f32 v177, v178, v179
v_mfma_f32_16x16x32_bf16 v[136:139], a[160:163], v[72:75], v[136:139]
v_add_f32 v87, v87, v60
v_mov_b32 v62, v60
v_mfma_f32_16x16x32_bf16 v[140:143], a[168:171], v[72:75], 0
ds_write_b64 v92, v[176:177] offset:8192
v_exp_f32 v84, v84
v_cvt_pk_bf16_f32 v180, v180, v181
v_exp_f32 v85, v85
v_mfma_f32_16x16x32_bf16 v[140:143], a[172:175], v[76:79], v[140:143]
v_cvt_pk_bf16_f32 v181, v182, v183
v_exp_f32 v86, v86
v_mfma_f32_16x16x32_bf16 v[144:147], a[180:183], v[76:79], 0
ds_write_b64 v93, v[180:181] offset:8192
v_exp_f32 v87, v87
v_mfma_f32_16x16x32_bf16 v[144:147], a[176:179], v[72:75], v[144:147]
v_add_f32 v88, v88, v60
v_cvt_pk_bf16_f32 v184, v184, v185
v_add_f32 v89, v89, v60
v_cvt_pk_bf16_f32 v185, v186, v187
v_add_f32 v90, v90, v60
v_mfma_f32_16x16x32_bf16 v[148:151], a[184:187], v[72:75], 0
v_add_f32 v91, v91, v60
v_mfma_f32_16x16x32_bf16 v[148:151], a[188:191], v[76:79], v[148:151]
ds_write_b64 v94, v[184:185] offset:8192
v_mov_b32 v63, v60
v_cvt_pk_bf16_f32 v188, v188, v189
v_exp_f32 v88, v88
v_mfma_f32_16x16x32_bf16 v[152:155], a[196:199], v[76:79], 0
v_exp_f32 v89, v89
v_cvt_pk_bf16_f32 v189, v190, v191
v_exp_f32 v90, v90
v_mfma_f32_16x16x32_bf16 v[152:155], a[192:195], v[72:75], v[152:155]
ds_write_b64 v95, v[188:189] offset:8192
v_exp_f32 v91, v91
v_mfma_f32_16x16x32_bf16 v[156:159], a[200:203], v[72:75], 0
v_cvt_pk_bf16_f32 v72, v80, v81
v_cvt_pk_bf16_f32 v73, v82, v83
v_mfma_f32_16x16x32_bf16 v[156:159], a[204:207], v[76:79], v[156:159]
v_cvt_pk_bf16_f32 v74, v84, v85
v_cvt_pk_bf16_f32 v75, v86, v87
v_mfma_f32_16x16x32_bf16 v[80:83], a[80:83], a[48:51], 0
v_cvt_pk_bf16_f32 v76, v88, v89
v_cvt_pk_bf16_f32 v77, v90, v91
v_mfma_f32_16x16x32_bf16 v[80:83], a[84:87], a[52:55], v[80:83]
v_accvgpr_read_b32 v3, a220
v_accvgpr_read_b32 v2, a221
v_accvgpr_write_b32 a220, 0
v_add_f32 v3, v3, v2
v_accvgpr_write_b32 a221, 0
v_cmp_ngt_f32 vcc, s31, v3
v_rcp_f32 v3, v3
v_mfma_f32_16x16x32_bf16 v[80:83], a[88:91], a[56:59], v[80:83]
s_add_u32 m0, s21, 77824
v_mfma_f32_16x16x32_bf16 v[80:83], a[92:95], a[60:63], v[80:83]
buffer_load_dwordx4 v17, s[12:15], s20 offen nt lds
v_mfma_f32_16x16x32_bf16 v[84:87], a[108:111], a[60:63], 0
s_add_u32 s20, s20, 4096
v_pk_mul_f32 v[192:193], v[192:193], v[2:3] op_sel:[0,1] op_sel_hi:[1,1]
v_pk_mul_f32 v[194:195], v[194:195], v[2:3] op_sel:[0,1] op_sel_hi:[1,1]
v_pk_mul_f32 v[196:197], v[196:197], v[2:3] op_sel:[0,1] op_sel_hi:[1,1]
v_pk_mul_f32 v[198:199], v[198:199], v[2:3] op_sel:[0,1] op_sel_hi:[1,1]
v_pk_mul_f32 v[200:201], v[200:201], v[2:3] op_sel:[0,1] op_sel_hi:[1,1]
v_pk_mul_f32 v[202:203], v[202:203], v[2:3] op_sel:[0,1] op_sel_hi:[1,1]
v_pk_mul_f32 v[204:205], v[204:205], v[2:3] op_sel:[0,1] op_sel_hi:[1,1]
v_pk_mul_f32 v[206:207], v[206:207], v[2:3] op_sel:[0,1] op_sel_hi:[1,1]
v_pk_mul_f32 v[208:209], v[208:209], v[2:3] op_sel:[0,1] op_sel_hi:[1,1]
v_pk_mul_f32 v[210:211], v[210:211], v[2:3] op_sel:[0,1] op_sel_hi:[1,1]
v_pk_mul_f32 v[212:213], v[212:213], v[2:3] op_sel:[0,1] op_sel_hi:[1,1]
v_pk_mul_f32 v[214:215], v[214:215], v[2:3] op_sel:[0,1] op_sel_hi:[1,1]
v_pk_mul_f32 v[216:217], v[216:217], v[2:3] op_sel:[0,1] op_sel_hi:[1,1]
v_pk_mul_f32 v[218:219], v[218:219], v[2:3] op_sel:[0,1] op_sel_hi:[1,1]
v_pk_mul_f32 v[220:221], v[220:221], v[2:3] op_sel:[0,1] op_sel_hi:[1,1]
v_pk_mul_f32 v[222:223], v[222:223], v[2:3] op_sel:[0,1] op_sel_hi:[1,1]
v_mfma_f32_16x16x32_bf16 v[84:87], a[104:107], a[56:59], v[84:87]
s_add_u32 s36, s22, 3072
v_mfma_f32_16x16x32_bf16 v[84:87], a[100:103], a[52:55], v[84:87]
buffer_load_dwordx4 v[44:47], v21, s[4:7], s36 offen nt
v_mfma_f32_16x16x32_bf16 v[84:87], a[96:99], a[48:51], v[84:87]
v_max3_f32 v1, v80, v81, v82
v_cvt_pk_bf16_f32 v192, v192, v193
v_max_f32 v1, v1, v83
v_cvt_pk_bf16_f32 v193, v194, v195
v_mov_b32 v2, v1
v_mfma_f32_16x16x32_bf16 v[88:91], a[112:115], a[48:51], 0
ds_write_b64 v28, v[192:193] offset:12288
v_permlane16_swap_b32 v1, v2
v_mfma_f32_16x16x32_bf16 v[88:91], a[116:119], a[52:55], v[88:91]
v_max_f32 v1, v1, v2
s_or_b64 s[34:35], s[34:35], vcc
v_mov_b32 v2, v1
v_cvt_pk_bf16_f32 v196, v196, v197
v_mfma_f32_16x16x32_bf16 v[88:91], a[120:123], a[56:59], v[88:91]
v_permlane32_swap_b32 v1, v2
v_max_f32 v1, v1, v2
v_cvt_pk_bf16_f32 v197, v198, v199
v_mfma_f32_16x16x32_bf16 v[88:91], a[124:127], a[60:63], v[88:91]
v_sub_f32 v64, 0, v1
v_add_f32 v80, v80, v64
v_smfmac_f32_16x16x64_bf16 a[216:219], a[228:231], v[72:79], v0
ds_write_b64 v29, v[196:197] offset:12288
v_add_f32 v81, v81, v64
v_cvt_pk_bf16_f32 v200, v200, v201
v_add_f32 v82, v82, v64
v_cvt_pk_bf16_f32 v201, v202, v203
v_mfma_f32_16x16x32_bf16 v[160:163], a[148:151], v[76:79], 0
v_add_f32 v83, v83, v64
v_mov_b32 v65, v64
v_mfma_f32_16x16x32_bf16 v[160:163], a[144:147], v[72:75], v[160:163]
ds_write_b64 v30, v[200:201] offset:12288
v_exp_f32 v80, v80
v_cvt_pk_bf16_f32 v204, v204, v205
v_exp_f32 v81, v81
v_mfma_f32_16x16x32_bf16 v[164:167], a[152:155], v[72:75], 0
v_cvt_pk_bf16_f32 v205, v206, v207
v_exp_f32 v82, v82
v_mfma_f32_16x16x32_bf16 v[164:167], a[156:159], v[76:79], v[164:167]
v_exp_f32 v83, v83
v_add_f32 v84, v84, v64
v_mfma_f32_16x16x32_bf16 v[168:171], a[164:167], v[76:79], 0
ds_write_b64 v31, v[204:205] offset:12288
v_cvt_pk_bf16_f32 v208, v208, v209
v_add_f32 v85, v85, v64
v_add_f32 v86, v86, v64
v_cvt_pk_bf16_f32 v209, v210, v211
v_mfma_f32_16x16x32_bf16 v[168:171], a[160:163], v[72:75], v[168:171]
v_add_f32 v87, v87, v64
v_mov_b32 v66, v64
v_mfma_f32_16x16x32_bf16 v[172:175], a[168:171], v[72:75], 0
ds_write_b64 v92, v[208:209] offset:12288
v_exp_f32 v84, v84
v_cvt_pk_bf16_f32 v212, v212, v213
v_exp_f32 v85, v85
v_mfma_f32_16x16x32_bf16 v[172:175], a[172:175], v[76:79], v[172:175]
v_cvt_pk_bf16_f32 v213, v214, v215
v_exp_f32 v86, v86
v_mfma_f32_16x16x32_bf16 v[176:179], a[180:183], v[76:79], 0
ds_write_b64 v93, v[212:213] offset:12288
v_exp_f32 v87, v87
v_mfma_f32_16x16x32_bf16 v[176:179], a[176:179], v[72:75], v[176:179]
v_add_f32 v88, v88, v64
v_cvt_pk_bf16_f32 v216, v216, v217
v_add_f32 v89, v89, v64
v_cvt_pk_bf16_f32 v217, v218, v219
v_add_f32 v90, v90, v64
v_mfma_f32_16x16x32_bf16 v[180:183], a[184:187], v[72:75], 0
v_add_f32 v91, v91, v64
v_mfma_f32_16x16x32_bf16 v[180:183], a[188:191], v[76:79], v[180:183]
ds_write_b64 v94, v[216:217] offset:12288
v_mov_b32 v67, v64
v_cvt_pk_bf16_f32 v220, v220, v221
v_exp_f32 v88, v88
v_mfma_f32_16x16x32_bf16 v[184:187], a[196:199], v[76:79], 0
v_exp_f32 v89, v89
v_cvt_pk_bf16_f32 v221, v222, v223
v_exp_f32 v90, v90
v_mfma_f32_16x16x32_bf16 v[184:187], a[192:195], v[72:75], v[184:187]
s_waitcnt vmcnt(7) lgkmcnt(0)
ds_write_b64 v95, v[220:221] offset:12288
v_exp_f32 v91, v91
v_mfma_f32_16x16x32_bf16 v[188:191], a[200:203], v[72:75], 0
s_barrier
v_cvt_pk_bf16_f32 v72, v80, v81
v_cvt_pk_bf16_f32 v73, v82, v83
v_mfma_f32_16x16x32_bf16 v[188:191], a[204:207], v[76:79], v[188:191]
v_cvt_pk_bf16_f32 v74, v84, v85
v_cvt_pk_bf16_f32 v75, v86, v87
v_mfma_f32_16x16x32_bf16 v[80:83], a[80:83], a[64:67], 0
v_cvt_pk_bf16_f32 v76, v88, v89
v_cvt_pk_bf16_f32 v77, v90, v91
v_mfma_f32_16x16x32_bf16 v[80:83], a[84:87], a[68:71], v[80:83]
v_accvgpr_read_b32 v3, a224
v_accvgpr_read_b32 v2, a225
v_accvgpr_write_b32 a224, 0
v_add_f32 v3, v3, v2
v_accvgpr_write_b32 a225, 0
v_cmp_ngt_f32 vcc, s31, v3
v_rcp_f32 v3, v3
v_mfma_f32_16x16x32_bf16 v[80:83], a[88:91], a[72:75], v[80:83]
s_add_u32 m0, s21, 0
ds_read_b128 a[80:83], v4 offset:16384
ds_read_b128 a[84:87], v5 offset:16384
v_mfma_f32_16x16x32_bf16 v[80:83], a[92:95], a[76:79], v[80:83]
buffer_load_dwordx4 v16, s[8:11], s20 offen nt lds
v_mfma_f32_16x16x32_bf16 v[84:87], a[108:111], a[76:79], 0
ds_read_b128 a[88:91], v6 offset:16384
ds_read_b128 a[92:95], v7 offset:16384
v_mfma_f32_16x16x32_bf16 v[84:87], a[104:107], a[72:75], v[84:87]
v_pk_mul_f32 v[224:225], v[224:225], v[2:3] op_sel:[0,1] op_sel_hi:[1,1]
v_pk_mul_f32 v[226:227], v[226:227], v[2:3] op_sel:[0,1] op_sel_hi:[1,1]
v_pk_mul_f32 v[228:229], v[228:229], v[2:3] op_sel:[0,1] op_sel_hi:[1,1]
v_pk_mul_f32 v[230:231], v[230:231], v[2:3] op_sel:[0,1] op_sel_hi:[1,1]
v_pk_mul_f32 v[232:233], v[232:233], v[2:3] op_sel:[0,1] op_sel_hi:[1,1]
v_pk_mul_f32 v[234:235], v[234:235], v[2:3] op_sel:[0,1] op_sel_hi:[1,1]
v_pk_mul_f32 v[236:237], v[236:237], v[2:3] op_sel:[0,1] op_sel_hi:[1,1]
v_pk_mul_f32 v[238:239], v[238:239], v[2:3] op_sel:[0,1] op_sel_hi:[1,1]
v_pk_mul_f32 v[240:241], v[240:241], v[2:3] op_sel:[0,1] op_sel_hi:[1,1]
v_pk_mul_f32 v[242:243], v[242:243], v[2:3] op_sel:[0,1] op_sel_hi:[1,1]
v_pk_mul_f32 v[244:245], v[244:245], v[2:3] op_sel:[0,1] op_sel_hi:[1,1]
v_pk_mul_f32 v[246:247], v[246:247], v[2:3] op_sel:[0,1] op_sel_hi:[1,1]
v_pk_mul_f32 v[248:249], v[248:249], v[2:3] op_sel:[0,1] op_sel_hi:[1,1]
v_pk_mul_f32 v[250:251], v[250:251], v[2:3] op_sel:[0,1] op_sel_hi:[1,1]
v_pk_mul_f32 v[252:253], v[252:253], v[2:3] op_sel:[0,1] op_sel_hi:[1,1]
v_pk_mul_f32 v[254:255], v[254:255], v[2:3] op_sel:[0,1] op_sel_hi:[1,1]
v_mfma_f32_16x16x32_bf16 v[84:87], a[100:103], a[68:71], v[84:87]
ds_read_b128 a[108:111], v7 offset:20480
ds_read_b128 a[104:107], v6 offset:20480
v_mfma_f32_16x16x32_bf16 v[84:87], a[96:99], a[64:67], v[84:87]
v_max3_f32 v1, v80, v81, v82
v_cvt_pk_bf16_f32 v224, v224, v225
v_max_f32 v1, v1, v83
v_cvt_pk_bf16_f32 v225, v226, v227
v_mov_b32 v2, v1
v_mfma_f32_16x16x32_bf16 v[88:91], a[112:115], a[64:67], 0
ds_write_b64 v28, v[224:225] offset:16384
v_permlane16_swap_b32 v1, v2
s_or_b64 s[34:35], s[34:35], vcc
v_max_f32 v1, v1, v2
v_mov_b32 v2, v1
v_cvt_pk_bf16_f32 v228, v228, v229
v_mfma_f32_16x16x32_bf16 v[88:91], a[116:119], a[68:71], v[88:91]
s_add_u32 s36, s22, 4096
ds_read_b128 a[100:103], v5 offset:20480
ds_read_b128 a[96:99], v4 offset:20480
v_mfma_f32_16x16x32_bf16 v[88:91], a[120:123], a[72:75], v[88:91]
buffer_load_dwordx4 v[48:51], v18, s[4:7], s36 offen nt
v_mfma_f32_16x16x32_bf16 v[88:91], a[124:127], a[76:79], v[88:91]
v_permlane32_swap_b32 v1, v2
v_cvt_pk_bf16_f32 v229, v230, v231
v_max_f32 v1, v1, v2
v_smfmac_f32_16x16x64_bf16 a[220:223], a[228:231], v[72:79], v0
ds_write_b64 v29, v[228:229] offset:16384
v_sub_f32 v68, s25, v1
v_add_f32 v80, v80, v68
v_cvt_pk_bf16_f32 v232, v232, v233
v_add_f32 v81, v81, v68
v_cvt_pk_bf16_f32 v233, v234, v235
v_add_f32 v82, v82, v68
v_mfma_f32_16x16x32_bf16 v[192:195], a[148:151], v[76:79], 0
s_add_u32 m0, s21, 40960
ds_read_b128 a[112:115], v4 offset:24576
ds_read_b128 a[116:119], v5 offset:24576
v_mfma_f32_16x16x32_bf16 v[192:195], a[144:147], v[72:75], v[192:195]
buffer_load_dwordx4 v17, s[12:15], s20 offen nt lds
v_mfma_f32_16x16x32_bf16 v[196:199], a[152:155], v[72:75], 0
s_add_u32 s20, s20, 4096
ds_write_b64 v30, v[232:233] offset:16384
v_add_f32 v83, v83, v68
v_cvt_pk_bf16_f32 v236, v236, v237
v_mov_b32 v69, v68
v_exp_f32 v80, v80
v_mfma_f32_16x16x32_bf16 v[196:199], a[156:159], v[76:79], v[196:199]
v_cvt_pk_bf16_f32 v237, v238, v239
v_exp_f32 v81, v81
v_exp_f32 v82, v82
v_mfma_f32_16x16x32_bf16 v[200:203], a[164:167], v[76:79], 0
ds_read_b128 a[120:123], v6 offset:24576
ds_read_b128 a[124:127], v7 offset:24576
ds_write_b64 v31, v[236:237] offset:16384
v_cvt_pk_bf16_f32 v240, v240, v241
v_exp_f32 v83, v83
v_add_f32 v84, v84, v68
v_mfma_f32_16x16x32_bf16 v[200:203], a[160:163], v[72:75], v[200:203]
v_cvt_pk_bf16_f32 v241, v242, v243
v_add_f32 v85, v85, v68
v_add_f32 v86, v86, v68
v_cvt_pk_bf16_f32 v244, v244, v245
v_mfma_f32_16x16x32_bf16 v[204:207], a[168:171], v[72:75], 0
ds_write_b64 v92, v[240:241] offset:16384
v_add_f32 v87, v87, v68
v_cvt_pk_bf16_f32 v245, v246, v247
v_mov_b32 v70, v68
v_exp_f32 v84, v84
v_mfma_f32_16x16x32_bf16 v[204:207], a[172:175], v[76:79], v[204:207]
ds_read_b128 a[140:143], v7 offset:28672
ds_read_b128 a[136:139], v6 offset:28672
ds_write_b64 v93, v[244:245] offset:16384
v_exp_f32 v85, v85
v_cvt_pk_bf16_f32 v248, v248, v249
v_exp_f32 v86, v86
v_mfma_f32_16x16x32_bf16 v[208:211], a[180:183], v[76:79], 0
v_cvt_pk_bf16_f32 v249, v250, v251
v_exp_f32 v87, v87
v_add_f32 v88, v88, v68
v_mfma_f32_16x16x32_bf16 v[208:211], a[176:179], v[72:75], v[208:211]
ds_write_b64 v94, v[248:249] offset:16384
v_add_f32 v89, v89, v68
v_cvt_pk_bf16_f32 v252, v252, v253
v_add_f32 v90, v90, v68
v_cvt_pk_bf16_f32 v253, v254, v255
v_add_f32 v91, v91, v68
v_mfma_f32_16x16x32_bf16 v[212:215], a[184:187], v[72:75], 0
s_add_u32 m0, s21, 4096
ds_read_b128 a[132:135], v5 offset:28672
ds_read_b128 a[128:131], v4 offset:28672
v_mfma_f32_16x16x32_bf16 v[212:215], a[188:191], v[76:79], v[212:215]
buffer_load_dwordx4 v16, s[8:11], s20 offen nt lds
v_mfma_f32_16x16x32_bf16 v[216:219], a[196:199], v[76:79], 0
ds_write_b64 v95, v[252:253] offset:16384
v_mov_b32 v71, v68
v_exp_f32 v88, v88
s_cmp_lg_u64 s[34:35], 0
v_exp_f32 v89, v89
v_mfma_f32_16x16x32_bf16 v[216:219], a[192:195], v[72:75], v[216:219]
s_waitcnt lgkmcnt(0)
s_addc_u32 s28, s28, s28
v_exp_f32 v90, v90
s_mov_b64 s[34:35], 0
v_exp_f32 v91, v91
v_mfma_f32_16x16x32_bf16 v[220:223], a[200:203], v[72:75], 0
v_cvt_pk_bf16_f32 v72, v80, v81
v_cvt_pk_bf16_f32 v73, v82, v83
v_mfma_f32_16x16x32_bf16 v[220:223], a[204:207], v[76:79], v[220:223]
v_cvt_pk_bf16_f32 v74, v84, v85
v_cvt_pk_bf16_f32 v75, v86, v87
MAIN:
v_mfma_f32_16x16x32_bf16 v[80:83], a[80:83], a[0:3], v[52:55]
v_cvt_pk_bf16_f32 v76, v88, v89
v_cvt_pk_bf16_f32 v77, v90, v91
v_mfma_f32_16x16x32_bf16 v[80:83], a[84:87], a[4:7], v[80:83]
v_mfma_f32_16x16x32_bf16 v[80:83], a[88:91], a[8:11], v[80:83]
ds_read_b128 a[232:235], v22 offset:0
v_mfma_f32_16x16x32_bf16 v[80:83], a[92:95], a[12:15], v[80:83]
v_mfma_f32_16x16x32_bf16 v[84:87], a[108:111], a[12:15], v[52:55]
v_lshlrev_b32 v28, 16, v32
v_and_b32 v29, s30, v32
v_lshlrev_b32 v30, 16, v33
v_mfma_f32_16x16x32_bf16 v[84:87], a[104:107], a[8:11], v[84:87]
v_and_b32 v31, s30, v33
v_mul_f32 v28, s26, v28
v_mfma_f32_16x16x32_bf16 v[84:87], a[100:103], a[4:7], v[84:87]
v_mul_f32 v29, s26, v29
v_mul_f32 v30, s26, v30
v_mfma_f32_16x16x32_bf16 v[84:87], a[96:99], a[0:3], v[84:87]
v_exp_f32 v80, v80
v_mfma_f32_16x16x32_bf16 v[88:91], a[112:115], a[0:3], v[52:55]
v_exp_f32 v81, v81
v_mfma_f32_16x16x32_bf16 v[88:91], a[116:119], a[4:7], v[88:91]
v_exp_f32 v82, v82
v_mfma_f32_16x16x32_bf16 v[88:91], a[120:123], a[8:11], v[88:91]
v_exp_f32 v83, v83
v_mfma_f32_16x16x32_bf16 v[88:91], a[124:127], a[12:15], v[88:91]
v_exp_f32 v84, v84
v_mfma_f32_16x16x32_bf16 v[92:95], a[140:143], a[12:15], v[52:55]
v_exp_f32 v85, v85
v_mfma_f32_16x16x32_bf16 v[92:95], a[136:139], a[8:11], v[92:95]
v_exp_f32 v86, v86
v_mfma_f32_16x16x32_bf16 v[92:95], a[132:135], a[4:7], v[92:95]
v_exp_f32 v87, v87
v_mfma_f32_16x16x32_bf16 v[92:95], a[128:131], a[0:3], v[92:95]
v_exp_f32 v88, v88
v_smfmac_f32_16x16x64_bf16 a[224:227], a[228:231], v[72:79], v0
v_mul_f32 v31, s26, v31
v_mfma_f32_16x16x32_bf16 v[224:227], a[148:151], v[76:79], 0
v_exp_f32 v89, v89
v_mfma_f32_16x16x32_bf16 v[224:227], a[144:147], v[72:75], v[224:227]
s_add_u32 m0, s21, 45056
ds_read_b64_tr_b16 a[144:145], v8 offset:16384
ds_read_b64_tr_b16 a[146:147], v8 offset:20480
v_mfma_f32_16x16x32_bf16 v[228:231], a[152:155], v[72:75], 0
buffer_load_dwordx4 v17, s[12:15], s20 offen nt lds
v_mfma_f32_16x16x32_bf16 v[228:231], a[156:159], v[76:79], v[228:231]
s_add_u32 s20, s20, 4096
v_exp_f32 v90, v90
v_mfma_f32_16x16x32_bf16 v[232:235], a[164:167], v[76:79], 0
ds_read_b64_tr_b16 a[148:149], v8 offset:24576
ds_read_b64_tr_b16 a[150:151], v8 offset:28672
v_mfma_f32_16x16x32_bf16 v[232:235], a[160:163], v[72:75], v[232:235]
v_exp_f32 v91, v91
v_mfma_f32_16x16x32_bf16 v[236:239], a[168:171], v[72:75], 0
ds_read_b64_tr_b16 a[152:153], v9 offset:16384
ds_read_b64_tr_b16 a[154:155], v9 offset:20480
v_mfma_f32_16x16x32_bf16 v[236:239], a[172:175], v[76:79], v[236:239]
v_exp_f32 v92, v92
v_mfma_f32_16x16x32_bf16 v[240:243], a[180:183], v[76:79], 0
ds_read_b64_tr_b16 a[156:157], v9 offset:24576
ds_read_b64_tr_b16 a[158:159], v9 offset:28672
v_mfma_f32_16x16x32_bf16 v[240:243], a[176:179], v[72:75], v[240:243]
v_exp_f32 v93, v93
v_mfma_f32_16x16x32_bf16 v[244:247], a[184:187], v[72:75], 0
ds_read_b64_tr_b16 a[160:161], v10 offset:16384
ds_read_b64_tr_b16 a[162:163], v10 offset:20480
v_mfma_f32_16x16x32_bf16 v[244:247], a[188:191], v[76:79], v[244:247]
v_exp_f32 v94, v94
v_mfma_f32_16x16x32_bf16 v[248:251], a[196:199], v[76:79], 0
ds_read_b64_tr_b16 a[164:165], v10 offset:24576
ds_read_b64_tr_b16 a[166:167], v10 offset:28672
v_mfma_f32_16x16x32_bf16 v[248:251], a[192:195], v[72:75], v[248:251]
v_exp_f32 v95, v95
v_mfma_f32_16x16x32_bf16 v[252:255], a[200:203], v[72:75], 0
v_cvt_pk_bf16_f32 v72, v80, v81
v_cvt_pk_bf16_f32 v73, v82, v83
v_mfma_f32_16x16x32_bf16 v[252:255], a[204:207], v[76:79], v[252:255]
v_cvt_pk_bf16_f32 v74, v84, v85
v_cvt_pk_bf16_f32 v75, v86, v87
v_mfma_f32_16x16x32_bf16 v[80:83], a[80:83], a[16:19], v[56:59]
v_cvt_pk_bf16_f32 v76, v88, v89
v_cvt_pk_bf16_f32 v77, v90, v91
v_mfma_f32_16x16x32_bf16 v[80:83], a[84:87], a[20:23], v[80:83]
v_cvt_pk_bf16_f32 v78, v92, v93
v_cvt_pk_bf16_f32 v79, v94, v95
v_mfma_f32_16x16x32_bf16 v[80:83], a[88:91], a[24:27], v[80:83]
s_add_u32 m0, s21, 8192
ds_read_b64_tr_b16 a[168:169], v11 offset:16384
ds_read_b64_tr_b16 a[170:171], v11 offset:20480
v_mfma_f32_16x16x32_bf16 v[80:83], a[92:95], a[28:31], v[80:83]
buffer_load_dwordx4 v16, s[8:11], s20 offen nt lds
v_mfma_f32_16x16x32_bf16 v[84:87], a[108:111], a[28:31], v[56:59]
ds_read_b64_tr_b16 a[172:173], v11 offset:24576
ds_read_b64_tr_b16 a[174:175], v11 offset:28672
v_mfma_f32_16x16x32_bf16 v[84:87], a[104:107], a[24:27], v[84:87]
ds_read_b64_tr_b16 a[176:177], v12 offset:16384
ds_read_b64_tr_b16 a[178:179], v12 offset:20480
v_mfma_f32_16x16x32_bf16 v[84:87], a[100:103], a[20:23], v[84:87]
ds_read_b64_tr_b16 a[180:181], v12 offset:24576
ds_read_b64_tr_b16 a[182:183], v12 offset:28672
v_mfma_f32_16x16x32_bf16 v[84:87], a[96:99], a[16:19], v[84:87]
v_exp_f32 v80, v80
v_mfma_f32_16x16x32_bf16 v[88:91], a[112:115], a[16:19], v[56:59]
v_exp_f32 v81, v81
v_mfma_f32_16x16x32_bf16 v[88:91], a[116:119], a[20:23], v[88:91]
ds_read_b64_tr_b16 a[184:185], v13 offset:16384
ds_read_b64_tr_b16 a[186:187], v13 offset:20480
v_mfma_f32_16x16x32_bf16 v[88:91], a[120:123], a[24:27], v[88:91]
v_exp_f32 v82, v82
v_mfma_f32_16x16x32_bf16 v[88:91], a[124:127], a[28:31], v[88:91]
v_exp_f32 v83, v83
v_mfma_f32_16x16x32_bf16 v[92:95], a[140:143], a[28:31], v[56:59]
ds_read_b64_tr_b16 a[188:189], v13 offset:24576
ds_read_b64_tr_b16 a[190:191], v13 offset:28672
v_mfma_f32_16x16x32_bf16 v[92:95], a[136:139], a[24:27], v[92:95]
v_exp_f32 v84, v84
v_mfma_f32_16x16x32_bf16 v[92:95], a[132:135], a[20:23], v[92:95]
v_exp_f32 v85, v85
v_mfma_f32_16x16x32_bf16 v[92:95], a[128:131], a[16:19], v[92:95]
ds_read_b64_tr_b16 a[192:193], v14 offset:16384
ds_read_b64_tr_b16 a[194:195], v14 offset:20480
v_smfmac_f32_16x16x64_bf16 a[208:211], a[228:231], v[72:79], v0
s_waitcnt lgkmcnt(14)
v_cvt_pk_bf16_f32 v32, v28, v29
v_mfma_f32_16x16x32_bf16 v[96:99], a[148:151], v[76:79], v[96:99]
v_exp_f32 v86, v86
v_mfma_f32_16x16x32_bf16 v[96:99], a[144:147], v[72:75], v[96:99]
s_add_u32 m0, s21, 49152
ds_read_b64_tr_b16 a[196:197], v14 offset:24576
ds_read_b64_tr_b16 a[198:199], v14 offset:28672
v_mfma_f32_16x16x32_bf16 v[100:103], a[152:155], v[72:75], v[100:103]
buffer_load_dwordx4 v17, s[12:15], s20 offen nt lds
v_mfma_f32_16x16x32_bf16 v[100:103], a[156:159], v[76:79], v[100:103]
s_add_u32 s20, s20, 4096
ds_read_b64_tr_b16 a[200:201], v15 offset:16384
ds_read_b64_tr_b16 a[202:203], v15 offset:20480
v_mfma_f32_16x16x32_bf16 v[104:107], a[164:167], v[76:79], v[104:107]
v_exp_f32 v87, v87
v_mfma_f32_16x16x32_bf16 v[104:107], a[160:163], v[72:75], v[104:107]
s_waitcnt lgkmcnt(4)
v_exp_f32 v88, v88
v_mfma_f32_16x16x32_bf16 v[108:111], a[168:171], v[72:75], v[108:111]
ds_read_b64_tr_b16 a[204:205], v15 offset:24576
ds_read_b64_tr_b16 a[206:207], v15 offset:28672
v_mfma_f32_16x16x32_bf16 v[108:111], a[172:175], v[76:79], v[108:111]
v_exp_f32 v89, v89
v_mfma_f32_16x16x32_bf16 v[112:115], a[180:183], v[76:79], v[112:115]
v_exp_f32 v90, v90
v_mfma_f32_16x16x32_bf16 v[112:115], a[176:179], v[72:75], v[112:115]
v_exp_f32 v91, v91
v_mfma_f32_16x16x32_bf16 v[116:119], a[184:187], v[72:75], v[116:119]
v_exp_f32 v92, v92
v_mfma_f32_16x16x32_bf16 v[116:119], a[188:191], v[76:79], v[116:119]
s_waitcnt lgkmcnt(0)
v_exp_f32 v93, v93
v_mfma_f32_16x16x32_bf16 v[120:123], a[196:199], v[76:79], v[120:123]
v_exp_f32 v94, v94
v_mfma_f32_16x16x32_bf16 v[120:123], a[192:195], v[72:75], v[120:123]
v_exp_f32 v95, v95
v_mfma_f32_16x16x32_bf16 v[124:127], a[200:203], v[72:75], v[124:127]
v_cvt_pk_bf16_f32 v72, v80, v81
v_cvt_pk_bf16_f32 v73, v82, v83
v_mfma_f32_16x16x32_bf16 v[124:127], a[204:207], v[76:79], v[124:127]
v_cvt_pk_bf16_f32 v74, v84, v85
v_cvt_pk_bf16_f32 v75, v86, v87
v_mfma_f32_16x16x32_bf16 v[80:83], a[80:83], a[32:35], v[60:63]
v_cvt_pk_bf16_f32 v76, v88, v89
v_cvt_pk_bf16_f32 v77, v90, v91
v_mfma_f32_16x16x32_bf16 v[80:83], a[84:87], a[36:39], v[80:83]
v_cvt_pk_bf16_f32 v78, v92, v93
v_cvt_pk_bf16_f32 v79, v94, v95
v_mfma_f32_16x16x32_bf16 v[80:83], a[88:91], a[40:43], v[80:83]
s_add_u32 m0, s21, 12288
v_cvt_pk_bf16_f32 v33, v30, v31
v_lshlrev_b32 v28, 16, v34
v_mfma_f32_16x16x32_bf16 v[80:83], a[92:95], a[44:47], v[80:83]
buffer_load_dwordx4 v16, s[8:11], s20 offen nt lds
v_mfma_f32_16x16x32_bf16 v[84:87], a[108:111], a[44:47], v[60:63]
v_and_b32 v29, s30, v34
v_lshlrev_b32 v30, 16, v35
v_mfma_f32_16x16x32_bf16 v[84:87], a[104:107], a[40:43], v[84:87]
v_and_b32 v31, s30, v35
v_mul_f32 v28, s26, v28
v_mfma_f32_16x16x32_bf16 v[84:87], a[100:103], a[36:39], v[84:87]
s_add_u32 s29, s23, 0
ds_read_b128 a[236:239], v22 offset:1024
v_mfma_f32_16x16x32_bf16 v[84:87], a[96:99], a[32:35], v[84:87]
buffer_store_dwordx4 a[232:235], v18, s[16:19], s29 offen nt
v_mfma_f32_16x16x32_bf16 v[88:91], a[112:115], a[32:35], v[60:63]
v_mul_f32 v29, s26, v29
v_mul_f32 v30, s26, v30
v_mfma_f32_16x16x32_bf16 v[88:91], a[116:119], a[36:39], v[88:91]
v_mul_f32 v31, s26, v31
v_cvt_pk_bf16_f32 v34, v28, v29
v_mfma_f32_16x16x32_bf16 v[88:91], a[120:123], a[40:43], v[88:91]
v_cvt_pk_bf16_f32 v35, v30, v31
v_mfma_f32_16x16x32_bf16 v[88:91], a[124:127], a[44:47], v[88:91]
s_add_u32 s36, s22, 5120
ds_write_b128 v22, v[32:35] offset:0
v_mfma_f32_16x16x32_bf16 v[92:95], a[140:143], a[44:47], v[60:63]
buffer_load_dwordx4 v[32:35], v19, s[4:7], s36 offen nt
v_mfma_f32_16x16x32_bf16 v[92:95], a[136:139], a[40:43], v[92:95]
s_waitcnt vmcnt(15)
v_lshlrev_b32 v28, 16, v36
v_and_b32 v29, s30, v36
v_lshlrev_b32 v30, 16, v37
v_mfma_f32_16x16x32_bf16 v[92:95], a[132:135], a[36:39], v[92:95]
v_exp_f32 v80, v80
v_mfma_f32_16x16x32_bf16 v[92:95], a[128:131], a[32:35], v[92:95]
v_exp_f32 v81, v81
v_smfmac_f32_16x16x64_bf16 a[212:215], a[228:231], v[72:79], v0
v_and_b32 v31, s30, v37
v_mfma_f32_16x16x32_bf16 v[128:131], a[148:151], v[76:79], v[128:131]
v_exp_f32 v82, v82
v_mfma_f32_16x16x32_bf16 v[128:131], a[144:147], v[72:75], v[128:131]
v_exp_f32 v83, v83
v_mfma_f32_16x16x32_bf16 v[132:135], a[152:155], v[72:75], v[132:135]
v_exp_f32 v84, v84
v_mfma_f32_16x16x32_bf16 v[132:135], a[156:159], v[76:79], v[132:135]
v_exp_f32 v85, v85
v_mfma_f32_16x16x32_bf16 v[136:139], a[164:167], v[76:79], v[136:139]
v_exp_f32 v86, v86
v_mfma_f32_16x16x32_bf16 v[136:139], a[160:163], v[72:75], v[136:139]
v_exp_f32 v87, v87
v_mfma_f32_16x16x32_bf16 v[140:143], a[168:171], v[72:75], v[140:143]
v_exp_f32 v88, v88
v_mfma_f32_16x16x32_bf16 v[140:143], a[172:175], v[76:79], v[140:143]
v_exp_f32 v89, v89
v_mfma_f32_16x16x32_bf16 v[144:147], a[180:183], v[76:79], v[144:147]
v_exp_f32 v90, v90
v_mfma_f32_16x16x32_bf16 v[144:147], a[176:179], v[72:75], v[144:147]
v_exp_f32 v91, v91
v_mfma_f32_16x16x32_bf16 v[148:151], a[184:187], v[72:75], v[148:151]
v_exp_f32 v92, v92
v_mfma_f32_16x16x32_bf16 v[148:151], a[188:191], v[76:79], v[148:151]
v_exp_f32 v93, v93
v_mfma_f32_16x16x32_bf16 v[152:155], a[196:199], v[76:79], v[152:155]
v_exp_f32 v94, v94
v_mfma_f32_16x16x32_bf16 v[152:155], a[192:195], v[72:75], v[152:155]
v_exp_f32 v95, v95
v_mfma_f32_16x16x32_bf16 v[156:159], a[200:203], v[72:75], v[156:159]
v_cvt_pk_bf16_f32 v72, v80, v81
v_cvt_pk_bf16_f32 v73, v82, v83
v_mfma_f32_16x16x32_bf16 v[156:159], a[204:207], v[76:79], v[156:159]
v_cvt_pk_bf16_f32 v74, v84, v85
v_cvt_pk_bf16_f32 v75, v86, v87
v_mfma_f32_16x16x32_bf16 v[80:83], a[80:83], a[48:51], v[64:67]
v_cvt_pk_bf16_f32 v76, v88, v89
v_cvt_pk_bf16_f32 v77, v90, v91
v_mfma_f32_16x16x32_bf16 v[80:83], a[84:87], a[52:55], v[80:83]
v_cvt_pk_bf16_f32 v78, v92, v93
v_cvt_pk_bf16_f32 v79, v94, v95
v_mfma_f32_16x16x32_bf16 v[80:83], a[88:91], a[56:59], v[80:83]
s_add_u32 m0, s21, 53248
v_mul_f32 v28, s26, v28
v_mul_f32 v29, s26, v29
v_mfma_f32_16x16x32_bf16 v[80:83], a[92:95], a[60:63], v[80:83]
buffer_load_dwordx4 v17, s[12:15], s20 offen nt lds
v_mfma_f32_16x16x32_bf16 v[84:87], a[108:111], a[60:63], v[64:67]
s_add_u32 s20, s20, 4096
v_mul_f32 v30, s26, v30
v_mul_f32 v31, s26, v31
v_mfma_f32_16x16x32_bf16 v[84:87], a[104:107], a[56:59], v[84:87]
s_waitcnt lgkmcnt(1)
v_cvt_pk_bf16_f32 v36, v28, v29
v_cvt_pk_bf16_f32 v37, v30, v31
v_mfma_f32_16x16x32_bf16 v[84:87], a[100:103], a[52:55], v[84:87]
s_add_u32 s29, s23, 1024
ds_read_b128 a[232:235], v22 offset:2048
v_mfma_f32_16x16x32_bf16 v[84:87], a[96:99], a[48:51], v[84:87]
buffer_store_dwordx4 a[236:239], v19, s[16:19], s29 offen nt
v_mfma_f32_16x16x32_bf16 v[88:91], a[112:115], a[48:51], v[64:67]
v_lshlrev_b32 v28, 16, v38
v_and_b32 v29, s30, v38
v_mfma_f32_16x16x32_bf16 v[88:91], a[116:119], a[52:55], v[88:91]
v_lshlrev_b32 v30, 16, v39
v_and_b32 v31, s30, v39
v_mfma_f32_16x16x32_bf16 v[88:91], a[120:123], a[56:59], v[88:91]
v_mul_f32 v28, s26, v28
v_mul_f32 v29, s26, v29
v_mfma_f32_16x16x32_bf16 v[88:91], a[124:127], a[60:63], v[88:91]
v_mul_f32 v30, s26, v30
v_mul_f32 v31, s26, v31
v_mfma_f32_16x16x32_bf16 v[92:95], a[140:143], a[60:63], v[64:67]
v_cvt_pk_bf16_f32 v38, v28, v29
v_cvt_pk_bf16_f32 v39, v30, v31
v_mfma_f32_16x16x32_bf16 v[92:95], a[136:139], a[56:59], v[92:95]
ds_write_b128 v22, v[36:39] offset:1024
v_mfma_f32_16x16x32_bf16 v[92:95], a[132:135], a[52:55], v[92:95]
v_exp_f32 v80, v80
v_mfma_f32_16x16x32_bf16 v[92:95], a[128:131], a[48:51], v[92:95]
s_add_u32 s36, s22, 6144
v_exp_f32 v81, v81
v_smfmac_f32_16x16x64_bf16 a[216:219], a[228:231], v[72:79], v0
buffer_load_dwordx4 v[36:39], v20, s[4:7], s36 offen nt
v_mfma_f32_16x16x32_bf16 v[160:163], a[148:151], v[76:79], v[160:163]
v_exp_f32 v82, v82
v_mfma_f32_16x16x32_bf16 v[160:163], a[144:147], v[72:75], v[160:163]
v_exp_f32 v83, v83
v_mfma_f32_16x16x32_bf16 v[164:167], a[152:155], v[72:75], v[164:167]
v_exp_f32 v84, v84
v_mfma_f32_16x16x32_bf16 v[164:167], a[156:159], v[76:79], v[164:167]
v_exp_f32 v85, v85
v_mfma_f32_16x16x32_bf16 v[168:171], a[164:167], v[76:79], v[168:171]
v_exp_f32 v86, v86
v_mfma_f32_16x16x32_bf16 v[168:171], a[160:163], v[72:75], v[168:171]
v_exp_f32 v87, v87
v_mfma_f32_16x16x32_bf16 v[172:175], a[168:171], v[72:75], v[172:175]
v_exp_f32 v88, v88
v_mfma_f32_16x16x32_bf16 v[172:175], a[172:175], v[76:79], v[172:175]
v_exp_f32 v89, v89
v_mfma_f32_16x16x32_bf16 v[176:179], a[180:183], v[76:79], v[176:179]
v_exp_f32 v90, v90
v_mfma_f32_16x16x32_bf16 v[176:179], a[176:179], v[72:75], v[176:179]
v_exp_f32 v91, v91
v_mfma_f32_16x16x32_bf16 v[180:183], a[184:187], v[72:75], v[180:183]
v_exp_f32 v92, v92
v_mfma_f32_16x16x32_bf16 v[180:183], a[188:191], v[76:79], v[180:183]
v_exp_f32 v93, v93
v_mfma_f32_16x16x32_bf16 v[184:187], a[196:199], v[76:79], v[184:187]
v_exp_f32 v94, v94
v_mfma_f32_16x16x32_bf16 v[184:187], a[192:195], v[72:75], v[184:187]
s_waitcnt vmcnt(8) lgkmcnt(0)
v_exp_f32 v95, v95
v_mfma_f32_16x16x32_bf16 v[188:191], a[200:203], v[72:75], v[188:191]
s_barrier
v_cvt_pk_bf16_f32 v72, v80, v81
v_cvt_pk_bf16_f32 v73, v82, v83
v_mfma_f32_16x16x32_bf16 v[188:191], a[204:207], v[76:79], v[188:191]
v_cvt_pk_bf16_f32 v74, v84, v85
v_cvt_pk_bf16_f32 v75, v86, v87
v_mfma_f32_16x16x32_bf16 v[80:83], a[80:83], a[64:67], v[68:71]
v_cvt_pk_bf16_f32 v76, v88, v89
v_cvt_pk_bf16_f32 v77, v90, v91
v_mfma_f32_16x16x32_bf16 v[80:83], a[84:87], a[68:71], v[80:83]
v_cvt_pk_bf16_f32 v78, v92, v93
v_cvt_pk_bf16_f32 v79, v94, v95
v_mfma_f32_16x16x32_bf16 v[80:83], a[88:91], a[72:75], v[80:83]
s_add_u32 m0, s21, 16384
ds_read_b128 a[80:83], v4 offset:32768
ds_read_b128 a[84:87], v5 offset:32768
v_mfma_f32_16x16x32_bf16 v[80:83], a[92:95], a[76:79], v[80:83]
buffer_load_dwordx4 v16, s[8:11], s20 offen nt lds
v_mfma_f32_16x16x32_bf16 v[84:87], a[108:111], a[76:79], v[68:71]
ds_read_b128 a[88:91], v6 offset:32768
ds_read_b128 a[92:95], v7 offset:32768
v_mfma_f32_16x16x32_bf16 v[84:87], a[104:107], a[72:75], v[84:87]
v_lshlrev_b32 v28, 16, v40
v_and_b32 v29, s30, v40
v_lshlrev_b32 v30, 16, v41
v_mfma_f32_16x16x32_bf16 v[84:87], a[100:103], a[68:71], v[84:87]
ds_read_b128 a[108:111], v7 offset:36864
ds_read_b128 a[104:107], v6 offset:36864
v_mfma_f32_16x16x32_bf16 v[84:87], a[96:99], a[64:67], v[84:87]
v_exp_f32 v80, v80
v_mfma_f32_16x16x32_bf16 v[88:91], a[112:115], a[64:67], v[68:71]
v_exp_f32 v81, v81
v_mfma_f32_16x16x32_bf16 v[88:91], a[116:119], a[68:71], v[88:91]
ds_read_b128 a[100:103], v5 offset:36864
ds_read_b128 a[96:99], v4 offset:36864
v_mfma_f32_16x16x32_bf16 v[88:91], a[120:123], a[72:75], v[88:91]
v_exp_f32 v82, v82
v_mfma_f32_16x16x32_bf16 v[88:91], a[124:127], a[76:79], v[88:91]
v_exp_f32 v83, v83
v_mfma_f32_16x16x32_bf16 v[92:95], a[140:143], a[76:79], v[68:71]
v_exp_f32 v84, v84
v_mfma_f32_16x16x32_bf16 v[92:95], a[136:139], a[72:75], v[92:95]
s_add_u32 m0, s21, 57344
ds_read_b128 a[112:115], v4 offset:0
ds_read_b128 a[116:119], v5 offset:0
v_mfma_f32_16x16x32_bf16 v[92:95], a[132:135], a[68:71], v[92:95]
buffer_load_dwordx4 v17, s[12:15], s20 offen nt lds
v_mfma_f32_16x16x32_bf16 v[92:95], a[128:131], a[64:67], v[92:95]
s_add_u32 s20, s20, 4096
v_exp_f32 v85, v85
v_smfmac_f32_16x16x64_bf16 a[220:223], a[228:231], v[72:79], v0
v_and_b32 v31, s30, v41
v_mfma_f32_16x16x32_bf16 v[192:195], a[148:151], v[76:79], v[192:195]
ds_read_b128 a[120:123], v6 offset:0
ds_read_b128 a[124:127], v7 offset:0
v_mfma_f32_16x16x32_bf16 v[192:195], a[144:147], v[72:75], v[192:195]
v_exp_f32 v86, v86
v_mfma_f32_16x16x32_bf16 v[196:199], a[152:155], v[72:75], v[196:199]
v_exp_f32 v87, v87
v_mfma_f32_16x16x32_bf16 v[196:199], a[156:159], v[76:79], v[196:199]
ds_read_b128 a[140:143], v7 offset:4096
ds_read_b128 a[136:139], v6 offset:4096
v_mfma_f32_16x16x32_bf16 v[200:203], a[164:167], v[76:79], v[200:203]
v_exp_f32 v88, v88
v_mfma_f32_16x16x32_bf16 v[200:203], a[160:163], v[72:75], v[200:203]
v_exp_f32 v89, v89
v_mfma_f32_16x16x32_bf16 v[204:207], a[168:171], v[72:75], v[204:207]
s_add_u32 m0, s21, 20480
ds_read_b128 a[132:135], v5 offset:4096
ds_read_b128 a[128:131], v4 offset:4096
v_mfma_f32_16x16x32_bf16 v[204:207], a[172:175], v[76:79], v[204:207]
buffer_load_dwordx4 v16, s[8:11], s20 offen nt lds
v_mfma_f32_16x16x32_bf16 v[208:211], a[180:183], v[76:79], v[208:211]
v_exp_f32 v90, v90
v_mfma_f32_16x16x32_bf16 v[208:211], a[176:179], v[72:75], v[208:211]
v_exp_f32 v91, v91
v_mfma_f32_16x16x32_bf16 v[212:215], a[184:187], v[72:75], v[212:215]
v_exp_f32 v92, v92
v_mfma_f32_16x16x32_bf16 v[212:215], a[188:191], v[76:79], v[212:215]
v_exp_f32 v93, v93
v_mfma_f32_16x16x32_bf16 v[216:219], a[196:199], v[76:79], v[216:219]
v_exp_f32 v94, v94
v_mfma_f32_16x16x32_bf16 v[216:219], a[192:195], v[72:75], v[216:219]
s_waitcnt lgkmcnt(0)
v_exp_f32 v95, v95
v_mfma_f32_16x16x32_bf16 v[220:223], a[200:203], v[72:75], v[220:223]
v_cvt_pk_bf16_f32 v72, v80, v81
v_cvt_pk_bf16_f32 v73, v82, v83
v_mfma_f32_16x16x32_bf16 v[220:223], a[204:207], v[76:79], v[220:223]
v_cvt_pk_bf16_f32 v74, v84, v85
v_cvt_pk_bf16_f32 v75, v86, v87
v_mfma_f32_16x16x32_bf16 v[80:83], a[80:83], a[0:3], v[52:55]
v_cvt_pk_bf16_f32 v76, v88, v89
v_cvt_pk_bf16_f32 v77, v90, v91
v_mfma_f32_16x16x32_bf16 v[80:83], a[84:87], a[4:7], v[80:83]
v_cvt_pk_bf16_f32 v78, v92, v93
v_cvt_pk_bf16_f32 v79, v94, v95
v_mfma_f32_16x16x32_bf16 v[80:83], a[88:91], a[8:11], v[80:83]
s_add_u32 s29, s23, 2048
ds_read_b128 a[236:239], v22 offset:3072
v_mfma_f32_16x16x32_bf16 v[80:83], a[92:95], a[12:15], v[80:83]
buffer_store_dwordx4 a[232:235], v20, s[16:19], s29 offen nt
v_mfma_f32_16x16x32_bf16 v[84:87], a[108:111], a[12:15], v[52:55]
v_mul_f32 v28, s26, v28
v_mul_f32 v29, s26, v29
v_mfma_f32_16x16x32_bf16 v[84:87], a[104:107], a[8:11], v[84:87]
v_mul_f32 v30, s26, v30
v_mul_f32 v31, s26, v31
v_mfma_f32_16x16x32_bf16 v[84:87], a[100:103], a[4:7], v[84:87]
v_cvt_pk_bf16_f32 v40, v28, v29
v_cvt_pk_bf16_f32 v41, v30, v31
v_mfma_f32_16x16x32_bf16 v[84:87], a[96:99], a[0:3], v[84:87]
v_exp_f32 v80, v80
v_mfma_f32_16x16x32_bf16 v[88:91], a[112:115], a[0:3], v[52:55]
v_exp_f32 v81, v81
v_mfma_f32_16x16x32_bf16 v[88:91], a[116:119], a[4:7], v[88:91]
v_exp_f32 v82, v82
v_mfma_f32_16x16x32_bf16 v[88:91], a[120:123], a[8:11], v[88:91]
v_exp_f32 v83, v83
v_mfma_f32_16x16x32_bf16 v[88:91], a[124:127], a[12:15], v[88:91]
v_exp_f32 v84, v84
v_mfma_f32_16x16x32_bf16 v[92:95], a[140:143], a[12:15], v[52:55]
v_exp_f32 v85, v85
v_mfma_f32_16x16x32_bf16 v[92:95], a[136:139], a[8:11], v[92:95]
v_exp_f32 v86, v86
v_mfma_f32_16x16x32_bf16 v[92:95], a[132:135], a[4:7], v[92:95]
v_exp_f32 v87, v87
v_mfma_f32_16x16x32_bf16 v[92:95], a[128:131], a[0:3], v[92:95]
v_exp_f32 v88, v88
v_smfmac_f32_16x16x64_bf16 a[224:227], a[228:231], v[72:79], v0
v_lshlrev_b32 v28, 16, v42
v_mfma_f32_16x16x32_bf16 v[224:227], a[148:151], v[76:79], v[224:227]
v_exp_f32 v89, v89
v_mfma_f32_16x16x32_bf16 v[224:227], a[144:147], v[72:75], v[224:227]
s_add_u32 m0, s21, 61440
ds_read_b64_tr_b16 a[144:145], v8 offset:32768
ds_read_b64_tr_b16 a[146:147], v8 offset:36864
v_mfma_f32_16x16x32_bf16 v[228:231], a[152:155], v[72:75], v[228:231]
buffer_load_dwordx4 v17, s[12:15], s20 offen nt lds
v_mfma_f32_16x16x32_bf16 v[228:231], a[156:159], v[76:79], v[228:231]
s_add_u32 s20, s20, 4096
v_exp_f32 v90, v90
v_mfma_f32_16x16x32_bf16 v[232:235], a[164:167], v[76:79], v[232:235]
ds_read_b64_tr_b16 a[148:149], v8 offset:0
ds_read_b64_tr_b16 a[150:151], v8 offset:4096
v_mfma_f32_16x16x32_bf16 v[232:235], a[160:163], v[72:75], v[232:235]
v_exp_f32 v91, v91
v_mfma_f32_16x16x32_bf16 v[236:239], a[168:171], v[72:75], v[236:239]
ds_read_b64_tr_b16 a[152:153], v9 offset:32768
ds_read_b64_tr_b16 a[154:155], v9 offset:36864
v_mfma_f32_16x16x32_bf16 v[236:239], a[172:175], v[76:79], v[236:239]
v_exp_f32 v92, v92
v_mfma_f32_16x16x32_bf16 v[240:243], a[180:183], v[76:79], v[240:243]
ds_read_b64_tr_b16 a[156:157], v9 offset:0
ds_read_b64_tr_b16 a[158:159], v9 offset:4096
v_mfma_f32_16x16x32_bf16 v[240:243], a[176:179], v[72:75], v[240:243]
v_exp_f32 v93, v93
v_mfma_f32_16x16x32_bf16 v[244:247], a[184:187], v[72:75], v[244:247]
ds_read_b64_tr_b16 a[160:161], v10 offset:32768
ds_read_b64_tr_b16 a[162:163], v10 offset:36864
v_mfma_f32_16x16x32_bf16 v[244:247], a[188:191], v[76:79], v[244:247]
v_exp_f32 v94, v94
v_mfma_f32_16x16x32_bf16 v[248:251], a[196:199], v[76:79], v[248:251]
ds_read_b64_tr_b16 a[164:165], v10 offset:0
ds_read_b64_tr_b16 a[166:167], v10 offset:4096
v_mfma_f32_16x16x32_bf16 v[248:251], a[192:195], v[72:75], v[248:251]
v_exp_f32 v95, v95
v_mfma_f32_16x16x32_bf16 v[252:255], a[200:203], v[72:75], v[252:255]
v_cvt_pk_bf16_f32 v72, v80, v81
v_cvt_pk_bf16_f32 v73, v82, v83
v_mfma_f32_16x16x32_bf16 v[252:255], a[204:207], v[76:79], v[252:255]
v_cvt_pk_bf16_f32 v74, v84, v85
v_cvt_pk_bf16_f32 v75, v86, v87
v_mfma_f32_16x16x32_bf16 v[80:83], a[80:83], a[16:19], v[56:59]
v_cvt_pk_bf16_f32 v76, v88, v89
v_cvt_pk_bf16_f32 v77, v90, v91
v_mfma_f32_16x16x32_bf16 v[80:83], a[84:87], a[20:23], v[80:83]
v_cvt_pk_bf16_f32 v78, v92, v93
v_cvt_pk_bf16_f32 v79, v94, v95
v_mfma_f32_16x16x32_bf16 v[80:83], a[88:91], a[24:27], v[80:83]
s_add_u32 m0, s21, 24576
ds_read_b64_tr_b16 a[168:169], v11 offset:32768
ds_read_b64_tr_b16 a[170:171], v11 offset:36864
v_mfma_f32_16x16x32_bf16 v[80:83], a[92:95], a[28:31], v[80:83]
buffer_load_dwordx4 v16, s[8:11], s20 offen nt lds
v_mfma_f32_16x16x32_bf16 v[84:87], a[108:111], a[28:31], v[56:59]
ds_read_b64_tr_b16 a[172:173], v11 offset:0
ds_read_b64_tr_b16 a[174:175], v11 offset:4096
v_mfma_f32_16x16x32_bf16 v[84:87], a[104:107], a[24:27], v[84:87]
ds_read_b64_tr_b16 a[176:177], v12 offset:32768
ds_read_b64_tr_b16 a[178:179], v12 offset:36864
v_mfma_f32_16x16x32_bf16 v[84:87], a[100:103], a[20:23], v[84:87]
ds_read_b64_tr_b16 a[180:181], v12 offset:0
ds_read_b64_tr_b16 a[182:183], v12 offset:4096
v_mfma_f32_16x16x32_bf16 v[84:87], a[96:99], a[16:19], v[84:87]
v_exp_f32 v80, v80
v_mfma_f32_16x16x32_bf16 v[88:91], a[112:115], a[16:19], v[56:59]
v_exp_f32 v81, v81
v_mfma_f32_16x16x32_bf16 v[88:91], a[116:119], a[20:23], v[88:91]
ds_read_b64_tr_b16 a[184:185], v13 offset:32768
ds_read_b64_tr_b16 a[186:187], v13 offset:36864
v_mfma_f32_16x16x32_bf16 v[88:91], a[120:123], a[24:27], v[88:91]
v_exp_f32 v82, v82
v_mfma_f32_16x16x32_bf16 v[88:91], a[124:127], a[28:31], v[88:91]
v_exp_f32 v83, v83
v_mfma_f32_16x16x32_bf16 v[92:95], a[140:143], a[28:31], v[56:59]
ds_read_b64_tr_b16 a[188:189], v13 offset:0
ds_read_b64_tr_b16 a[190:191], v13 offset:4096
v_mfma_f32_16x16x32_bf16 v[92:95], a[136:139], a[24:27], v[92:95]
v_exp_f32 v84, v84
v_mfma_f32_16x16x32_bf16 v[92:95], a[132:135], a[20:23], v[92:95]
v_exp_f32 v85, v85
v_mfma_f32_16x16x32_bf16 v[92:95], a[128:131], a[16:19], v[92:95]
ds_read_b64_tr_b16 a[192:193], v14 offset:32768
ds_read_b64_tr_b16 a[194:195], v14 offset:36864
v_smfmac_f32_16x16x64_bf16 a[208:211], a[228:231], v[72:79], v0
s_waitcnt lgkmcnt(14)
v_and_b32 v29, s30, v42
v_mfma_f32_16x16x32_bf16 v[96:99], a[148:151], v[76:79], v[96:99]
v_exp_f32 v86, v86
v_mfma_f32_16x16x32_bf16 v[96:99], a[144:147], v[72:75], v[96:99]
s_add_u32 m0, s21, 65536
ds_read_b64_tr_b16 a[196:197], v14 offset:0
ds_read_b64_tr_b16 a[198:199], v14 offset:4096
v_mfma_f32_16x16x32_bf16 v[100:103], a[152:155], v[72:75], v[100:103]
buffer_load_dwordx4 v17, s[12:15], s20 offen nt lds
v_mfma_f32_16x16x32_bf16 v[100:103], a[156:159], v[76:79], v[100:103]
s_add_u32 s20, s20, 4096
ds_read_b64_tr_b16 a[200:201], v15 offset:32768
ds_read_b64_tr_b16 a[202:203], v15 offset:36864
v_mfma_f32_16x16x32_bf16 v[104:107], a[164:167], v[76:79], v[104:107]
v_exp_f32 v87, v87
v_mfma_f32_16x16x32_bf16 v[104:107], a[160:163], v[72:75], v[104:107]
s_waitcnt lgkmcnt(4)
v_exp_f32 v88, v88
v_mfma_f32_16x16x32_bf16 v[108:111], a[168:171], v[72:75], v[108:111]
ds_read_b64_tr_b16 a[204:205], v15 offset:0
ds_read_b64_tr_b16 a[206:207], v15 offset:4096
v_mfma_f32_16x16x32_bf16 v[108:111], a[172:175], v[76:79], v[108:111]
v_exp_f32 v89, v89
v_mfma_f32_16x16x32_bf16 v[112:115], a[180:183], v[76:79], v[112:115]
v_exp_f32 v90, v90
v_mfma_f32_16x16x32_bf16 v[112:115], a[176:179], v[72:75], v[112:115]
v_exp_f32 v91, v91
v_mfma_f32_16x16x32_bf16 v[116:119], a[184:187], v[72:75], v[116:119]
v_exp_f32 v92, v92
v_mfma_f32_16x16x32_bf16 v[116:119], a[188:191], v[76:79], v[116:119]
s_waitcnt lgkmcnt(0)
v_exp_f32 v93, v93
v_mfma_f32_16x16x32_bf16 v[120:123], a[196:199], v[76:79], v[120:123]
v_exp_f32 v94, v94
v_mfma_f32_16x16x32_bf16 v[120:123], a[192:195], v[72:75], v[120:123]
v_exp_f32 v95, v95
v_mfma_f32_16x16x32_bf16 v[124:127], a[200:203], v[72:75], v[124:127]
v_cvt_pk_bf16_f32 v72, v80, v81
v_cvt_pk_bf16_f32 v73, v82, v83
v_mfma_f32_16x16x32_bf16 v[124:127], a[204:207], v[76:79], v[124:127]
v_cvt_pk_bf16_f32 v74, v84, v85
v_cvt_pk_bf16_f32 v75, v86, v87
v_mfma_f32_16x16x32_bf16 v[80:83], a[80:83], a[32:35], v[60:63]
v_cvt_pk_bf16_f32 v76, v88, v89
v_cvt_pk_bf16_f32 v77, v90, v91
v_mfma_f32_16x16x32_bf16 v[80:83], a[84:87], a[36:39], v[80:83]
v_cvt_pk_bf16_f32 v78, v92, v93
v_cvt_pk_bf16_f32 v79, v94, v95
v_mfma_f32_16x16x32_bf16 v[80:83], a[88:91], a[40:43], v[80:83]
s_add_u32 m0, s21, 28672
v_lshlrev_b32 v30, 16, v43
v_and_b32 v31, s30, v43
v_mfma_f32_16x16x32_bf16 v[80:83], a[92:95], a[44:47], v[80:83]
buffer_load_dwordx4 v16, s[8:11], s20 offen nt lds
v_mfma_f32_16x16x32_bf16 v[84:87], a[108:111], a[44:47], v[60:63]
v_mul_f32 v28, s26, v28
v_mul_f32 v29, s26, v29
v_mfma_f32_16x16x32_bf16 v[84:87], a[104:107], a[40:43], v[84:87]
v_mul_f32 v30, s26, v30
v_mul_f32 v31, s26, v31
v_mfma_f32_16x16x32_bf16 v[84:87], a[100:103], a[36:39], v[84:87]
v_cvt_pk_bf16_f32 v42, v28, v29
v_cvt_pk_bf16_f32 v43, v30, v31
v_mfma_f32_16x16x32_bf16 v[84:87], a[96:99], a[32:35], v[84:87]
s_add_u32 s36, s22, 7168
ds_write_b128 v22, v[40:43] offset:2048
v_mfma_f32_16x16x32_bf16 v[88:91], a[112:115], a[32:35], v[60:63]
buffer_load_dwordx4 v[40:43], v21, s[4:7], s36 offen nt
v_mfma_f32_16x16x32_bf16 v[88:91], a[116:119], a[36:39], v[88:91]
v_lshlrev_b32 v28, 16, v44
v_and_b32 v29, s30, v44
v_lshlrev_b32 v30, 16, v45
v_mfma_f32_16x16x32_bf16 v[88:91], a[120:123], a[40:43], v[88:91]
v_and_b32 v31, s30, v45
v_mul_f32 v28, s26, v28
v_mfma_f32_16x16x32_bf16 v[88:91], a[124:127], a[44:47], v[88:91]
s_add_u32 s29, s23, 3072
ds_read_b128 a[232:235], v22 offset:4096
v_mfma_f32_16x16x32_bf16 v[92:95], a[140:143], a[44:47], v[60:63]
buffer_store_dwordx4 a[236:239], v21, s[16:19], s29 offen nt
v_mfma_f32_16x16x32_bf16 v[92:95], a[136:139], a[40:43], v[92:95]
v_mul_f32 v29, s26, v29
v_mul_f32 v30, s26, v30
v_mfma_f32_16x16x32_bf16 v[92:95], a[132:135], a[36:39], v[92:95]
v_exp_f32 v80, v80
v_mfma_f32_16x16x32_bf16 v[92:95], a[128:131], a[32:35], v[92:95]
v_exp_f32 v81, v81
v_smfmac_f32_16x16x64_bf16 a[212:215], a[228:231], v[72:79], v0
v_mul_f32 v31, s26, v31
v_mfma_f32_16x16x32_bf16 v[128:131], a[148:151], v[76:79], v[128:131]
v_exp_f32 v82, v82
v_mfma_f32_16x16x32_bf16 v[128:131], a[144:147], v[72:75], v[128:131]
v_exp_f32 v83, v83
v_mfma_f32_16x16x32_bf16 v[132:135], a[152:155], v[72:75], v[132:135]
v_exp_f32 v84, v84
v_mfma_f32_16x16x32_bf16 v[132:135], a[156:159], v[76:79], v[132:135]
v_exp_f32 v85, v85
v_mfma_f32_16x16x32_bf16 v[136:139], a[164:167], v[76:79], v[136:139]
v_exp_f32 v86, v86
v_mfma_f32_16x16x32_bf16 v[136:139], a[160:163], v[72:75], v[136:139]
v_exp_f32 v87, v87
v_mfma_f32_16x16x32_bf16 v[140:143], a[168:171], v[72:75], v[140:143]
v_exp_f32 v88, v88
v_mfma_f32_16x16x32_bf16 v[140:143], a[172:175], v[76:79], v[140:143]
v_exp_f32 v89, v89
v_mfma_f32_16x16x32_bf16 v[144:147], a[180:183], v[76:79], v[144:147]
v_exp_f32 v90, v90
v_mfma_f32_16x16x32_bf16 v[144:147], a[176:179], v[72:75], v[144:147]
v_exp_f32 v91, v91
v_mfma_f32_16x16x32_bf16 v[148:151], a[184:187], v[72:75], v[148:151]
v_exp_f32 v92, v92
v_mfma_f32_16x16x32_bf16 v[148:151], a[188:191], v[76:79], v[148:151]
v_exp_f32 v93, v93
v_mfma_f32_16x16x32_bf16 v[152:155], a[196:199], v[76:79], v[152:155]
v_exp_f32 v94, v94
v_mfma_f32_16x16x32_bf16 v[152:155], a[192:195], v[72:75], v[152:155]
v_exp_f32 v95, v95
v_mfma_f32_16x16x32_bf16 v[156:159], a[200:203], v[72:75], v[156:159]
v_cvt_pk_bf16_f32 v72, v80, v81
v_cvt_pk_bf16_f32 v73, v82, v83
v_mfma_f32_16x16x32_bf16 v[156:159], a[204:207], v[76:79], v[156:159]
v_cvt_pk_bf16_f32 v74, v84, v85
v_cvt_pk_bf16_f32 v75, v86, v87
v_mfma_f32_16x16x32_bf16 v[80:83], a[80:83], a[48:51], v[64:67]
v_cvt_pk_bf16_f32 v76, v88, v89
v_cvt_pk_bf16_f32 v77, v90, v91
v_mfma_f32_16x16x32_bf16 v[80:83], a[84:87], a[52:55], v[80:83]
v_cvt_pk_bf16_f32 v78, v92, v93
v_cvt_pk_bf16_f32 v79, v94, v95
v_mfma_f32_16x16x32_bf16 v[80:83], a[88:91], a[56:59], v[80:83]
s_add_u32 m0, s21, 69632
v_cvt_pk_bf16_f32 v44, v28, v29
v_cvt_pk_bf16_f32 v45, v30, v31
v_mfma_f32_16x16x32_bf16 v[80:83], a[92:95], a[60:63], v[80:83]
buffer_load_dwordx4 v17, s[12:15], s20 offen nt lds
v_mfma_f32_16x16x32_bf16 v[84:87], a[108:111], a[60:63], v[64:67]
s_add_u32 s20, s20, 4096
v_lshlrev_b32 v28, 16, v46
v_and_b32 v29, s30, v46
v_mfma_f32_16x16x32_bf16 v[84:87], a[104:107], a[56:59], v[84:87]
v_lshlrev_b32 v30, 16, v47
v_and_b32 v31, s30, v47
v_mfma_f32_16x16x32_bf16 v[84:87], a[100:103], a[52:55], v[84:87]
v_mul_f32 v28, s26, v28
v_mul_f32 v29, s26, v29
v_mfma_f32_16x16x32_bf16 v[84:87], a[96:99], a[48:51], v[84:87]
v_mul_f32 v30, s26, v30
v_mul_f32 v31, s26, v31
v_mfma_f32_16x16x32_bf16 v[88:91], a[112:115], a[48:51], v[64:67]
v_cvt_pk_bf16_f32 v46, v28, v29
v_cvt_pk_bf16_f32 v47, v30, v31
v_mfma_f32_16x16x32_bf16 v[88:91], a[116:119], a[52:55], v[88:91]
s_add_u32 s36, s22, 8192
ds_write_b128 v22, v[44:47] offset:3072
v_mfma_f32_16x16x32_bf16 v[88:91], a[120:123], a[56:59], v[88:91]
buffer_load_dwordx4 v[44:47], v18, s[4:7], s36 offen nt
v_mfma_f32_16x16x32_bf16 v[88:91], a[124:127], a[60:63], v[88:91]
v_lshlrev_b32 v28, 16, v48
v_and_b32 v29, s30, v48
v_lshlrev_b32 v30, 16, v49
v_mfma_f32_16x16x32_bf16 v[92:95], a[140:143], a[60:63], v[64:67]
v_and_b32 v31, s30, v49
v_mul_f32 v28, s26, v28
v_mfma_f32_16x16x32_bf16 v[92:95], a[136:139], a[56:59], v[92:95]
v_mul_f32 v29, s26, v29
v_mul_f32 v30, s26, v30
v_mfma_f32_16x16x32_bf16 v[92:95], a[132:135], a[52:55], v[92:95]
v_exp_f32 v80, v80
v_mfma_f32_16x16x32_bf16 v[92:95], a[128:131], a[48:51], v[92:95]
v_exp_f32 v81, v81
v_smfmac_f32_16x16x64_bf16 a[216:219], a[228:231], v[72:79], v0
v_mul_f32 v31, s26, v31
v_mfma_f32_16x16x32_bf16 v[160:163], a[148:151], v[76:79], v[160:163]
v_exp_f32 v82, v82
v_mfma_f32_16x16x32_bf16 v[160:163], a[144:147], v[72:75], v[160:163]
v_exp_f32 v83, v83
v_mfma_f32_16x16x32_bf16 v[164:167], a[152:155], v[72:75], v[164:167]
v_exp_f32 v84, v84
v_mfma_f32_16x16x32_bf16 v[164:167], a[156:159], v[76:79], v[164:167]
v_exp_f32 v85, v85
v_mfma_f32_16x16x32_bf16 v[168:171], a[164:167], v[76:79], v[168:171]
v_exp_f32 v86, v86
v_mfma_f32_16x16x32_bf16 v[168:171], a[160:163], v[72:75], v[168:171]
v_exp_f32 v87, v87
v_mfma_f32_16x16x32_bf16 v[172:175], a[168:171], v[72:75], v[172:175]
v_exp_f32 v88, v88
v_mfma_f32_16x16x32_bf16 v[172:175], a[172:175], v[76:79], v[172:175]
v_exp_f32 v89, v89
v_mfma_f32_16x16x32_bf16 v[176:179], a[180:183], v[76:79], v[176:179]
v_exp_f32 v90, v90
v_mfma_f32_16x16x32_bf16 v[176:179], a[176:179], v[72:75], v[176:179]
v_exp_f32 v91, v91
v_mfma_f32_16x16x32_bf16 v[180:183], a[184:187], v[72:75], v[180:183]
v_exp_f32 v92, v92
v_mfma_f32_16x16x32_bf16 v[180:183], a[188:191], v[76:79], v[180:183]
v_exp_f32 v93, v93
v_mfma_f32_16x16x32_bf16 v[184:187], a[196:199], v[76:79], v[184:187]
v_exp_f32 v94, v94
v_mfma_f32_16x16x32_bf16 v[184:187], a[192:195], v[72:75], v[184:187]
s_waitcnt vmcnt(7) lgkmcnt(0)
v_exp_f32 v95, v95
v_mfma_f32_16x16x32_bf16 v[188:191], a[200:203], v[72:75], v[188:191]
s_barrier
v_cvt_pk_bf16_f32 v72, v80, v81
v_cvt_pk_bf16_f32 v73, v82, v83
v_mfma_f32_16x16x32_bf16 v[188:191], a[204:207], v[76:79], v[188:191]
v_cvt_pk_bf16_f32 v74, v84, v85
v_cvt_pk_bf16_f32 v75, v86, v87
v_mfma_f32_16x16x32_bf16 v[80:83], a[80:83], a[64:67], v[68:71]
v_cvt_pk_bf16_f32 v76, v88, v89
v_cvt_pk_bf16_f32 v77, v90, v91
v_mfma_f32_16x16x32_bf16 v[80:83], a[84:87], a[68:71], v[80:83]
v_cvt_pk_bf16_f32 v78, v92, v93
v_cvt_pk_bf16_f32 v79, v94, v95
v_mfma_f32_16x16x32_bf16 v[80:83], a[88:91], a[72:75], v[80:83]
s_add_u32 m0, s21, 32768
ds_read_b128 a[80:83], v4 offset:8192
ds_read_b128 a[84:87], v5 offset:8192
v_mfma_f32_16x16x32_bf16 v[80:83], a[92:95], a[76:79], v[80:83]
buffer_load_dwordx4 v16, s[8:11], s20 offen nt lds
v_mfma_f32_16x16x32_bf16 v[84:87], a[108:111], a[76:79], v[68:71]
ds_read_b128 a[88:91], v6 offset:8192
ds_read_b128 a[92:95], v7 offset:8192
v_mfma_f32_16x16x32_bf16 v[84:87], a[104:107], a[72:75], v[84:87]
v_cvt_pk_bf16_f32 v48, v28, v29
v_cvt_pk_bf16_f32 v49, v30, v31
v_mfma_f32_16x16x32_bf16 v[84:87], a[100:103], a[68:71], v[84:87]
ds_read_b128 a[108:111], v7 offset:12288
ds_read_b128 a[104:107], v6 offset:12288
v_mfma_f32_16x16x32_bf16 v[84:87], a[96:99], a[64:67], v[84:87]
v_exp_f32 v80, v80
v_mfma_f32_16x16x32_bf16 v[88:91], a[112:115], a[64:67], v[68:71]
v_exp_f32 v81, v81
v_mfma_f32_16x16x32_bf16 v[88:91], a[116:119], a[68:71], v[88:91]
ds_read_b128 a[100:103], v5 offset:12288
ds_read_b128 a[96:99], v4 offset:12288
v_mfma_f32_16x16x32_bf16 v[88:91], a[120:123], a[72:75], v[88:91]
v_exp_f32 v82, v82
v_mfma_f32_16x16x32_bf16 v[88:91], a[124:127], a[76:79], v[88:91]
v_exp_f32 v83, v83
v_mfma_f32_16x16x32_bf16 v[92:95], a[140:143], a[76:79], v[68:71]
v_exp_f32 v84, v84
v_mfma_f32_16x16x32_bf16 v[92:95], a[136:139], a[72:75], v[92:95]
s_add_u32 m0, s21, 73728
ds_read_b128 a[112:115], v4 offset:16384
ds_read_b128 a[116:119], v5 offset:16384
v_mfma_f32_16x16x32_bf16 v[92:95], a[132:135], a[68:71], v[92:95]
buffer_load_dwordx4 v17, s[12:15], s20 offen nt lds
v_mfma_f32_16x16x32_bf16 v[92:95], a[128:131], a[64:67], v[92:95]
s_add_u32 s20, s20, 4096
v_exp_f32 v85, v85
v_smfmac_f32_16x16x64_bf16 a[220:223], a[228:231], v[72:79], v0
v_lshlrev_b32 v28, 16, v50
v_mfma_f32_16x16x32_bf16 v[192:195], a[148:151], v[76:79], v[192:195]
ds_read_b128 a[120:123], v6 offset:16384
ds_read_b128 a[124:127], v7 offset:16384
v_mfma_f32_16x16x32_bf16 v[192:195], a[144:147], v[72:75], v[192:195]
v_exp_f32 v86, v86
v_mfma_f32_16x16x32_bf16 v[196:199], a[152:155], v[72:75], v[196:199]
v_exp_f32 v87, v87
v_mfma_f32_16x16x32_bf16 v[196:199], a[156:159], v[76:79], v[196:199]
ds_read_b128 a[140:143], v7 offset:20480
ds_read_b128 a[136:139], v6 offset:20480
v_mfma_f32_16x16x32_bf16 v[200:203], a[164:167], v[76:79], v[200:203]
v_exp_f32 v88, v88
v_mfma_f32_16x16x32_bf16 v[200:203], a[160:163], v[72:75], v[200:203]
v_exp_f32 v89, v89
v_mfma_f32_16x16x32_bf16 v[204:207], a[168:171], v[72:75], v[204:207]
s_add_u32 m0, s21, 36864
ds_read_b128 a[132:135], v5 offset:20480
ds_read_b128 a[128:131], v4 offset:20480
v_mfma_f32_16x16x32_bf16 v[204:207], a[172:175], v[76:79], v[204:207]
buffer_load_dwordx4 v16, s[8:11], s20 offen nt lds
v_mfma_f32_16x16x32_bf16 v[208:211], a[180:183], v[76:79], v[208:211]
v_exp_f32 v90, v90
v_mfma_f32_16x16x32_bf16 v[208:211], a[176:179], v[72:75], v[208:211]
v_exp_f32 v91, v91
v_mfma_f32_16x16x32_bf16 v[212:215], a[184:187], v[72:75], v[212:215]
v_exp_f32 v92, v92
v_mfma_f32_16x16x32_bf16 v[212:215], a[188:191], v[76:79], v[212:215]
v_exp_f32 v93, v93
v_mfma_f32_16x16x32_bf16 v[216:219], a[196:199], v[76:79], v[216:219]
v_exp_f32 v94, v94
v_mfma_f32_16x16x32_bf16 v[216:219], a[192:195], v[72:75], v[216:219]
s_waitcnt lgkmcnt(0)
v_exp_f32 v95, v95
v_mfma_f32_16x16x32_bf16 v[220:223], a[200:203], v[72:75], v[220:223]
v_cvt_pk_bf16_f32 v72, v80, v81
v_cvt_pk_bf16_f32 v73, v82, v83
v_mfma_f32_16x16x32_bf16 v[220:223], a[204:207], v[76:79], v[220:223]
v_cvt_pk_bf16_f32 v74, v84, v85
v_cvt_pk_bf16_f32 v75, v86, v87
v_mfma_f32_16x16x32_bf16 v[80:83], a[80:83], a[0:3], v[52:55]
v_cvt_pk_bf16_f32 v76, v88, v89
v_cvt_pk_bf16_f32 v77, v90, v91
v_mfma_f32_16x16x32_bf16 v[80:83], a[84:87], a[4:7], v[80:83]
v_cvt_pk_bf16_f32 v78, v92, v93
v_cvt_pk_bf16_f32 v79, v94, v95
v_mfma_f32_16x16x32_bf16 v[80:83], a[88:91], a[8:11], v[80:83]
s_add_u32 s29, s23, 4096
ds_read_b128 a[236:239], v22 offset:5120
v_mfma_f32_16x16x32_bf16 v[80:83], a[92:95], a[12:15], v[80:83]
buffer_store_dwordx4 a[232:235], v18, s[16:19], s29 offen nt
v_mfma_f32_16x16x32_bf16 v[84:87], a[108:111], a[12:15], v[52:55]
v_and_b32 v29, s30, v50
v_lshlrev_b32 v30, 16, v51
v_mfma_f32_16x16x32_bf16 v[84:87], a[104:107], a[8:11], v[84:87]
v_and_b32 v31, s30, v51
v_mul_f32 v28, s26, v28
v_mfma_f32_16x16x32_bf16 v[84:87], a[100:103], a[4:7], v[84:87]
v_mul_f32 v29, s26, v29
v_mul_f32 v30, s26, v30
v_mfma_f32_16x16x32_bf16 v[84:87], a[96:99], a[0:3], v[84:87]
v_exp_f32 v80, v80
v_mfma_f32_16x16x32_bf16 v[88:91], a[112:115], a[0:3], v[52:55]
v_exp_f32 v81, v81
v_mfma_f32_16x16x32_bf16 v[88:91], a[116:119], a[4:7], v[88:91]
v_exp_f32 v82, v82
v_mfma_f32_16x16x32_bf16 v[88:91], a[120:123], a[8:11], v[88:91]
v_exp_f32 v83, v83
v_mfma_f32_16x16x32_bf16 v[88:91], a[124:127], a[12:15], v[88:91]
v_exp_f32 v84, v84
v_mfma_f32_16x16x32_bf16 v[92:95], a[140:143], a[12:15], v[52:55]
v_exp_f32 v85, v85
v_mfma_f32_16x16x32_bf16 v[92:95], a[136:139], a[8:11], v[92:95]
v_exp_f32 v86, v86
v_mfma_f32_16x16x32_bf16 v[92:95], a[132:135], a[4:7], v[92:95]
v_exp_f32 v87, v87
v_mfma_f32_16x16x32_bf16 v[92:95], a[128:131], a[0:3], v[92:95]
v_exp_f32 v88, v88
v_smfmac_f32_16x16x64_bf16 a[224:227], a[228:231], v[72:79], v0
v_mul_f32 v31, s26, v31
v_mfma_f32_16x16x32_bf16 v[224:227], a[148:151], v[76:79], v[224:227]
v_exp_f32 v89, v89
v_mfma_f32_16x16x32_bf16 v[224:227], a[144:147], v[72:75], v[224:227]
s_add_u32 m0, s21, 77824
ds_read_b64_tr_b16 a[144:145], v8 offset:8192
ds_read_b64_tr_b16 a[146:147], v8 offset:12288
v_mfma_f32_16x16x32_bf16 v[228:231], a[152:155], v[72:75], v[228:231]
buffer_load_dwordx4 v17, s[12:15], s20 offen nt lds
v_mfma_f32_16x16x32_bf16 v[228:231], a[156:159], v[76:79], v[228:231]
s_add_u32 s20, s20, 4096
v_exp_f32 v90, v90
v_mfma_f32_16x16x32_bf16 v[232:235], a[164:167], v[76:79], v[232:235]
ds_read_b64_tr_b16 a[148:149], v8 offset:16384
ds_read_b64_tr_b16 a[150:151], v8 offset:20480
v_mfma_f32_16x16x32_bf16 v[232:235], a[160:163], v[72:75], v[232:235]
v_exp_f32 v91, v91
v_mfma_f32_16x16x32_bf16 v[236:239], a[168:171], v[72:75], v[236:239]
ds_read_b64_tr_b16 a[152:153], v9 offset:8192
ds_read_b64_tr_b16 a[154:155], v9 offset:12288
v_mfma_f32_16x16x32_bf16 v[236:239], a[172:175], v[76:79], v[236:239]
v_exp_f32 v92, v92
v_mfma_f32_16x16x32_bf16 v[240:243], a[180:183], v[76:79], v[240:243]
ds_read_b64_tr_b16 a[156:157], v9 offset:16384
ds_read_b64_tr_b16 a[158:159], v9 offset:20480
v_mfma_f32_16x16x32_bf16 v[240:243], a[176:179], v[72:75], v[240:243]
v_exp_f32 v93, v93
v_mfma_f32_16x16x32_bf16 v[244:247], a[184:187], v[72:75], v[244:247]
ds_read_b64_tr_b16 a[160:161], v10 offset:8192
ds_read_b64_tr_b16 a[162:163], v10 offset:12288
v_mfma_f32_16x16x32_bf16 v[244:247], a[188:191], v[76:79], v[244:247]
v_exp_f32 v94, v94
v_mfma_f32_16x16x32_bf16 v[248:251], a[196:199], v[76:79], v[248:251]
ds_read_b64_tr_b16 a[164:165], v10 offset:16384
ds_read_b64_tr_b16 a[166:167], v10 offset:20480
v_mfma_f32_16x16x32_bf16 v[248:251], a[192:195], v[72:75], v[248:251]
v_exp_f32 v95, v95
v_mfma_f32_16x16x32_bf16 v[252:255], a[200:203], v[72:75], v[252:255]
v_cvt_pk_bf16_f32 v72, v80, v81
v_cvt_pk_bf16_f32 v73, v82, v83
v_mfma_f32_16x16x32_bf16 v[252:255], a[204:207], v[76:79], v[252:255]
v_cvt_pk_bf16_f32 v74, v84, v85
v_cvt_pk_bf16_f32 v75, v86, v87
v_mfma_f32_16x16x32_bf16 v[80:83], a[80:83], a[16:19], v[56:59]
v_cvt_pk_bf16_f32 v76, v88, v89
v_cvt_pk_bf16_f32 v77, v90, v91
v_mfma_f32_16x16x32_bf16 v[80:83], a[84:87], a[20:23], v[80:83]
v_cvt_pk_bf16_f32 v78, v92, v93
v_cvt_pk_bf16_f32 v79, v94, v95
v_mfma_f32_16x16x32_bf16 v[80:83], a[88:91], a[24:27], v[80:83]
s_add_u32 m0, s21, 0
ds_read_b64_tr_b16 a[168:169], v11 offset:8192
ds_read_b64_tr_b16 a[170:171], v11 offset:12288
v_mfma_f32_16x16x32_bf16 v[80:83], a[92:95], a[28:31], v[80:83]
buffer_load_dwordx4 v16, s[8:11], s20 offen nt lds
v_mfma_f32_16x16x32_bf16 v[84:87], a[108:111], a[28:31], v[56:59]
ds_read_b64_tr_b16 a[172:173], v11 offset:16384
ds_read_b64_tr_b16 a[174:175], v11 offset:20480
v_mfma_f32_16x16x32_bf16 v[84:87], a[104:107], a[24:27], v[84:87]
ds_read_b64_tr_b16 a[176:177], v12 offset:8192
ds_read_b64_tr_b16 a[178:179], v12 offset:12288
v_mfma_f32_16x16x32_bf16 v[84:87], a[100:103], a[20:23], v[84:87]
ds_read_b64_tr_b16 a[180:181], v12 offset:16384
ds_read_b64_tr_b16 a[182:183], v12 offset:20480
v_mfma_f32_16x16x32_bf16 v[84:87], a[96:99], a[16:19], v[84:87]
v_exp_f32 v80, v80
v_mfma_f32_16x16x32_bf16 v[88:91], a[112:115], a[16:19], v[56:59]
v_exp_f32 v81, v81
v_mfma_f32_16x16x32_bf16 v[88:91], a[116:119], a[20:23], v[88:91]
ds_read_b64_tr_b16 a[184:185], v13 offset:8192
ds_read_b64_tr_b16 a[186:187], v13 offset:12288
v_mfma_f32_16x16x32_bf16 v[88:91], a[120:123], a[24:27], v[88:91]
v_exp_f32 v82, v82
v_mfma_f32_16x16x32_bf16 v[88:91], a[124:127], a[28:31], v[88:91]
v_exp_f32 v83, v83
v_mfma_f32_16x16x32_bf16 v[92:95], a[140:143], a[28:31], v[56:59]
ds_read_b64_tr_b16 a[188:189], v13 offset:16384
ds_read_b64_tr_b16 a[190:191], v13 offset:20480
v_mfma_f32_16x16x32_bf16 v[92:95], a[136:139], a[24:27], v[92:95]
v_exp_f32 v84, v84
v_mfma_f32_16x16x32_bf16 v[92:95], a[132:135], a[20:23], v[92:95]
v_exp_f32 v85, v85
v_mfma_f32_16x16x32_bf16 v[92:95], a[128:131], a[16:19], v[92:95]
ds_read_b64_tr_b16 a[192:193], v14 offset:8192
ds_read_b64_tr_b16 a[194:195], v14 offset:12288
v_smfmac_f32_16x16x64_bf16 a[208:211], a[228:231], v[72:79], v0
s_waitcnt lgkmcnt(14)
v_cvt_pk_bf16_f32 v50, v28, v29
v_mfma_f32_16x16x32_bf16 v[96:99], a[148:151], v[76:79], v[96:99]
v_exp_f32 v86, v86
v_mfma_f32_16x16x32_bf16 v[96:99], a[144:147], v[72:75], v[96:99]
s_add_u32 m0, s21, 40960
ds_read_b64_tr_b16 a[196:197], v14 offset:16384
ds_read_b64_tr_b16 a[198:199], v14 offset:20480
v_mfma_f32_16x16x32_bf16 v[100:103], a[152:155], v[72:75], v[100:103]
buffer_load_dwordx4 v17, s[12:15], s20 offen nt lds
v_mfma_f32_16x16x32_bf16 v[100:103], a[156:159], v[76:79], v[100:103]
s_add_u32 s20, s20, 4096
ds_read_b64_tr_b16 a[200:201], v15 offset:8192
ds_read_b64_tr_b16 a[202:203], v15 offset:12288
v_mfma_f32_16x16x32_bf16 v[104:107], a[164:167], v[76:79], v[104:107]
v_exp_f32 v87, v87
v_mfma_f32_16x16x32_bf16 v[104:107], a[160:163], v[72:75], v[104:107]
s_waitcnt lgkmcnt(4)
v_exp_f32 v88, v88
v_mfma_f32_16x16x32_bf16 v[108:111], a[168:171], v[72:75], v[108:111]
ds_read_b64_tr_b16 a[204:205], v15 offset:16384
ds_read_b64_tr_b16 a[206:207], v15 offset:20480
v_mfma_f32_16x16x32_bf16 v[108:111], a[172:175], v[76:79], v[108:111]
v_exp_f32 v89, v89
v_mfma_f32_16x16x32_bf16 v[112:115], a[180:183], v[76:79], v[112:115]
v_exp_f32 v90, v90
v_mfma_f32_16x16x32_bf16 v[112:115], a[176:179], v[72:75], v[112:115]
v_exp_f32 v91, v91
v_mfma_f32_16x16x32_bf16 v[116:119], a[184:187], v[72:75], v[116:119]
v_exp_f32 v92, v92
v_mfma_f32_16x16x32_bf16 v[116:119], a[188:191], v[76:79], v[116:119]
s_waitcnt lgkmcnt(0)
v_exp_f32 v93, v93
v_mfma_f32_16x16x32_bf16 v[120:123], a[196:199], v[76:79], v[120:123]
v_exp_f32 v94, v94
v_mfma_f32_16x16x32_bf16 v[120:123], a[192:195], v[72:75], v[120:123]
v_exp_f32 v95, v95
v_mfma_f32_16x16x32_bf16 v[124:127], a[200:203], v[72:75], v[124:127]
v_cvt_pk_bf16_f32 v72, v80, v81
v_cvt_pk_bf16_f32 v73, v82, v83
v_mfma_f32_16x16x32_bf16 v[124:127], a[204:207], v[76:79], v[124:127]
v_cvt_pk_bf16_f32 v74, v84, v85
v_cvt_pk_bf16_f32 v75, v86, v87
v_mfma_f32_16x16x32_bf16 v[80:83], a[80:83], a[32:35], v[60:63]
v_cvt_pk_bf16_f32 v76, v88, v89
v_cvt_pk_bf16_f32 v77, v90, v91
v_mfma_f32_16x16x32_bf16 v[80:83], a[84:87], a[36:39], v[80:83]
v_cvt_pk_bf16_f32 v78, v92, v93
v_cvt_pk_bf16_f32 v79, v94, v95
v_mfma_f32_16x16x32_bf16 v[80:83], a[88:91], a[40:43], v[80:83]
s_add_u32 m0, s21, 4096
v_cvt_pk_bf16_f32 v51, v30, v31
v_mfma_f32_16x16x32_bf16 v[80:83], a[92:95], a[44:47], v[80:83]
buffer_load_dwordx4 v16, s[8:11], s20 offen nt lds
v_mfma_f32_16x16x32_bf16 v[84:87], a[108:111], a[44:47], v[60:63]
s_add_u32 s36, s22, 9216
ds_write_b128 v22, v[48:51] offset:4096
v_mfma_f32_16x16x32_bf16 v[84:87], a[104:107], a[40:43], v[84:87]
buffer_load_dwordx4 v[48:51], v19, s[4:7], s36 offen nt
v_mfma_f32_16x16x32_bf16 v[84:87], a[100:103], a[36:39], v[84:87]
v_lshlrev_b32 v28, 16, v32
v_and_b32 v29, s30, v32
v_lshlrev_b32 v30, 16, v33
v_mfma_f32_16x16x32_bf16 v[84:87], a[96:99], a[32:35], v[84:87]
v_and_b32 v31, s30, v33
v_mul_f32 v28, s26, v28
v_mfma_f32_16x16x32_bf16 v[88:91], a[112:115], a[32:35], v[60:63]
s_add_u32 s29, s23, 5120
ds_read_b128 a[232:235], v22 offset:6144
v_mfma_f32_16x16x32_bf16 v[88:91], a[116:119], a[36:39], v[88:91]
buffer_store_dwordx4 a[236:239], v19, s[16:19], s29 offen nt
v_mfma_f32_16x16x32_bf16 v[88:91], a[120:123], a[40:43], v[88:91]
v_mul_f32 v29, s26, v29
v_mul_f32 v30, s26, v30
v_mfma_f32_16x16x32_bf16 v[88:91], a[124:127], a[44:47], v[88:91]
v_mul_f32 v31, s26, v31
v_cvt_pk_bf16_f32 v32, v28, v29
v_mfma_f32_16x16x32_bf16 v[92:95], a[140:143], a[44:47], v[60:63]
v_cvt_pk_bf16_f32 v33, v30, v31
v_lshlrev_b32 v28, 16, v34
v_mfma_f32_16x16x32_bf16 v[92:95], a[136:139], a[40:43], v[92:95]
v_and_b32 v29, s30, v34
v_lshlrev_b32 v30, 16, v35
v_mfma_f32_16x16x32_bf16 v[92:95], a[132:135], a[36:39], v[92:95]
v_exp_f32 v80, v80
v_mfma_f32_16x16x32_bf16 v[92:95], a[128:131], a[32:35], v[92:95]
v_exp_f32 v81, v81
v_smfmac_f32_16x16x64_bf16 a[212:215], a[228:231], v[72:79], v0
v_and_b32 v31, s30, v35
v_mfma_f32_16x16x32_bf16 v[128:131], a[148:151], v[76:79], v[128:131]
v_exp_f32 v82, v82
v_mfma_f32_16x16x32_bf16 v[128:131], a[144:147], v[72:75], v[128:131]
v_exp_f32 v83, v83
v_mfma_f32_16x16x32_bf16 v[132:135], a[152:155], v[72:75], v[132:135]
v_exp_f32 v84, v84
v_mfma_f32_16x16x32_bf16 v[132:135], a[156:159], v[76:79], v[132:135]
v_exp_f32 v85, v85
v_mfma_f32_16x16x32_bf16 v[136:139], a[164:167], v[76:79], v[136:139]
v_exp_f32 v86, v86
v_mfma_f32_16x16x32_bf16 v[136:139], a[160:163], v[72:75], v[136:139]
v_exp_f32 v87, v87
v_mfma_f32_16x16x32_bf16 v[140:143], a[168:171], v[72:75], v[140:143]
v_exp_f32 v88, v88
v_mfma_f32_16x16x32_bf16 v[140:143], a[172:175], v[76:79], v[140:143]
v_exp_f32 v89, v89
v_mfma_f32_16x16x32_bf16 v[144:147], a[180:183], v[76:79], v[144:147]
v_exp_f32 v90, v90
v_mfma_f32_16x16x32_bf16 v[144:147], a[176:179], v[72:75], v[144:147]
v_exp_f32 v91, v91
v_mfma_f32_16x16x32_bf16 v[148:151], a[184:187], v[72:75], v[148:151]
v_exp_f32 v92, v92
v_mfma_f32_16x16x32_bf16 v[148:151], a[188:191], v[76:79], v[148:151]
v_exp_f32 v93, v93
v_mfma_f32_16x16x32_bf16 v[152:155], a[196:199], v[76:79], v[152:155]
v_exp_f32 v94, v94
v_mfma_f32_16x16x32_bf16 v[152:155], a[192:195], v[72:75], v[152:155]
v_exp_f32 v95, v95
v_mfma_f32_16x16x32_bf16 v[156:159], a[200:203], v[72:75], v[156:159]
v_cvt_pk_bf16_f32 v72, v80, v81
v_cvt_pk_bf16_f32 v73, v82, v83
v_mfma_f32_16x16x32_bf16 v[156:159], a[204:207], v[76:79], v[156:159]
v_cvt_pk_bf16_f32 v74, v84, v85
v_cvt_pk_bf16_f32 v75, v86, v87
v_mfma_f32_16x16x32_bf16 v[80:83], a[80:83], a[48:51], v[64:67]
v_cvt_pk_bf16_f32 v76, v88, v89
v_cvt_pk_bf16_f32 v77, v90, v91
v_mfma_f32_16x16x32_bf16 v[80:83], a[84:87], a[52:55], v[80:83]
v_cvt_pk_bf16_f32 v78, v92, v93
v_cvt_pk_bf16_f32 v79, v94, v95
v_mfma_f32_16x16x32_bf16 v[80:83], a[88:91], a[56:59], v[80:83]
s_add_u32 m0, s21, 45056
v_mul_f32 v28, s26, v28
v_mul_f32 v29, s26, v29
v_mfma_f32_16x16x32_bf16 v[80:83], a[92:95], a[60:63], v[80:83]
buffer_load_dwordx4 v17, s[12:15], s20 offen nt lds
v_mfma_f32_16x16x32_bf16 v[84:87], a[108:111], a[60:63], v[64:67]
s_add_u32 s20, s20, 4096
v_mul_f32 v30, s26, v30
v_mul_f32 v31, s26, v31
v_mfma_f32_16x16x32_bf16 v[84:87], a[104:107], a[56:59], v[84:87]
v_cvt_pk_bf16_f32 v34, v28, v29
v_cvt_pk_bf16_f32 v35, v30, v31
v_mfma_f32_16x16x32_bf16 v[84:87], a[100:103], a[52:55], v[84:87]
s_add_u32 s36, s22, 10240
ds_write_b128 v22, v[32:35] offset:5120
v_mfma_f32_16x16x32_bf16 v[84:87], a[96:99], a[48:51], v[84:87]
buffer_load_dwordx4 v[32:35], v20, s[4:7], s36 offen nt
v_mfma_f32_16x16x32_bf16 v[88:91], a[112:115], a[48:51], v[64:67]
v_lshlrev_b32 v28, 16, v36
v_and_b32 v29, s30, v36
v_lshlrev_b32 v30, 16, v37
v_mfma_f32_16x16x32_bf16 v[88:91], a[116:119], a[52:55], v[88:91]
s_waitcnt lgkmcnt(1)
v_and_b32 v31, s30, v37
v_mul_f32 v28, s26, v28
v_mfma_f32_16x16x32_bf16 v[88:91], a[120:123], a[56:59], v[88:91]
s_add_u32 s29, s23, 6144
ds_read_b128 a[236:239], v22 offset:7168
v_mfma_f32_16x16x32_bf16 v[88:91], a[124:127], a[60:63], v[88:91]
buffer_store_dwordx4 a[232:235], v20, s[16:19], s29 offen nt
v_mfma_f32_16x16x32_bf16 v[92:95], a[140:143], a[60:63], v[64:67]
v_mul_f32 v29, s26, v29
v_mul_f32 v30, s26, v30
v_mfma_f32_16x16x32_bf16 v[92:95], a[136:139], a[56:59], v[92:95]
v_mul_f32 v31, s26, v31
v_cvt_pk_bf16_f32 v36, v28, v29
v_mfma_f32_16x16x32_bf16 v[92:95], a[132:135], a[52:55], v[92:95]
v_exp_f32 v80, v80
v_mfma_f32_16x16x32_bf16 v[92:95], a[128:131], a[48:51], v[92:95]
v_exp_f32 v81, v81
v_smfmac_f32_16x16x64_bf16 a[216:219], a[228:231], v[72:79], v0
v_cvt_pk_bf16_f32 v37, v30, v31
v_mfma_f32_16x16x32_bf16 v[160:163], a[148:151], v[76:79], v[160:163]
v_exp_f32 v82, v82
v_mfma_f32_16x16x32_bf16 v[160:163], a[144:147], v[72:75], v[160:163]
v_exp_f32 v83, v83
v_mfma_f32_16x16x32_bf16 v[164:167], a[152:155], v[72:75], v[164:167]
v_exp_f32 v84, v84
v_mfma_f32_16x16x32_bf16 v[164:167], a[156:159], v[76:79], v[164:167]
v_exp_f32 v85, v85
v_mfma_f32_16x16x32_bf16 v[168:171], a[164:167], v[76:79], v[168:171]
v_exp_f32 v86, v86
v_mfma_f32_16x16x32_bf16 v[168:171], a[160:163], v[72:75], v[168:171]
v_exp_f32 v87, v87
v_mfma_f32_16x16x32_bf16 v[172:175], a[168:171], v[72:75], v[172:175]
v_exp_f32 v88, v88
v_mfma_f32_16x16x32_bf16 v[172:175], a[172:175], v[76:79], v[172:175]
v_exp_f32 v89, v89
v_mfma_f32_16x16x32_bf16 v[176:179], a[180:183], v[76:79], v[176:179]
v_exp_f32 v90, v90
v_mfma_f32_16x16x32_bf16 v[176:179], a[176:179], v[72:75], v[176:179]
v_exp_f32 v91, v91
v_mfma_f32_16x16x32_bf16 v[180:183], a[184:187], v[72:75], v[180:183]
v_exp_f32 v92, v92
v_mfma_f32_16x16x32_bf16 v[180:183], a[188:191], v[76:79], v[180:183]
v_exp_f32 v93, v93
v_mfma_f32_16x16x32_bf16 v[184:187], a[196:199], v[76:79], v[184:187]
v_exp_f32 v94, v94
v_mfma_f32_16x16x32_bf16 v[184:187], a[192:195], v[72:75], v[184:187]
s_waitcnt vmcnt(8) lgkmcnt(0)
v_exp_f32 v95, v95
v_mfma_f32_16x16x32_bf16 v[188:191], a[200:203], v[72:75], v[188:191]
s_barrier
v_cvt_pk_bf16_f32 v72, v80, v81
v_cvt_pk_bf16_f32 v73, v82, v83
v_mfma_f32_16x16x32_bf16 v[188:191], a[204:207], v[76:79], v[188:191]
v_cvt_pk_bf16_f32 v74, v84, v85
v_cvt_pk_bf16_f32 v75, v86, v87
v_mfma_f32_16x16x32_bf16 v[80:83], a[80:83], a[64:67], v[68:71]
v_cvt_pk_bf16_f32 v76, v88, v89
v_cvt_pk_bf16_f32 v77, v90, v91
v_mfma_f32_16x16x32_bf16 v[80:83], a[84:87], a[68:71], v[80:83]
v_cvt_pk_bf16_f32 v78, v92, v93
v_cvt_pk_bf16_f32 v79, v94, v95
v_mfma_f32_16x16x32_bf16 v[80:83], a[88:91], a[72:75], v[80:83]
s_add_u32 m0, s21, 8192
ds_read_b128 a[80:83], v4 offset:24576
ds_read_b128 a[84:87], v5 offset:24576
v_mfma_f32_16x16x32_bf16 v[80:83], a[92:95], a[76:79], v[80:83]
buffer_load_dwordx4 v16, s[8:11], s20 offen nt lds
v_mfma_f32_16x16x32_bf16 v[84:87], a[108:111], a[76:79], v[68:71]
ds_read_b128 a[88:91], v6 offset:24576
ds_read_b128 a[92:95], v7 offset:24576
v_mfma_f32_16x16x32_bf16 v[84:87], a[104:107], a[72:75], v[84:87]
v_lshlrev_b32 v28, 16, v38
v_and_b32 v29, s30, v38
v_mfma_f32_16x16x32_bf16 v[84:87], a[100:103], a[68:71], v[84:87]
ds_read_b128 a[108:111], v7 offset:28672
ds_read_b128 a[104:107], v6 offset:28672
v_mfma_f32_16x16x32_bf16 v[84:87], a[96:99], a[64:67], v[84:87]
v_exp_f32 v80, v80
v_mfma_f32_16x16x32_bf16 v[88:91], a[112:115], a[64:67], v[68:71]
v_exp_f32 v81, v81
v_mfma_f32_16x16x32_bf16 v[88:91], a[116:119], a[68:71], v[88:91]
ds_read_b128 a[100:103], v5 offset:28672
ds_read_b128 a[96:99], v4 offset:28672
v_mfma_f32_16x16x32_bf16 v[88:91], a[120:123], a[72:75], v[88:91]
v_exp_f32 v82, v82
v_mfma_f32_16x16x32_bf16 v[88:91], a[124:127], a[76:79], v[88:91]
v_exp_f32 v83, v83
v_mfma_f32_16x16x32_bf16 v[92:95], a[140:143], a[76:79], v[68:71]
v_exp_f32 v84, v84
v_mfma_f32_16x16x32_bf16 v[92:95], a[136:139], a[72:75], v[92:95]
s_add_u32 m0, s21, 49152
ds_read_b128 a[112:115], v4 offset:32768
ds_read_b128 a[116:119], v5 offset:32768
v_mfma_f32_16x16x32_bf16 v[92:95], a[132:135], a[68:71], v[92:95]
buffer_load_dwordx4 v17, s[12:15], s20 offen nt lds
v_mfma_f32_16x16x32_bf16 v[92:95], a[128:131], a[64:67], v[92:95]
s_add_u32 s20, s20, 4096
v_exp_f32 v85, v85
v_smfmac_f32_16x16x64_bf16 a[220:223], a[228:231], v[72:79], v0
v_lshlrev_b32 v30, 16, v39
v_mfma_f32_16x16x32_bf16 v[192:195], a[148:151], v[76:79], v[192:195]
ds_read_b128 a[120:123], v6 offset:32768
ds_read_b128 a[124:127], v7 offset:32768
v_mfma_f32_16x16x32_bf16 v[192:195], a[144:147], v[72:75], v[192:195]
v_exp_f32 v86, v86
v_mfma_f32_16x16x32_bf16 v[196:199], a[152:155], v[72:75], v[196:199]
v_exp_f32 v87, v87
v_mfma_f32_16x16x32_bf16 v[196:199], a[156:159], v[76:79], v[196:199]
ds_read_b128 a[140:143], v7 offset:36864
ds_read_b128 a[136:139], v6 offset:36864
v_mfma_f32_16x16x32_bf16 v[200:203], a[164:167], v[76:79], v[200:203]
v_exp_f32 v88, v88
v_mfma_f32_16x16x32_bf16 v[200:203], a[160:163], v[72:75], v[200:203]
v_exp_f32 v89, v89
v_mfma_f32_16x16x32_bf16 v[204:207], a[168:171], v[72:75], v[204:207]
s_add_u32 m0, s21, 12288
ds_read_b128 a[132:135], v5 offset:36864
ds_read_b128 a[128:131], v4 offset:36864
v_mfma_f32_16x16x32_bf16 v[204:207], a[172:175], v[76:79], v[204:207]
buffer_load_dwordx4 v16, s[8:11], s20 offen nt lds
v_mfma_f32_16x16x32_bf16 v[208:211], a[180:183], v[76:79], v[208:211]
v_exp_f32 v90, v90
v_mfma_f32_16x16x32_bf16 v[208:211], a[176:179], v[72:75], v[208:211]
v_exp_f32 v91, v91
v_mfma_f32_16x16x32_bf16 v[212:215], a[184:187], v[72:75], v[212:215]
v_exp_f32 v92, v92
v_mfma_f32_16x16x32_bf16 v[212:215], a[188:191], v[76:79], v[212:215]
v_exp_f32 v93, v93
v_mfma_f32_16x16x32_bf16 v[216:219], a[196:199], v[76:79], v[216:219]
v_exp_f32 v94, v94
v_mfma_f32_16x16x32_bf16 v[216:219], a[192:195], v[72:75], v[216:219]
s_waitcnt lgkmcnt(0)
v_exp_f32 v95, v95
v_mfma_f32_16x16x32_bf16 v[220:223], a[200:203], v[72:75], v[220:223]
v_cvt_pk_bf16_f32 v72, v80, v81
v_cvt_pk_bf16_f32 v73, v82, v83
v_mfma_f32_16x16x32_bf16 v[220:223], a[204:207], v[76:79], v[220:223]
v_cvt_pk_bf16_f32 v74, v84, v85
v_cvt_pk_bf16_f32 v75, v86, v87
v_mfma_f32_16x16x32_bf16 v[80:83], a[80:83], a[0:3], v[52:55]
v_cvt_pk_bf16_f32 v76, v88, v89
v_cvt_pk_bf16_f32 v77, v90, v91
v_mfma_f32_16x16x32_bf16 v[80:83], a[84:87], a[4:7], v[80:83]
v_cvt_pk_bf16_f32 v78, v92, v93
v_cvt_pk_bf16_f32 v79, v94, v95
v_mfma_f32_16x16x32_bf16 v[80:83], a[88:91], a[8:11], v[80:83]
v_and_b32 v31, s30, v39
v_mul_f32 v28, s26, v28
v_mfma_f32_16x16x32_bf16 v[80:83], a[92:95], a[12:15], v[80:83]
v_mul_f32 v29, s26, v29
v_mul_f32 v30, s26, v30
v_mfma_f32_16x16x32_bf16 v[84:87], a[108:111], a[12:15], v[52:55]
v_mul_f32 v31, s26, v31
v_cvt_pk_bf16_f32 v38, v28, v29
v_mfma_f32_16x16x32_bf16 v[84:87], a[104:107], a[8:11], v[84:87]
v_cvt_pk_bf16_f32 v39, v30, v31
v_mfma_f32_16x16x32_bf16 v[84:87], a[100:103], a[4:7], v[84:87]
ds_write_b128 v22, v[36:39] offset:6144
v_mfma_f32_16x16x32_bf16 v[84:87], a[96:99], a[0:3], v[84:87]
v_exp_f32 v80, v80
v_mfma_f32_16x16x32_bf16 v[88:91], a[112:115], a[0:3], v[52:55]
v_exp_f32 v81, v81
v_mfma_f32_16x16x32_bf16 v[88:91], a[116:119], a[4:7], v[88:91]
v_exp_f32 v82, v82
v_mfma_f32_16x16x32_bf16 v[88:91], a[120:123], a[8:11], v[88:91]
v_exp_f32 v83, v83
v_mfma_f32_16x16x32_bf16 v[88:91], a[124:127], a[12:15], v[88:91]
v_exp_f32 v84, v84
v_mfma_f32_16x16x32_bf16 v[92:95], a[140:143], a[12:15], v[52:55]
v_exp_f32 v85, v85
v_mfma_f32_16x16x32_bf16 v[92:95], a[136:139], a[8:11], v[92:95]
v_exp_f32 v86, v86
v_mfma_f32_16x16x32_bf16 v[92:95], a[132:135], a[4:7], v[92:95]
v_exp_f32 v87, v87
v_mfma_f32_16x16x32_bf16 v[92:95], a[128:131], a[0:3], v[92:95]
s_add_u32 s36, s22, 11264
v_exp_f32 v88, v88
v_smfmac_f32_16x16x64_bf16 a[224:227], a[228:231], v[72:79], v0
buffer_load_dwordx4 v[36:39], v21, s[4:7], s36 offen nt
v_mfma_f32_16x16x32_bf16 v[224:227], a[148:151], v[76:79], v[224:227]
v_exp_f32 v89, v89
v_mfma_f32_16x16x32_bf16 v[224:227], a[144:147], v[72:75], v[224:227]
s_add_u32 m0, s21, 53248
ds_read_b64_tr_b16 a[144:145], v8 offset:24576
ds_read_b64_tr_b16 a[146:147], v8 offset:28672
v_mfma_f32_16x16x32_bf16 v[228:231], a[152:155], v[72:75], v[228:231]
buffer_load_dwordx4 v17, s[12:15], s20 offen nt lds
v_mfma_f32_16x16x32_bf16 v[228:231], a[156:159], v[76:79], v[228:231]
s_add_u32 s20, s20, 4096
v_exp_f32 v90, v90
v_mfma_f32_16x16x32_bf16 v[232:235], a[164:167], v[76:79], v[232:235]
ds_read_b64_tr_b16 a[148:149], v8 offset:32768
ds_read_b64_tr_b16 a[150:151], v8 offset:36864
v_mfma_f32_16x16x32_bf16 v[232:235], a[160:163], v[72:75], v[232:235]
v_exp_f32 v91, v91
v_mfma_f32_16x16x32_bf16 v[236:239], a[168:171], v[72:75], v[236:239]
ds_read_b64_tr_b16 a[152:153], v9 offset:24576
ds_read_b64_tr_b16 a[154:155], v9 offset:28672
v_mfma_f32_16x16x32_bf16 v[236:239], a[172:175], v[76:79], v[236:239]
v_exp_f32 v92, v92
v_mfma_f32_16x16x32_bf16 v[240:243], a[180:183], v[76:79], v[240:243]
ds_read_b64_tr_b16 a[156:157], v9 offset:32768
ds_read_b64_tr_b16 a[158:159], v9 offset:36864
v_mfma_f32_16x16x32_bf16 v[240:243], a[176:179], v[72:75], v[240:243]
v_exp_f32 v93, v93
v_mfma_f32_16x16x32_bf16 v[244:247], a[184:187], v[72:75], v[244:247]
ds_read_b64_tr_b16 a[160:161], v10 offset:24576
ds_read_b64_tr_b16 a[162:163], v10 offset:28672
v_mfma_f32_16x16x32_bf16 v[244:247], a[188:191], v[76:79], v[244:247]
v_exp_f32 v94, v94
v_mfma_f32_16x16x32_bf16 v[248:251], a[196:199], v[76:79], v[248:251]
ds_read_b64_tr_b16 a[164:165], v10 offset:32768
ds_read_b64_tr_b16 a[166:167], v10 offset:36864
v_mfma_f32_16x16x32_bf16 v[248:251], a[192:195], v[72:75], v[248:251]
v_exp_f32 v95, v95
v_mfma_f32_16x16x32_bf16 v[252:255], a[200:203], v[72:75], v[252:255]
v_cvt_pk_bf16_f32 v72, v80, v81
v_cvt_pk_bf16_f32 v73, v82, v83
v_mfma_f32_16x16x32_bf16 v[252:255], a[204:207], v[76:79], v[252:255]
v_cvt_pk_bf16_f32 v74, v84, v85
v_cvt_pk_bf16_f32 v75, v86, v87
v_mfma_f32_16x16x32_bf16 v[80:83], a[80:83], a[16:19], v[56:59]
v_cvt_pk_bf16_f32 v76, v88, v89
v_cvt_pk_bf16_f32 v77, v90, v91
v_mfma_f32_16x16x32_bf16 v[80:83], a[84:87], a[20:23], v[80:83]
v_cvt_pk_bf16_f32 v78, v92, v93
v_cvt_pk_bf16_f32 v79, v94, v95
v_mfma_f32_16x16x32_bf16 v[80:83], a[88:91], a[24:27], v[80:83]
s_add_u32 m0, s21, 16384
ds_read_b64_tr_b16 a[168:169], v11 offset:24576
ds_read_b64_tr_b16 a[170:171], v11 offset:28672
v_mfma_f32_16x16x32_bf16 v[80:83], a[92:95], a[28:31], v[80:83]
buffer_load_dwordx4 v16, s[8:11], s20 offen nt lds
v_mfma_f32_16x16x32_bf16 v[84:87], a[108:111], a[28:31], v[56:59]
ds_read_b64_tr_b16 a[172:173], v11 offset:32768
ds_read_b64_tr_b16 a[174:175], v11 offset:36864
v_mfma_f32_16x16x32_bf16 v[84:87], a[104:107], a[24:27], v[84:87]
ds_read_b64_tr_b16 a[176:177], v12 offset:24576
ds_read_b64_tr_b16 a[178:179], v12 offset:28672
v_mfma_f32_16x16x32_bf16 v[84:87], a[100:103], a[20:23], v[84:87]
ds_read_b64_tr_b16 a[180:181], v12 offset:32768
ds_read_b64_tr_b16 a[182:183], v12 offset:36864
v_mfma_f32_16x16x32_bf16 v[84:87], a[96:99], a[16:19], v[84:87]
v_exp_f32 v80, v80
v_mfma_f32_16x16x32_bf16 v[88:91], a[112:115], a[16:19], v[56:59]
v_exp_f32 v81, v81
v_mfma_f32_16x16x32_bf16 v[88:91], a[116:119], a[20:23], v[88:91]
ds_read_b64_tr_b16 a[184:185], v13 offset:24576
ds_read_b64_tr_b16 a[186:187], v13 offset:28672
v_mfma_f32_16x16x32_bf16 v[88:91], a[120:123], a[24:27], v[88:91]
v_exp_f32 v82, v82
v_mfma_f32_16x16x32_bf16 v[88:91], a[124:127], a[28:31], v[88:91]
v_exp_f32 v83, v83
v_mfma_f32_16x16x32_bf16 v[92:95], a[140:143], a[28:31], v[56:59]
ds_read_b64_tr_b16 a[188:189], v13 offset:32768
ds_read_b64_tr_b16 a[190:191], v13 offset:36864
v_mfma_f32_16x16x32_bf16 v[92:95], a[136:139], a[24:27], v[92:95]
v_exp_f32 v84, v84
v_mfma_f32_16x16x32_bf16 v[92:95], a[132:135], a[20:23], v[92:95]
v_exp_f32 v85, v85
v_mfma_f32_16x16x32_bf16 v[92:95], a[128:131], a[16:19], v[92:95]
ds_read_b64_tr_b16 a[192:193], v14 offset:24576
ds_read_b64_tr_b16 a[194:195], v14 offset:28672
v_smfmac_f32_16x16x64_bf16 a[208:211], a[228:231], v[72:79], v0
s_waitcnt lgkmcnt(14)
v_lshlrev_b32 v28, 16, v40
v_mfma_f32_16x16x32_bf16 v[96:99], a[148:151], v[76:79], v[96:99]
v_exp_f32 v86, v86
v_mfma_f32_16x16x32_bf16 v[96:99], a[144:147], v[72:75], v[96:99]
s_add_u32 m0, s21, 57344
ds_read_b64_tr_b16 a[196:197], v14 offset:32768
ds_read_b64_tr_b16 a[198:199], v14 offset:36864
v_mfma_f32_16x16x32_bf16 v[100:103], a[152:155], v[72:75], v[100:103]
buffer_load_dwordx4 v17, s[12:15], s20 offen nt lds
v_mfma_f32_16x16x32_bf16 v[100:103], a[156:159], v[76:79], v[100:103]
s_add_u32 s20, s20, 4096
ds_read_b64_tr_b16 a[200:201], v15 offset:24576
ds_read_b64_tr_b16 a[202:203], v15 offset:28672
v_mfma_f32_16x16x32_bf16 v[104:107], a[164:167], v[76:79], v[104:107]
v_exp_f32 v87, v87
v_mfma_f32_16x16x32_bf16 v[104:107], a[160:163], v[72:75], v[104:107]
s_waitcnt lgkmcnt(4)
v_exp_f32 v88, v88
v_mfma_f32_16x16x32_bf16 v[108:111], a[168:171], v[72:75], v[108:111]
ds_read_b64_tr_b16 a[204:205], v15 offset:32768
ds_read_b64_tr_b16 a[206:207], v15 offset:36864
v_mfma_f32_16x16x32_bf16 v[108:111], a[172:175], v[76:79], v[108:111]
v_exp_f32 v89, v89
v_mfma_f32_16x16x32_bf16 v[112:115], a[180:183], v[76:79], v[112:115]
v_exp_f32 v90, v90
v_mfma_f32_16x16x32_bf16 v[112:115], a[176:179], v[72:75], v[112:115]
v_exp_f32 v91, v91
v_mfma_f32_16x16x32_bf16 v[116:119], a[184:187], v[72:75], v[116:119]
v_exp_f32 v92, v92
v_mfma_f32_16x16x32_bf16 v[116:119], a[188:191], v[76:79], v[116:119]
s_waitcnt lgkmcnt(0)
v_exp_f32 v93, v93
v_mfma_f32_16x16x32_bf16 v[120:123], a[196:199], v[76:79], v[120:123]
v_exp_f32 v94, v94
v_mfma_f32_16x16x32_bf16 v[120:123], a[192:195], v[72:75], v[120:123]
v_exp_f32 v95, v95
v_mfma_f32_16x16x32_bf16 v[124:127], a[200:203], v[72:75], v[124:127]
v_cvt_pk_bf16_f32 v72, v80, v81
v_cvt_pk_bf16_f32 v73, v82, v83
v_mfma_f32_16x16x32_bf16 v[124:127], a[204:207], v[76:79], v[124:127]
v_cvt_pk_bf16_f32 v74, v84, v85
v_cvt_pk_bf16_f32 v75, v86, v87
v_mfma_f32_16x16x32_bf16 v[80:83], a[80:83], a[32:35], v[60:63]
v_cvt_pk_bf16_f32 v76, v88, v89
v_cvt_pk_bf16_f32 v77, v90, v91
v_mfma_f32_16x16x32_bf16 v[80:83], a[84:87], a[36:39], v[80:83]
v_cvt_pk_bf16_f32 v78, v92, v93
v_cvt_pk_bf16_f32 v79, v94, v95
v_mfma_f32_16x16x32_bf16 v[80:83], a[88:91], a[40:43], v[80:83]
s_add_u32 m0, s21, 20480
v_and_b32 v29, s30, v40
v_lshlrev_b32 v30, 16, v41
v_and_b32 v31, s30, v41
v_mfma_f32_16x16x32_bf16 v[80:83], a[92:95], a[44:47], v[80:83]
buffer_load_dwordx4 v16, s[8:11], s20 offen nt lds
v_mfma_f32_16x16x32_bf16 v[84:87], a[108:111], a[44:47], v[60:63]
v_mul_f32 v28, s26, v28
v_mul_f32 v29, s26, v29
v_mfma_f32_16x16x32_bf16 v[84:87], a[104:107], a[40:43], v[84:87]
v_mul_f32 v30, s26, v30
v_mul_f32 v31, s26, v31
v_mfma_f32_16x16x32_bf16 v[84:87], a[100:103], a[36:39], v[84:87]
s_add_u32 s29, s23, 7168
ds_read_b128 a[232:235], v22 offset:8192
v_mfma_f32_16x16x32_bf16 v[84:87], a[96:99], a[32:35], v[84:87]
buffer_store_dwordx4 a[236:239], v21, s[16:19], s29 offen nt
v_mfma_f32_16x16x32_bf16 v[88:91], a[112:115], a[32:35], v[60:63]
v_cvt_pk_bf16_f32 v40, v28, v29
v_cvt_pk_bf16_f32 v41, v30, v31
v_mfma_f32_16x16x32_bf16 v[88:91], a[116:119], a[36:39], v[88:91]
v_lshlrev_b32 v28, 16, v42
v_and_b32 v29, s30, v42
v_mfma_f32_16x16x32_bf16 v[88:91], a[120:123], a[40:43], v[88:91]
v_lshlrev_b32 v30, 16, v43
v_and_b32 v31, s30, v43
v_mfma_f32_16x16x32_bf16 v[88:91], a[124:127], a[44:47], v[88:91]
v_mul_f32 v28, s26, v28
v_mul_f32 v29, s26, v29
v_mfma_f32_16x16x32_bf16 v[92:95], a[140:143], a[44:47], v[60:63]
v_mul_f32 v30, s26, v30
v_mul_f32 v31, s26, v31
v_mfma_f32_16x16x32_bf16 v[92:95], a[136:139], a[40:43], v[92:95]
v_cvt_pk_bf16_f32 v42, v28, v29
v_cvt_pk_bf16_f32 v43, v30, v31
v_mfma_f32_16x16x32_bf16 v[92:95], a[132:135], a[36:39], v[92:95]
v_exp_f32 v80, v80
v_mfma_f32_16x16x32_bf16 v[92:95], a[128:131], a[32:35], v[92:95]
v_exp_f32 v81, v81
v_smfmac_f32_16x16x64_bf16 a[212:215], a[228:231], v[72:79], v0
ds_write_b128 v22, v[40:43] offset:7168
v_mfma_f32_16x16x32_bf16 v[128:131], a[148:151], v[76:79], v[128:131]
v_exp_f32 v82, v82
v_mfma_f32_16x16x32_bf16 v[128:131], a[144:147], v[72:75], v[128:131]
v_exp_f32 v83, v83
v_mfma_f32_16x16x32_bf16 v[132:135], a[152:155], v[72:75], v[132:135]
v_exp_f32 v84, v84
v_mfma_f32_16x16x32_bf16 v[132:135], a[156:159], v[76:79], v[132:135]
v_exp_f32 v85, v85
v_mfma_f32_16x16x32_bf16 v[136:139], a[164:167], v[76:79], v[136:139]
v_exp_f32 v86, v86
v_mfma_f32_16x16x32_bf16 v[136:139], a[160:163], v[72:75], v[136:139]
v_exp_f32 v87, v87
v_mfma_f32_16x16x32_bf16 v[140:143], a[168:171], v[72:75], v[140:143]
v_exp_f32 v88, v88
v_mfma_f32_16x16x32_bf16 v[140:143], a[172:175], v[76:79], v[140:143]
v_exp_f32 v89, v89
v_mfma_f32_16x16x32_bf16 v[144:147], a[180:183], v[76:79], v[144:147]
v_exp_f32 v90, v90
v_mfma_f32_16x16x32_bf16 v[144:147], a[176:179], v[72:75], v[144:147]
v_exp_f32 v91, v91
v_mfma_f32_16x16x32_bf16 v[148:151], a[184:187], v[72:75], v[148:151]
v_exp_f32 v92, v92
v_mfma_f32_16x16x32_bf16 v[148:151], a[188:191], v[76:79], v[148:151]
v_exp_f32 v93, v93
v_mfma_f32_16x16x32_bf16 v[152:155], a[196:199], v[76:79], v[152:155]
v_exp_f32 v94, v94
v_mfma_f32_16x16x32_bf16 v[152:155], a[192:195], v[72:75], v[152:155]
v_exp_f32 v95, v95
v_mfma_f32_16x16x32_bf16 v[156:159], a[200:203], v[72:75], v[156:159]
v_cvt_pk_bf16_f32 v72, v80, v81
v_cvt_pk_bf16_f32 v73, v82, v83
v_mfma_f32_16x16x32_bf16 v[156:159], a[204:207], v[76:79], v[156:159]
v_cvt_pk_bf16_f32 v74, v84, v85
v_cvt_pk_bf16_f32 v75, v86, v87
v_mfma_f32_16x16x32_bf16 v[80:83], a[80:83], a[48:51], v[64:67]
v_cvt_pk_bf16_f32 v76, v88, v89
v_cvt_pk_bf16_f32 v77, v90, v91
v_mfma_f32_16x16x32_bf16 v[80:83], a[84:87], a[52:55], v[80:83]
s_add_u32 s36, s22, 12288
v_cvt_pk_bf16_f32 v78, v92, v93
v_cvt_pk_bf16_f32 v79, v94, v95
v_mfma_f32_16x16x32_bf16 v[80:83], a[88:91], a[56:59], v[80:83]
s_add_u32 m0, s21, 61440
buffer_load_dwordx4 v[40:43], v18, s[4:7], s36 offen nt
v_mfma_f32_16x16x32_bf16 v[80:83], a[92:95], a[60:63], v[80:83]
buffer_load_dwordx4 v17, s[12:15], s20 offen nt lds
v_mfma_f32_16x16x32_bf16 v[84:87], a[108:111], a[60:63], v[64:67]
s_add_u32 s20, s20, 4096
v_lshlrev_b32 v28, 16, v44
v_and_b32 v29, s30, v44
v_lshlrev_b32 v30, 16, v45
v_mfma_f32_16x16x32_bf16 v[84:87], a[104:107], a[56:59], v[84:87]
s_waitcnt lgkmcnt(1)
v_and_b32 v31, s30, v45
v_mul_f32 v28, s26, v28
v_mfma_f32_16x16x32_bf16 v[84:87], a[100:103], a[52:55], v[84:87]
s_add_u32 s29, s23, 8192
ds_read_b128 a[236:239], v22 offset:9216
v_mfma_f32_16x16x32_bf16 v[84:87], a[96:99], a[48:51], v[84:87]
buffer_store_dwordx4 a[232:235], v18, s[16:19], s29 offen nt
v_mfma_f32_16x16x32_bf16 v[88:91], a[112:115], a[48:51], v[64:67]
v_mul_f32 v29, s26, v29
v_mul_f32 v30, s26, v30
v_mfma_f32_16x16x32_bf16 v[88:91], a[116:119], a[52:55], v[88:91]
v_mul_f32 v31, s26, v31
v_cvt_pk_bf16_f32 v44, v28, v29
v_mfma_f32_16x16x32_bf16 v[88:91], a[120:123], a[56:59], v[88:91]
v_cvt_pk_bf16_f32 v45, v30, v31
v_lshlrev_b32 v28, 16, v46
v_mfma_f32_16x16x32_bf16 v[88:91], a[124:127], a[60:63], v[88:91]
v_and_b32 v29, s30, v46
v_lshlrev_b32 v30, 16, v47
v_mfma_f32_16x16x32_bf16 v[92:95], a[140:143], a[60:63], v[64:67]
v_and_b32 v31, s30, v47
v_mul_f32 v28, s26, v28
v_mfma_f32_16x16x32_bf16 v[92:95], a[136:139], a[56:59], v[92:95]
v_mul_f32 v29, s26, v29
v_mul_f32 v30, s26, v30
v_mfma_f32_16x16x32_bf16 v[92:95], a[132:135], a[52:55], v[92:95]
v_exp_f32 v80, v80
v_mfma_f32_16x16x32_bf16 v[92:95], a[128:131], a[48:51], v[92:95]
v_exp_f32 v81, v81
v_smfmac_f32_16x16x64_bf16 a[216:219], a[228:231], v[72:79], v0
v_mul_f32 v31, s26, v31
v_mfma_f32_16x16x32_bf16 v[160:163], a[148:151], v[76:79], v[160:163]
v_exp_f32 v82, v82
v_mfma_f32_16x16x32_bf16 v[160:163], a[144:147], v[72:75], v[160:163]
v_exp_f32 v83, v83
v_mfma_f32_16x16x32_bf16 v[164:167], a[152:155], v[72:75], v[164:167]
v_exp_f32 v84, v84
v_mfma_f32_16x16x32_bf16 v[164:167], a[156:159], v[76:79], v[164:167]
v_exp_f32 v85, v85
v_mfma_f32_16x16x32_bf16 v[168:171], a[164:167], v[76:79], v[168:171]
v_exp_f32 v86, v86
v_mfma_f32_16x16x32_bf16 v[168:171], a[160:163], v[72:75], v[168:171]
v_exp_f32 v87, v87
v_mfma_f32_16x16x32_bf16 v[172:175], a[168:171], v[72:75], v[172:175]
v_exp_f32 v88, v88
v_mfma_f32_16x16x32_bf16 v[172:175], a[172:175], v[76:79], v[172:175]
v_exp_f32 v89, v89
v_mfma_f32_16x16x32_bf16 v[176:179], a[180:183], v[76:79], v[176:179]
v_exp_f32 v90, v90
v_mfma_f32_16x16x32_bf16 v[176:179], a[176:179], v[72:75], v[176:179]
v_exp_f32 v91, v91
v_mfma_f32_16x16x32_bf16 v[180:183], a[184:187], v[72:75], v[180:183]
v_exp_f32 v92, v92
v_mfma_f32_16x16x32_bf16 v[180:183], a[188:191], v[76:79], v[180:183]
v_exp_f32 v93, v93
v_mfma_f32_16x16x32_bf16 v[184:187], a[196:199], v[76:79], v[184:187]
v_exp_f32 v94, v94
v_mfma_f32_16x16x32_bf16 v[184:187], a[192:195], v[72:75], v[184:187]
s_waitcnt vmcnt(7) lgkmcnt(0)
v_exp_f32 v95, v95
v_mfma_f32_16x16x32_bf16 v[188:191], a[200:203], v[72:75], v[188:191]
s_barrier
v_cvt_pk_bf16_f32 v72, v80, v81
v_cvt_pk_bf16_f32 v73, v82, v83
v_mfma_f32_16x16x32_bf16 v[188:191], a[204:207], v[76:79], v[188:191]
v_cvt_pk_bf16_f32 v74, v84, v85
v_cvt_pk_bf16_f32 v75, v86, v87
v_mfma_f32_16x16x32_bf16 v[80:83], a[80:83], a[64:67], v[68:71]
v_cvt_pk_bf16_f32 v76, v88, v89
v_cvt_pk_bf16_f32 v77, v90, v91
v_mfma_f32_16x16x32_bf16 v[80:83], a[84:87], a[68:71], v[80:83]
v_cvt_pk_bf16_f32 v78, v92, v93
v_cvt_pk_bf16_f32 v79, v94, v95
v_mfma_f32_16x16x32_bf16 v[80:83], a[88:91], a[72:75], v[80:83]
s_add_u32 m0, s21, 24576
ds_read_b128 a[80:83], v4 offset:0
ds_read_b128 a[84:87], v5 offset:0
v_mfma_f32_16x16x32_bf16 v[80:83], a[92:95], a[76:79], v[80:83]
buffer_load_dwordx4 v16, s[8:11], s20 offen nt lds
v_mfma_f32_16x16x32_bf16 v[84:87], a[108:111], a[76:79], v[68:71]
ds_read_b128 a[88:91], v6 offset:0
ds_read_b128 a[92:95], v7 offset:0
v_mfma_f32_16x16x32_bf16 v[84:87], a[104:107], a[72:75], v[84:87]
v_cvt_pk_bf16_f32 v46, v28, v29
v_cvt_pk_bf16_f32 v47, v30, v31
v_mfma_f32_16x16x32_bf16 v[84:87], a[100:103], a[68:71], v[84:87]
ds_read_b128 a[108:111], v7 offset:4096
ds_read_b128 a[104:107], v6 offset:4096
v_mfma_f32_16x16x32_bf16 v[84:87], a[96:99], a[64:67], v[84:87]
v_exp_f32 v80, v80
v_mfma_f32_16x16x32_bf16 v[88:91], a[112:115], a[64:67], v[68:71]
v_exp_f32 v81, v81
v_mfma_f32_16x16x32_bf16 v[88:91], a[116:119], a[68:71], v[88:91]
ds_read_b128 a[100:103], v5 offset:4096
ds_read_b128 a[96:99], v4 offset:4096
v_mfma_f32_16x16x32_bf16 v[88:91], a[120:123], a[72:75], v[88:91]
v_exp_f32 v82, v82
v_mfma_f32_16x16x32_bf16 v[88:91], a[124:127], a[76:79], v[88:91]
v_exp_f32 v83, v83
v_mfma_f32_16x16x32_bf16 v[92:95], a[140:143], a[76:79], v[68:71]
v_exp_f32 v84, v84
v_mfma_f32_16x16x32_bf16 v[92:95], a[136:139], a[72:75], v[92:95]
s_add_u32 m0, s21, 65536
ds_read_b128 a[112:115], v4 offset:8192
ds_read_b128 a[116:119], v5 offset:8192
v_mfma_f32_16x16x32_bf16 v[92:95], a[132:135], a[68:71], v[92:95]
buffer_load_dwordx4 v17, s[12:15], s20 offen nt lds
v_mfma_f32_16x16x32_bf16 v[92:95], a[128:131], a[64:67], v[92:95]
s_add_u32 s20, s20, 4096
v_exp_f32 v85, v85
v_smfmac_f32_16x16x64_bf16 a[220:223], a[228:231], v[72:79], v0
ds_write_b128 v22, v[44:47] offset:8192
v_mfma_f32_16x16x32_bf16 v[192:195], a[148:151], v[76:79], v[192:195]
ds_read_b128 a[120:123], v6 offset:8192
ds_read_b128 a[124:127], v7 offset:8192
v_mfma_f32_16x16x32_bf16 v[192:195], a[144:147], v[72:75], v[192:195]
v_exp_f32 v86, v86
v_mfma_f32_16x16x32_bf16 v[196:199], a[152:155], v[72:75], v[196:199]
v_exp_f32 v87, v87
v_mfma_f32_16x16x32_bf16 v[196:199], a[156:159], v[76:79], v[196:199]
ds_read_b128 a[140:143], v7 offset:12288
ds_read_b128 a[136:139], v6 offset:12288
v_mfma_f32_16x16x32_bf16 v[200:203], a[164:167], v[76:79], v[200:203]
v_exp_f32 v88, v88
v_mfma_f32_16x16x32_bf16 v[200:203], a[160:163], v[72:75], v[200:203]
v_exp_f32 v89, v89
v_mfma_f32_16x16x32_bf16 v[204:207], a[168:171], v[72:75], v[204:207]
s_add_u32 m0, s21, 28672
ds_read_b128 a[132:135], v5 offset:12288
ds_read_b128 a[128:131], v4 offset:12288
v_mfma_f32_16x16x32_bf16 v[204:207], a[172:175], v[76:79], v[204:207]
buffer_load_dwordx4 v16, s[8:11], s20 offen nt lds
v_mfma_f32_16x16x32_bf16 v[208:211], a[180:183], v[76:79], v[208:211]
v_exp_f32 v90, v90
v_mfma_f32_16x16x32_bf16 v[208:211], a[176:179], v[72:75], v[208:211]
v_exp_f32 v91, v91
v_mfma_f32_16x16x32_bf16 v[212:215], a[184:187], v[72:75], v[212:215]
v_exp_f32 v92, v92
v_mfma_f32_16x16x32_bf16 v[212:215], a[188:191], v[76:79], v[212:215]
v_exp_f32 v93, v93
v_mfma_f32_16x16x32_bf16 v[216:219], a[196:199], v[76:79], v[216:219]
v_exp_f32 v94, v94
v_mfma_f32_16x16x32_bf16 v[216:219], a[192:195], v[72:75], v[216:219]
s_waitcnt lgkmcnt(0)
v_exp_f32 v95, v95
v_mfma_f32_16x16x32_bf16 v[220:223], a[200:203], v[72:75], v[220:223]
v_cvt_pk_bf16_f32 v72, v80, v81
v_cvt_pk_bf16_f32 v73, v82, v83
v_mfma_f32_16x16x32_bf16 v[220:223], a[204:207], v[76:79], v[220:223]
v_cvt_pk_bf16_f32 v74, v84, v85
v_cvt_pk_bf16_f32 v75, v86, v87
v_mfma_f32_16x16x32_bf16 v[80:83], a[80:83], a[0:3], v[52:55]
v_cvt_pk_bf16_f32 v76, v88, v89
v_cvt_pk_bf16_f32 v77, v90, v91
v_mfma_f32_16x16x32_bf16 v[80:83], a[84:87], a[4:7], v[80:83]
s_add_u32 s36, s22, 13312
v_cvt_pk_bf16_f32 v78, v92, v93
v_cvt_pk_bf16_f32 v79, v94, v95
v_mfma_f32_16x16x32_bf16 v[80:83], a[88:91], a[8:11], v[80:83]
buffer_load_dwordx4 v[44:47], v19, s[4:7], s36 offen nt
v_mfma_f32_16x16x32_bf16 v[80:83], a[92:95], a[12:15], v[80:83]
v_lshlrev_b32 v28, 16, v48
v_and_b32 v29, s30, v48
v_lshlrev_b32 v30, 16, v49
v_mfma_f32_16x16x32_bf16 v[84:87], a[108:111], a[12:15], v[52:55]
v_and_b32 v31, s30, v49
v_mul_f32 v28, s26, v28
v_mfma_f32_16x16x32_bf16 v[84:87], a[104:107], a[8:11], v[84:87]
s_add_u32 s29, s23, 9216
ds_read_b128 a[232:235], v22 offset:10240
v_mfma_f32_16x16x32_bf16 v[84:87], a[100:103], a[4:7], v[84:87]
buffer_store_dwordx4 a[236:239], v19, s[16:19], s29 offen nt
v_mfma_f32_16x16x32_bf16 v[84:87], a[96:99], a[0:3], v[84:87]
v_exp_f32 v80, v80
v_mfma_f32_16x16x32_bf16 v[88:91], a[112:115], a[0:3], v[52:55]
v_exp_f32 v81, v81
v_mfma_f32_16x16x32_bf16 v[88:91], a[116:119], a[4:7], v[88:91]
v_exp_f32 v82, v82
v_mfma_f32_16x16x32_bf16 v[88:91], a[120:123], a[8:11], v[88:91]
v_exp_f32 v83, v83
v_mfma_f32_16x16x32_bf16 v[88:91], a[124:127], a[12:15], v[88:91]
v_exp_f32 v84, v84
v_mfma_f32_16x16x32_bf16 v[92:95], a[140:143], a[12:15], v[52:55]
v_exp_f32 v85, v85
v_mfma_f32_16x16x32_bf16 v[92:95], a[136:139], a[8:11], v[92:95]
v_exp_f32 v86, v86
v_mfma_f32_16x16x32_bf16 v[92:95], a[132:135], a[4:7], v[92:95]
v_exp_f32 v87, v87
v_mfma_f32_16x16x32_bf16 v[92:95], a[128:131], a[0:3], v[92:95]
v_exp_f32 v88, v88
v_smfmac_f32_16x16x64_bf16 a[224:227], a[228:231], v[72:79], v0
v_mul_f32 v29, s26, v29
v_mfma_f32_16x16x32_bf16 v[224:227], a[148:151], v[76:79], v[224:227]
v_exp_f32 v89, v89
v_mfma_f32_16x16x32_bf16 v[224:227], a[144:147], v[72:75], v[224:227]
s_add_u32 m0, s21, 69632
ds_read_b64_tr_b16 a[144:145], v8 offset:0
ds_read_b64_tr_b16 a[146:147], v8 offset:4096
v_mfma_f32_16x16x32_bf16 v[228:231], a[152:155], v[72:75], v[228:231]
buffer_load_dwordx4 v17, s[12:15], s20 offen nt lds
v_mfma_f32_16x16x32_bf16 v[228:231], a[156:159], v[76:79], v[228:231]
s_add_u32 s20, s20, 4096
v_exp_f32 v90, v90
v_mfma_f32_16x16x32_bf16 v[232:235], a[164:167], v[76:79], v[232:235]
ds_read_b64_tr_b16 a[148:149], v8 offset:8192
ds_read_b64_tr_b16 a[150:151], v8 offset:12288
v_mfma_f32_16x16x32_bf16 v[232:235], a[160:163], v[72:75], v[232:235]
v_exp_f32 v91, v91
v_mfma_f32_16x16x32_bf16 v[236:239], a[168:171], v[72:75], v[236:239]
ds_read_b64_tr_b16 a[152:153], v9 offset:0
ds_read_b64_tr_b16 a[154:155], v9 offset:4096
v_mfma_f32_16x16x32_bf16 v[236:239], a[172:175], v[76:79], v[236:239]
v_exp_f32 v92, v92
v_mfma_f32_16x16x32_bf16 v[240:243], a[180:183], v[76:79], v[240:243]
ds_read_b64_tr_b16 a[156:157], v9 offset:8192
ds_read_b64_tr_b16 a[158:159], v9 offset:12288
v_mfma_f32_16x16x32_bf16 v[240:243], a[176:179], v[72:75], v[240:243]
v_exp_f32 v93, v93
v_mfma_f32_16x16x32_bf16 v[244:247], a[184:187], v[72:75], v[244:247]
ds_read_b64_tr_b16 a[160:161], v10 offset:0
ds_read_b64_tr_b16 a[162:163], v10 offset:4096
v_mfma_f32_16x16x32_bf16 v[244:247], a[188:191], v[76:79], v[244:247]
v_exp_f32 v94, v94
v_mfma_f32_16x16x32_bf16 v[248:251], a[196:199], v[76:79], v[248:251]
ds_read_b64_tr_b16 a[164:165], v10 offset:8192
ds_read_b64_tr_b16 a[166:167], v10 offset:12288
v_mfma_f32_16x16x32_bf16 v[248:251], a[192:195], v[72:75], v[248:251]
v_exp_f32 v95, v95
v_mfma_f32_16x16x32_bf16 v[252:255], a[200:203], v[72:75], v[252:255]
v_cvt_pk_bf16_f32 v72, v80, v81
v_cvt_pk_bf16_f32 v73, v82, v83
v_mfma_f32_16x16x32_bf16 v[252:255], a[204:207], v[76:79], v[252:255]
v_cvt_pk_bf16_f32 v74, v84, v85
v_cvt_pk_bf16_f32 v75, v86, v87
v_mfma_f32_16x16x32_bf16 v[80:83], a[80:83], a[16:19], v[56:59]
v_cvt_pk_bf16_f32 v76, v88, v89
v_cvt_pk_bf16_f32 v77, v90, v91
v_mfma_f32_16x16x32_bf16 v[80:83], a[84:87], a[20:23], v[80:83]
v_cvt_pk_bf16_f32 v78, v92, v93
v_cvt_pk_bf16_f32 v79, v94, v95
v_mfma_f32_16x16x32_bf16 v[80:83], a[88:91], a[24:27], v[80:83]
s_add_u32 m0, s21, 32768
ds_read_b64_tr_b16 a[168:169], v11 offset:0
ds_read_b64_tr_b16 a[170:171], v11 offset:4096
v_mfma_f32_16x16x32_bf16 v[80:83], a[92:95], a[28:31], v[80:83]
buffer_load_dwordx4 v16, s[8:11], s20 offen nt lds
v_mfma_f32_16x16x32_bf16 v[84:87], a[108:111], a[28:31], v[56:59]
ds_read_b64_tr_b16 a[172:173], v11 offset:8192
ds_read_b64_tr_b16 a[174:175], v11 offset:12288
v_mfma_f32_16x16x32_bf16 v[84:87], a[104:107], a[24:27], v[84:87]
ds_read_b64_tr_b16 a[176:177], v12 offset:0
ds_read_b64_tr_b16 a[178:179], v12 offset:4096
v_mfma_f32_16x16x32_bf16 v[84:87], a[100:103], a[20:23], v[84:87]
ds_read_b64_tr_b16 a[180:181], v12 offset:8192
ds_read_b64_tr_b16 a[182:183], v12 offset:12288
v_mfma_f32_16x16x32_bf16 v[84:87], a[96:99], a[16:19], v[84:87]
v_exp_f32 v80, v80
v_mfma_f32_16x16x32_bf16 v[88:91], a[112:115], a[16:19], v[56:59]
v_exp_f32 v81, v81
v_mfma_f32_16x16x32_bf16 v[88:91], a[116:119], a[20:23], v[88:91]
ds_read_b64_tr_b16 a[184:185], v13 offset:0
ds_read_b64_tr_b16 a[186:187], v13 offset:4096
v_mfma_f32_16x16x32_bf16 v[88:91], a[120:123], a[24:27], v[88:91]
v_exp_f32 v82, v82
v_mfma_f32_16x16x32_bf16 v[88:91], a[124:127], a[28:31], v[88:91]
v_exp_f32 v83, v83
v_mfma_f32_16x16x32_bf16 v[92:95], a[140:143], a[28:31], v[56:59]
ds_read_b64_tr_b16 a[188:189], v13 offset:8192
ds_read_b64_tr_b16 a[190:191], v13 offset:12288
v_mfma_f32_16x16x32_bf16 v[92:95], a[136:139], a[24:27], v[92:95]
v_exp_f32 v84, v84
v_mfma_f32_16x16x32_bf16 v[92:95], a[132:135], a[20:23], v[92:95]
v_exp_f32 v85, v85
v_mfma_f32_16x16x32_bf16 v[92:95], a[128:131], a[16:19], v[92:95]
ds_read_b64_tr_b16 a[192:193], v14 offset:0
ds_read_b64_tr_b16 a[194:195], v14 offset:4096
v_smfmac_f32_16x16x64_bf16 a[208:211], a[228:231], v[72:79], v0
s_waitcnt lgkmcnt(14)
v_mul_f32 v30, s26, v30
v_mfma_f32_16x16x32_bf16 v[96:99], a[148:151], v[76:79], v[96:99]
v_exp_f32 v86, v86
v_mfma_f32_16x16x32_bf16 v[96:99], a[144:147], v[72:75], v[96:99]
s_add_u32 m0, s21, 73728
ds_read_b64_tr_b16 a[196:197], v14 offset:8192
ds_read_b64_tr_b16 a[198:199], v14 offset:12288
v_mfma_f32_16x16x32_bf16 v[100:103], a[152:155], v[72:75], v[100:103]
buffer_load_dwordx4 v17, s[12:15], s20 offen nt lds
v_mfma_f32_16x16x32_bf16 v[100:103], a[156:159], v[76:79], v[100:103]
s_add_u32 s20, s20, 4096
ds_read_b64_tr_b16 a[200:201], v15 offset:0
ds_read_b64_tr_b16 a[202:203], v15 offset:4096
v_mfma_f32_16x16x32_bf16 v[104:107], a[164:167], v[76:79], v[104:107]
v_exp_f32 v87, v87
v_mfma_f32_16x16x32_bf16 v[104:107], a[160:163], v[72:75], v[104:107]
s_waitcnt lgkmcnt(4)
v_exp_f32 v88, v88
v_mfma_f32_16x16x32_bf16 v[108:111], a[168:171], v[72:75], v[108:111]
ds_read_b64_tr_b16 a[204:205], v15 offset:8192
ds_read_b64_tr_b16 a[206:207], v15 offset:12288
v_mfma_f32_16x16x32_bf16 v[108:111], a[172:175], v[76:79], v[108:111]
v_exp_f32 v89, v89
v_mfma_f32_16x16x32_bf16 v[112:115], a[180:183], v[76:79], v[112:115]
v_exp_f32 v90, v90
v_mfma_f32_16x16x32_bf16 v[112:115], a[176:179], v[72:75], v[112:115]
v_exp_f32 v91, v91
v_mfma_f32_16x16x32_bf16 v[116:119], a[184:187], v[72:75], v[116:119]
v_exp_f32 v92, v92
v_mfma_f32_16x16x32_bf16 v[116:119], a[188:191], v[76:79], v[116:119]
s_waitcnt lgkmcnt(0)
v_exp_f32 v93, v93
v_mfma_f32_16x16x32_bf16 v[120:123], a[196:199], v[76:79], v[120:123]
v_exp_f32 v94, v94
v_mfma_f32_16x16x32_bf16 v[120:123], a[192:195], v[72:75], v[120:123]
v_exp_f32 v95, v95
v_mfma_f32_16x16x32_bf16 v[124:127], a[200:203], v[72:75], v[124:127]
v_cvt_pk_bf16_f32 v72, v80, v81
v_cvt_pk_bf16_f32 v73, v82, v83
v_mfma_f32_16x16x32_bf16 v[124:127], a[204:207], v[76:79], v[124:127]
v_cvt_pk_bf16_f32 v74, v84, v85
v_cvt_pk_bf16_f32 v75, v86, v87
v_mfma_f32_16x16x32_bf16 v[80:83], a[80:83], a[32:35], v[60:63]
v_cvt_pk_bf16_f32 v76, v88, v89
v_cvt_pk_bf16_f32 v77, v90, v91
v_mfma_f32_16x16x32_bf16 v[80:83], a[84:87], a[36:39], v[80:83]
v_cvt_pk_bf16_f32 v78, v92, v93
v_cvt_pk_bf16_f32 v79, v94, v95
v_mfma_f32_16x16x32_bf16 v[80:83], a[88:91], a[40:43], v[80:83]
s_add_u32 m0, s21, 36864
v_mul_f32 v31, s26, v31
v_cvt_pk_bf16_f32 v48, v28, v29
v_mfma_f32_16x16x32_bf16 v[80:83], a[92:95], a[44:47], v[80:83]
buffer_load_dwordx4 v16, s[8:11], s20 offen nt lds
v_mfma_f32_16x16x32_bf16 v[84:87], a[108:111], a[44:47], v[60:63]
v_cvt_pk_bf16_f32 v49, v30, v31
v_lshlrev_b32 v28, 16, v50
v_mfma_f32_16x16x32_bf16 v[84:87], a[104:107], a[40:43], v[84:87]
v_and_b32 v29, s30, v50
v_lshlrev_b32 v30, 16, v51
v_mfma_f32_16x16x32_bf16 v[84:87], a[100:103], a[36:39], v[84:87]
v_and_b32 v31, s30, v51
v_mul_f32 v28, s26, v28
v_mfma_f32_16x16x32_bf16 v[84:87], a[96:99], a[32:35], v[84:87]
v_mul_f32 v29, s26, v29
v_mul_f32 v30, s26, v30
v_mfma_f32_16x16x32_bf16 v[88:91], a[112:115], a[32:35], v[60:63]
v_mul_f32 v31, s26, v31
v_cvt_pk_bf16_f32 v50, v28, v29
v_mfma_f32_16x16x32_bf16 v[88:91], a[116:119], a[36:39], v[88:91]
v_cvt_pk_bf16_f32 v51, v30, v31
v_mfma_f32_16x16x32_bf16 v[88:91], a[120:123], a[40:43], v[88:91]
s_add_u32 s36, s22, 14336
ds_write_b128 v22, v[48:51] offset:9216
v_mfma_f32_16x16x32_bf16 v[88:91], a[124:127], a[44:47], v[88:91]
buffer_load_dwordx4 v[48:51], v20, s[4:7], s36 offen nt
v_mfma_f32_16x16x32_bf16 v[92:95], a[140:143], a[44:47], v[60:63]
v_lshlrev_b32 v28, 16, v32
v_and_b32 v29, s30, v32
v_lshlrev_b32 v30, 16, v33
v_mfma_f32_16x16x32_bf16 v[92:95], a[136:139], a[40:43], v[92:95]
v_and_b32 v31, s30, v33
v_mul_f32 v28, s26, v28
v_mfma_f32_16x16x32_bf16 v[92:95], a[132:135], a[36:39], v[92:95]
v_exp_f32 v80, v80
v_mfma_f32_16x16x32_bf16 v[92:95], a[128:131], a[32:35], v[92:95]
v_exp_f32 v81, v81
v_smfmac_f32_16x16x64_bf16 a[212:215], a[228:231], v[72:79], v0
v_mul_f32 v29, s26, v29
v_mfma_f32_16x16x32_bf16 v[128:131], a[148:151], v[76:79], v[128:131]
v_exp_f32 v82, v82
v_mfma_f32_16x16x32_bf16 v[128:131], a[144:147], v[72:75], v[128:131]
v_exp_f32 v83, v83
v_mfma_f32_16x16x32_bf16 v[132:135], a[152:155], v[72:75], v[132:135]
v_exp_f32 v84, v84
v_mfma_f32_16x16x32_bf16 v[132:135], a[156:159], v[76:79], v[132:135]
v_exp_f32 v85, v85
v_mfma_f32_16x16x32_bf16 v[136:139], a[164:167], v[76:79], v[136:139]
v_exp_f32 v86, v86
v_mfma_f32_16x16x32_bf16 v[136:139], a[160:163], v[72:75], v[136:139]
v_exp_f32 v87, v87
v_mfma_f32_16x16x32_bf16 v[140:143], a[168:171], v[72:75], v[140:143]
v_exp_f32 v88, v88
v_mfma_f32_16x16x32_bf16 v[140:143], a[172:175], v[76:79], v[140:143]
v_exp_f32 v89, v89
v_mfma_f32_16x16x32_bf16 v[144:147], a[180:183], v[76:79], v[144:147]
v_exp_f32 v90, v90
v_mfma_f32_16x16x32_bf16 v[144:147], a[176:179], v[72:75], v[144:147]
v_exp_f32 v91, v91
v_mfma_f32_16x16x32_bf16 v[148:151], a[184:187], v[72:75], v[148:151]
v_exp_f32 v92, v92
v_mfma_f32_16x16x32_bf16 v[148:151], a[188:191], v[76:79], v[148:151]
v_exp_f32 v93, v93
v_mfma_f32_16x16x32_bf16 v[152:155], a[196:199], v[76:79], v[152:155]
v_exp_f32 v94, v94
v_mfma_f32_16x16x32_bf16 v[152:155], a[192:195], v[72:75], v[152:155]
v_exp_f32 v95, v95
v_mfma_f32_16x16x32_bf16 v[156:159], a[200:203], v[72:75], v[156:159]
v_cvt_pk_bf16_f32 v72, v80, v81
v_cvt_pk_bf16_f32 v73, v82, v83
v_mfma_f32_16x16x32_bf16 v[156:159], a[204:207], v[76:79], v[156:159]
v_cvt_pk_bf16_f32 v74, v84, v85
v_cvt_pk_bf16_f32 v75, v86, v87
v_mfma_f32_16x16x32_bf16 v[80:83], a[80:83], a[48:51], v[64:67]
v_cvt_pk_bf16_f32 v76, v88, v89
v_cvt_pk_bf16_f32 v77, v90, v91
v_mfma_f32_16x16x32_bf16 v[80:83], a[84:87], a[52:55], v[80:83]
v_cvt_pk_bf16_f32 v78, v92, v93
v_cvt_pk_bf16_f32 v79, v94, v95
v_mfma_f32_16x16x32_bf16 v[80:83], a[88:91], a[56:59], v[80:83]
s_add_u32 m0, s21, 77824
v_mul_f32 v30, s26, v30
v_mul_f32 v31, s26, v31
v_mfma_f32_16x16x32_bf16 v[80:83], a[92:95], a[60:63], v[80:83]
buffer_load_dwordx4 v17, s[12:15], s20 offen nt lds
v_mfma_f32_16x16x32_bf16 v[84:87], a[108:111], a[60:63], v[64:67]
s_add_u32 s20, s20, 4096
v_cvt_pk_bf16_f32 v32, v28, v29
v_cvt_pk_bf16_f32 v33, v30, v31
v_mfma_f32_16x16x32_bf16 v[84:87], a[104:107], a[56:59], v[84:87]
v_lshlrev_b32 v28, 16, v34
v_and_b32 v29, s30, v34
v_mfma_f32_16x16x32_bf16 v[84:87], a[100:103], a[52:55], v[84:87]
s_add_u32 s29, s23, 10240
ds_read_b128 a[236:239], v22 offset:11264
v_mfma_f32_16x16x32_bf16 v[84:87], a[96:99], a[48:51], v[84:87]
buffer_store_dwordx4 a[232:235], v20, s[16:19], s29 offen nt
v_mfma_f32_16x16x32_bf16 v[88:91], a[112:115], a[48:51], v[64:67]
v_lshlrev_b32 v30, 16, v35
v_and_b32 v31, s30, v35
v_mfma_f32_16x16x32_bf16 v[88:91], a[116:119], a[52:55], v[88:91]
v_mul_f32 v28, s26, v28
v_mul_f32 v29, s26, v29
v_mfma_f32_16x16x32_bf16 v[88:91], a[120:123], a[56:59], v[88:91]
v_mul_f32 v30, s26, v30
v_mul_f32 v31, s26, v31
v_mfma_f32_16x16x32_bf16 v[88:91], a[124:127], a[60:63], v[88:91]
v_cvt_pk_bf16_f32 v34, v28, v29
v_cvt_pk_bf16_f32 v35, v30, v31
v_mfma_f32_16x16x32_bf16 v[92:95], a[140:143], a[60:63], v[64:67]
s_add_u32 s36, s22, 15360
ds_write_b128 v22, v[32:35] offset:10240
v_mfma_f32_16x16x32_bf16 v[92:95], a[136:139], a[56:59], v[92:95]
buffer_load_dwordx4 v[32:35], v21, s[4:7], s36 offen nt
v_mfma_f32_16x16x32_bf16 v[92:95], a[132:135], a[52:55], v[92:95]
v_exp_f32 v80, v80
v_mfma_f32_16x16x32_bf16 v[92:95], a[128:131], a[48:51], v[92:95]
v_exp_f32 v81, v81
v_smfmac_f32_16x16x64_bf16 a[216:219], a[228:231], v[72:79], v0
v_lshlrev_b32 v28, 16, v36
v_mfma_f32_16x16x32_bf16 v[160:163], a[148:151], v[76:79], v[160:163]
v_exp_f32 v82, v82
v_mfma_f32_16x16x32_bf16 v[160:163], a[144:147], v[72:75], v[160:163]
v_exp_f32 v83, v83
v_mfma_f32_16x16x32_bf16 v[164:167], a[152:155], v[72:75], v[164:167]
v_exp_f32 v84, v84
v_mfma_f32_16x16x32_bf16 v[164:167], a[156:159], v[76:79], v[164:167]
v_exp_f32 v85, v85
v_mfma_f32_16x16x32_bf16 v[168:171], a[164:167], v[76:79], v[168:171]
v_exp_f32 v86, v86
v_mfma_f32_16x16x32_bf16 v[168:171], a[160:163], v[72:75], v[168:171]
v_exp_f32 v87, v87
v_mfma_f32_16x16x32_bf16 v[172:175], a[168:171], v[72:75], v[172:175]
v_exp_f32 v88, v88
v_mfma_f32_16x16x32_bf16 v[172:175], a[172:175], v[76:79], v[172:175]
v_exp_f32 v89, v89
v_mfma_f32_16x16x32_bf16 v[176:179], a[180:183], v[76:79], v[176:179]
v_exp_f32 v90, v90
v_mfma_f32_16x16x32_bf16 v[176:179], a[176:179], v[72:75], v[176:179]
v_exp_f32 v91, v91
v_mfma_f32_16x16x32_bf16 v[180:183], a[184:187], v[72:75], v[180:183]
v_exp_f32 v92, v92
v_mfma_f32_16x16x32_bf16 v[180:183], a[188:191], v[76:79], v[180:183]
v_exp_f32 v93, v93
v_mfma_f32_16x16x32_bf16 v[184:187], a[196:199], v[76:79], v[184:187]
v_exp_f32 v94, v94
v_mfma_f32_16x16x32_bf16 v[184:187], a[192:195], v[72:75], v[184:187]
s_waitcnt vmcnt(7) lgkmcnt(0)
v_exp_f32 v95, v95
v_mfma_f32_16x16x32_bf16 v[188:191], a[200:203], v[72:75], v[188:191]
s_barrier
v_cvt_pk_bf16_f32 v72, v80, v81
v_cvt_pk_bf16_f32 v73, v82, v83
v_mfma_f32_16x16x32_bf16 v[188:191], a[204:207], v[76:79], v[188:191]
v_cvt_pk_bf16_f32 v74, v84, v85
v_cvt_pk_bf16_f32 v75, v86, v87
v_mfma_f32_16x16x32_bf16 v[80:83], a[80:83], a[64:67], v[68:71]
v_cvt_pk_bf16_f32 v76, v88, v89
v_cvt_pk_bf16_f32 v77, v90, v91
v_mfma_f32_16x16x32_bf16 v[80:83], a[84:87], a[68:71], v[80:83]
v_cvt_pk_bf16_f32 v78, v92, v93
v_cvt_pk_bf16_f32 v79, v94, v95
v_mfma_f32_16x16x32_bf16 v[80:83], a[88:91], a[72:75], v[80:83]
s_add_u32 m0, s21, 0
ds_read_b128 a[80:83], v4 offset:16384
ds_read_b128 a[84:87], v5 offset:16384
v_mfma_f32_16x16x32_bf16 v[80:83], a[92:95], a[76:79], v[80:83]
buffer_load_dwordx4 v16, s[8:11], s20 offen nt lds
v_mfma_f32_16x16x32_bf16 v[84:87], a[108:111], a[76:79], v[68:71]
ds_read_b128 a[88:91], v6 offset:16384
ds_read_b128 a[92:95], v7 offset:16384
v_mfma_f32_16x16x32_bf16 v[84:87], a[104:107], a[72:75], v[84:87]
v_and_b32 v29, s30, v36
v_lshlrev_b32 v30, 16, v37
v_and_b32 v31, s30, v37
v_mfma_f32_16x16x32_bf16 v[84:87], a[100:103], a[68:71], v[84:87]
ds_read_b128 a[108:111], v7 offset:20480
ds_read_b128 a[104:107], v6 offset:20480
v_mfma_f32_16x16x32_bf16 v[84:87], a[96:99], a[64:67], v[84:87]
v_exp_f32 v80, v80
v_mfma_f32_16x16x32_bf16 v[88:91], a[112:115], a[64:67], v[68:71]
v_exp_f32 v81, v81
v_mfma_f32_16x16x32_bf16 v[88:91], a[116:119], a[68:71], v[88:91]
ds_read_b128 a[100:103], v5 offset:20480
ds_read_b128 a[96:99], v4 offset:20480
v_mfma_f32_16x16x32_bf16 v[88:91], a[120:123], a[72:75], v[88:91]
v_exp_f32 v82, v82
v_mfma_f32_16x16x32_bf16 v[88:91], a[124:127], a[76:79], v[88:91]
v_exp_f32 v83, v83
v_mfma_f32_16x16x32_bf16 v[92:95], a[140:143], a[76:79], v[68:71]
v_exp_f32 v84, v84
v_mfma_f32_16x16x32_bf16 v[92:95], a[136:139], a[72:75], v[92:95]
s_add_u32 m0, s21, 40960
ds_read_b128 a[112:115], v4 offset:24576
ds_read_b128 a[116:119], v5 offset:24576
v_mfma_f32_16x16x32_bf16 v[92:95], a[132:135], a[68:71], v[92:95]
buffer_load_dwordx4 v17, s[12:15], s20 offen nt lds
v_mfma_f32_16x16x32_bf16 v[92:95], a[128:131], a[64:67], v[92:95]
s_add_u32 s20, s20, 4096
v_exp_f32 v85, v85
v_smfmac_f32_16x16x64_bf16 a[220:223], a[228:231], v[72:79], v0
v_mul_f32 v28, s26, v28
v_mfma_f32_16x16x32_bf16 v[192:195], a[148:151], v[76:79], v[192:195]
ds_read_b128 a[120:123], v6 offset:24576
ds_read_b128 a[124:127], v7 offset:24576
v_mfma_f32_16x16x32_bf16 v[192:195], a[144:147], v[72:75], v[192:195]
v_exp_f32 v86, v86
v_mfma_f32_16x16x32_bf16 v[196:199], a[152:155], v[72:75], v[196:199]
v_exp_f32 v87, v87
v_mfma_f32_16x16x32_bf16 v[196:199], a[156:159], v[76:79], v[196:199]
ds_read_b128 a[140:143], v7 offset:28672
ds_read_b128 a[136:139], v6 offset:28672
v_mfma_f32_16x16x32_bf16 v[200:203], a[164:167], v[76:79], v[200:203]
v_exp_f32 v88, v88
v_mfma_f32_16x16x32_bf16 v[200:203], a[160:163], v[72:75], v[200:203]
v_exp_f32 v89, v89
v_mfma_f32_16x16x32_bf16 v[204:207], a[168:171], v[72:75], v[204:207]
s_add_u32 m0, s21, 4096
ds_read_b128 a[132:135], v5 offset:28672
ds_read_b128 a[128:131], v4 offset:28672
v_mfma_f32_16x16x32_bf16 v[204:207], a[172:175], v[76:79], v[204:207]
buffer_load_dwordx4 v16, s[8:11], s20 offen nt lds
v_mfma_f32_16x16x32_bf16 v[208:211], a[180:183], v[76:79], v[208:211]
v_exp_f32 v90, v90
v_mfma_f32_16x16x32_bf16 v[208:211], a[176:179], v[72:75], v[208:211]
v_exp_f32 v91, v91
v_mfma_f32_16x16x32_bf16 v[212:215], a[184:187], v[72:75], v[212:215]
v_exp_f32 v92, v92
v_mfma_f32_16x16x32_bf16 v[212:215], a[188:191], v[76:79], v[212:215]
v_exp_f32 v93, v93
v_mfma_f32_16x16x32_bf16 v[216:219], a[196:199], v[76:79], v[216:219]
v_exp_f32 v94, v94
v_mfma_f32_16x16x32_bf16 v[216:219], a[192:195], v[72:75], v[216:219]
s_waitcnt lgkmcnt(0)
v_exp_f32 v95, v95
v_mfma_f32_16x16x32_bf16 v[220:223], a[200:203], v[72:75], v[220:223]
v_cvt_pk_bf16_f32 v72, v80, v81
v_cvt_pk_bf16_f32 v73, v82, v83
v_mfma_f32_16x16x32_bf16 v[220:223], a[204:207], v[76:79], v[220:223]
v_cvt_pk_bf16_f32 v74, v84, v85
v_cvt_pk_bf16_f32 v75, v86, v87
v_mfma_f32_16x16x32_bf16 v[80:83], a[80:83], a[0:3], v[52:55]
v_cvt_pk_bf16_f32 v76, v88, v89
v_cvt_pk_bf16_f32 v77, v90, v91
v_mfma_f32_16x16x32_bf16 v[80:83], a[84:87], a[4:7], v[80:83]
v_cvt_pk_bf16_f32 v78, v92, v93
v_cvt_pk_bf16_f32 v79, v94, v95
v_mfma_f32_16x16x32_bf16 v[80:83], a[88:91], a[8:11], v[80:83]
s_add_u32 s29, s23, 11264
ds_read_b128 a[232:235], v22 offset:12288
v_mfma_f32_16x16x32_bf16 v[80:83], a[92:95], a[12:15], v[80:83]
buffer_store_dwordx4 a[236:239], v21, s[16:19], s29 offen nt
v_mfma_f32_16x16x32_bf16 v[84:87], a[108:111], a[12:15], v[52:55]
v_mul_f32 v29, s26, v29
v_mul_f32 v30, s26, v30
v_mfma_f32_16x16x32_bf16 v[84:87], a[104:107], a[8:11], v[84:87]
v_mul_f32 v31, s26, v31
v_cvt_pk_bf16_f32 v36, v28, v29
v_mfma_f32_16x16x32_bf16 v[84:87], a[100:103], a[4:7], v[84:87]
v_cvt_pk_bf16_f32 v37, v30, v31
v_lshlrev_b32 v28, 16, v38
v_mfma_f32_16x16x32_bf16 v[84:87], a[96:99], a[0:3], v[84:87]
v_exp_f32 v80, v80
v_mfma_f32_16x16x32_bf16 v[88:91], a[112:115], a[0:3], v[52:55]
v_exp_f32 v81, v81
v_mfma_f32_16x16x32_bf16 v[88:91], a[116:119], a[4:7], v[88:91]
v_exp_f32 v82, v82
v_mfma_f32_16x16x32_bf16 v[88:91], a[120:123], a[8:11], v[88:91]
v_exp_f32 v83, v83
v_mfma_f32_16x16x32_bf16 v[88:91], a[124:127], a[12:15], v[88:91]
v_exp_f32 v84, v84
v_mfma_f32_16x16x32_bf16 v[92:95], a[140:143], a[12:15], v[52:55]
v_exp_f32 v85, v85
v_mfma_f32_16x16x32_bf16 v[92:95], a[136:139], a[8:11], v[92:95]
v_exp_f32 v86, v86
v_mfma_f32_16x16x32_bf16 v[92:95], a[132:135], a[4:7], v[92:95]
v_exp_f32 v87, v87
v_mfma_f32_16x16x32_bf16 v[92:95], a[128:131], a[0:3], v[92:95]
v_exp_f32 v88, v88
v_smfmac_f32_16x16x64_bf16 a[224:227], a[228:231], v[72:79], v0
v_and_b32 v29, s30, v38
v_mfma_f32_16x16x32_bf16 v[224:227], a[148:151], v[76:79], v[224:227]
v_exp_f32 v89, v89
v_mfma_f32_16x16x32_bf16 v[224:227], a[144:147], v[72:75], v[224:227]
s_add_u32 m0, s21, 45056
ds_read_b64_tr_b16 a[144:145], v8 offset:16384
ds_read_b64_tr_b16 a[146:147], v8 offset:20480
v_mfma_f32_16x16x32_bf16 v[228:231], a[152:155], v[72:75], v[228:231]
buffer_load_dwordx4 v17, s[12:15], s20 offen nt lds
v_mfma_f32_16x16x32_bf16 v[228:231], a[156:159], v[76:79], v[228:231]
s_add_u32 s20, s20, 4096
v_exp_f32 v90, v90
v_mfma_f32_16x16x32_bf16 v[232:235], a[164:167], v[76:79], v[232:235]
ds_read_b64_tr_b16 a[148:149], v8 offset:24576
ds_read_b64_tr_b16 a[150:151], v8 offset:28672
v_mfma_f32_16x16x32_bf16 v[232:235], a[160:163], v[72:75], v[232:235]
v_exp_f32 v91, v91
v_mfma_f32_16x16x32_bf16 v[236:239], a[168:171], v[72:75], v[236:239]
ds_read_b64_tr_b16 a[152:153], v9 offset:16384
ds_read_b64_tr_b16 a[154:155], v9 offset:20480
v_mfma_f32_16x16x32_bf16 v[236:239], a[172:175], v[76:79], v[236:239]
v_exp_f32 v92, v92
v_mfma_f32_16x16x32_bf16 v[240:243], a[180:183], v[76:79], v[240:243]
ds_read_b64_tr_b16 a[156:157], v9 offset:24576
ds_read_b64_tr_b16 a[158:159], v9 offset:28672
v_mfma_f32_16x16x32_bf16 v[240:243], a[176:179], v[72:75], v[240:243]
v_exp_f32 v93, v93
v_mfma_f32_16x16x32_bf16 v[244:247], a[184:187], v[72:75], v[244:247]
ds_read_b64_tr_b16 a[160:161], v10 offset:16384
ds_read_b64_tr_b16 a[162:163], v10 offset:20480
v_mfma_f32_16x16x32_bf16 v[244:247], a[188:191], v[76:79], v[244:247]
v_exp_f32 v94, v94
v_mfma_f32_16x16x32_bf16 v[248:251], a[196:199], v[76:79], v[248:251]
ds_read_b64_tr_b16 a[164:165], v10 offset:24576
ds_read_b64_tr_b16 a[166:167], v10 offset:28672
v_mfma_f32_16x16x32_bf16 v[248:251], a[192:195], v[72:75], v[248:251]
v_exp_f32 v95, v95
v_mfma_f32_16x16x32_bf16 v[252:255], a[200:203], v[72:75], v[252:255]
v_cvt_pk_bf16_f32 v72, v80, v81
v_cvt_pk_bf16_f32 v73, v82, v83
v_mfma_f32_16x16x32_bf16 v[252:255], a[204:207], v[76:79], v[252:255]
v_cvt_pk_bf16_f32 v74, v84, v85
v_cvt_pk_bf16_f32 v75, v86, v87
v_mfma_f32_16x16x32_bf16 v[80:83], a[80:83], a[16:19], v[56:59]
v_cvt_pk_bf16_f32 v76, v88, v89
v_cvt_pk_bf16_f32 v77, v90, v91
v_mfma_f32_16x16x32_bf16 v[80:83], a[84:87], a[20:23], v[80:83]
v_cvt_pk_bf16_f32 v78, v92, v93
v_cvt_pk_bf16_f32 v79, v94, v95
v_mfma_f32_16x16x32_bf16 v[80:83], a[88:91], a[24:27], v[80:83]
s_add_u32 m0, s21, 8192
ds_read_b64_tr_b16 a[168:169], v11 offset:16384
ds_read_b64_tr_b16 a[170:171], v11 offset:20480
v_mfma_f32_16x16x32_bf16 v[80:83], a[92:95], a[28:31], v[80:83]
buffer_load_dwordx4 v16, s[8:11], s20 offen nt lds
v_mfma_f32_16x16x32_bf16 v[84:87], a[108:111], a[28:31], v[56:59]
ds_read_b64_tr_b16 a[172:173], v11 offset:24576
ds_read_b64_tr_b16 a[174:175], v11 offset:28672
v_mfma_f32_16x16x32_bf16 v[84:87], a[104:107], a[24:27], v[84:87]
ds_read_b64_tr_b16 a[176:177], v12 offset:16384
ds_read_b64_tr_b16 a[178:179], v12 offset:20480
v_mfma_f32_16x16x32_bf16 v[84:87], a[100:103], a[20:23], v[84:87]
ds_read_b64_tr_b16 a[180:181], v12 offset:24576
ds_read_b64_tr_b16 a[182:183], v12 offset:28672
v_mfma_f32_16x16x32_bf16 v[84:87], a[96:99], a[16:19], v[84:87]
v_exp_f32 v80, v80
v_mfma_f32_16x16x32_bf16 v[88:91], a[112:115], a[16:19], v[56:59]
v_exp_f32 v81, v81
v_mfma_f32_16x16x32_bf16 v[88:91], a[116:119], a[20:23], v[88:91]
ds_read_b64_tr_b16 a[184:185], v13 offset:16384
ds_read_b64_tr_b16 a[186:187], v13 offset:20480
v_mfma_f32_16x16x32_bf16 v[88:91], a[120:123], a[24:27], v[88:91]
v_exp_f32 v82, v82
v_mfma_f32_16x16x32_bf16 v[88:91], a[124:127], a[28:31], v[88:91]
v_exp_f32 v83, v83
v_mfma_f32_16x16x32_bf16 v[92:95], a[140:143], a[28:31], v[56:59]
ds_read_b64_tr_b16 a[188:189], v13 offset:24576
ds_read_b64_tr_b16 a[190:191], v13 offset:28672
v_mfma_f32_16x16x32_bf16 v[92:95], a[136:139], a[24:27], v[92:95]
v_exp_f32 v84, v84
v_mfma_f32_16x16x32_bf16 v[92:95], a[132:135], a[20:23], v[92:95]
v_exp_f32 v85, v85
v_mfma_f32_16x16x32_bf16 v[92:95], a[128:131], a[16:19], v[92:95]
ds_read_b64_tr_b16 a[192:193], v14 offset:16384
ds_read_b64_tr_b16 a[194:195], v14 offset:20480
v_smfmac_f32_16x16x64_bf16 a[208:211], a[228:231], v[72:79], v0
s_waitcnt lgkmcnt(14)
v_lshlrev_b32 v30, 16, v39
v_mfma_f32_16x16x32_bf16 v[96:99], a[148:151], v[76:79], v[96:99]
v_exp_f32 v86, v86
v_mfma_f32_16x16x32_bf16 v[96:99], a[144:147], v[72:75], v[96:99]
s_add_u32 m0, s21, 49152
ds_read_b64_tr_b16 a[196:197], v14 offset:24576
ds_read_b64_tr_b16 a[198:199], v14 offset:28672
v_mfma_f32_16x16x32_bf16 v[100:103], a[152:155], v[72:75], v[100:103]
buffer_load_dwordx4 v17, s[12:15], s20 offen nt lds
v_mfma_f32_16x16x32_bf16 v[100:103], a[156:159], v[76:79], v[100:103]
s_add_u32 s20, s20, 4096
ds_read_b64_tr_b16 a[200:201], v15 offset:16384
ds_read_b64_tr_b16 a[202:203], v15 offset:20480
v_mfma_f32_16x16x32_bf16 v[104:107], a[164:167], v[76:79], v[104:107]
v_exp_f32 v87, v87
v_mfma_f32_16x16x32_bf16 v[104:107], a[160:163], v[72:75], v[104:107]
s_waitcnt lgkmcnt(4)
v_exp_f32 v88, v88
v_mfma_f32_16x16x32_bf16 v[108:111], a[168:171], v[72:75], v[108:111]
ds_read_b64_tr_b16 a[204:205], v15 offset:24576
ds_read_b64_tr_b16 a[206:207], v15 offset:28672
v_mfma_f32_16x16x32_bf16 v[108:111], a[172:175], v[76:79], v[108:111]
v_exp_f32 v89, v89
v_mfma_f32_16x16x32_bf16 v[112:115], a[180:183], v[76:79], v[112:115]
v_exp_f32 v90, v90
v_mfma_f32_16x16x32_bf16 v[112:115], a[176:179], v[72:75], v[112:115]
v_exp_f32 v91, v91
v_mfma_f32_16x16x32_bf16 v[116:119], a[184:187], v[72:75], v[116:119]
v_exp_f32 v92, v92
v_mfma_f32_16x16x32_bf16 v[116:119], a[188:191], v[76:79], v[116:119]
s_waitcnt lgkmcnt(0)
v_exp_f32 v93, v93
v_mfma_f32_16x16x32_bf16 v[120:123], a[196:199], v[76:79], v[120:123]
v_exp_f32 v94, v94
v_mfma_f32_16x16x32_bf16 v[120:123], a[192:195], v[72:75], v[120:123]
v_exp_f32 v95, v95
v_mfma_f32_16x16x32_bf16 v[124:127], a[200:203], v[72:75], v[124:127]
v_cvt_pk_bf16_f32 v72, v80, v81
v_cvt_pk_bf16_f32 v73, v82, v83
v_mfma_f32_16x16x32_bf16 v[124:127], a[204:207], v[76:79], v[124:127]
v_cvt_pk_bf16_f32 v74, v84, v85
v_cvt_pk_bf16_f32 v75, v86, v87
v_mfma_f32_16x16x32_bf16 v[80:83], a[80:83], a[32:35], v[60:63]
v_cvt_pk_bf16_f32 v76, v88, v89
v_cvt_pk_bf16_f32 v77, v90, v91
v_mfma_f32_16x16x32_bf16 v[80:83], a[84:87], a[36:39], v[80:83]
v_cvt_pk_bf16_f32 v78, v92, v93
v_cvt_pk_bf16_f32 v79, v94, v95
v_mfma_f32_16x16x32_bf16 v[80:83], a[88:91], a[40:43], v[80:83]
s_add_u32 m0, s21, 12288
v_and_b32 v31, s30, v39
v_mul_f32 v28, s26, v28
v_mfma_f32_16x16x32_bf16 v[80:83], a[92:95], a[44:47], v[80:83]
buffer_load_dwordx4 v16, s[8:11], s20 offen nt lds
v_mfma_f32_16x16x32_bf16 v[84:87], a[108:111], a[44:47], v[60:63]
v_mul_f32 v29, s26, v29
v_mul_f32 v30, s26, v30
v_mfma_f32_16x16x32_bf16 v[84:87], a[104:107], a[40:43], v[84:87]
v_mul_f32 v31, s26, v31
v_cvt_pk_bf16_f32 v38, v28, v29
v_mfma_f32_16x16x32_bf16 v[84:87], a[100:103], a[36:39], v[84:87]
v_cvt_pk_bf16_f32 v39, v30, v31
v_mfma_f32_16x16x32_bf16 v[84:87], a[96:99], a[32:35], v[84:87]
s_add_u32 s36, s37, 16384
ds_write_b128 v22, v[36:39] offset:11264
v_mfma_f32_16x16x32_bf16 v[88:91], a[112:115], a[32:35], v[60:63]
buffer_load_dwordx4 v[36:39], v18, s[4:7], s36 offen nt
v_mfma_f32_16x16x32_bf16 v[88:91], a[116:119], a[36:39], v[88:91]
v_lshlrev_b32 v28, 16, v40
v_and_b32 v29, s30, v40
v_lshlrev_b32 v30, 16, v41
v_mfma_f32_16x16x32_bf16 v[88:91], a[120:123], a[40:43], v[88:91]
v_and_b32 v31, s30, v41
v_mul_f32 v28, s26, v28
v_mfma_f32_16x16x32_bf16 v[88:91], a[124:127], a[44:47], v[88:91]
s_add_u32 s29, s23, 12288
ds_read_b128 a[236:239], v22 offset:13312
v_mfma_f32_16x16x32_bf16 v[92:95], a[140:143], a[44:47], v[60:63]
buffer_store_dwordx4 a[232:235], v18, s[16:19], s29 offen nt
v_mfma_f32_16x16x32_bf16 v[92:95], a[136:139], a[40:43], v[92:95]
v_mul_f32 v29, s26, v29
v_mul_f32 v30, s26, v30
v_mfma_f32_16x16x32_bf16 v[92:95], a[132:135], a[36:39], v[92:95]
v_exp_f32 v80, v80
v_mfma_f32_16x16x32_bf16 v[92:95], a[128:131], a[32:35], v[92:95]
v_exp_f32 v81, v81
v_smfmac_f32_16x16x64_bf16 a[212:215], a[228:231], v[72:79], v0
v_mul_f32 v31, s26, v31
v_mfma_f32_16x16x32_bf16 v[128:131], a[148:151], v[76:79], v[128:131]
v_exp_f32 v82, v82
v_mfma_f32_16x16x32_bf16 v[128:131], a[144:147], v[72:75], v[128:131]
v_exp_f32 v83, v83
v_mfma_f32_16x16x32_bf16 v[132:135], a[152:155], v[72:75], v[132:135]
v_exp_f32 v84, v84
v_mfma_f32_16x16x32_bf16 v[132:135], a[156:159], v[76:79], v[132:135]
v_exp_f32 v85, v85
v_mfma_f32_16x16x32_bf16 v[136:139], a[164:167], v[76:79], v[136:139]
v_exp_f32 v86, v86
v_mfma_f32_16x16x32_bf16 v[136:139], a[160:163], v[72:75], v[136:139]
v_exp_f32 v87, v87
v_mfma_f32_16x16x32_bf16 v[140:143], a[168:171], v[72:75], v[140:143]
v_exp_f32 v88, v88
v_mfma_f32_16x16x32_bf16 v[140:143], a[172:175], v[76:79], v[140:143]
v_exp_f32 v89, v89
v_mfma_f32_16x16x32_bf16 v[144:147], a[180:183], v[76:79], v[144:147]
v_exp_f32 v90, v90
v_mfma_f32_16x16x32_bf16 v[144:147], a[176:179], v[72:75], v[144:147]
v_exp_f32 v91, v91
v_mfma_f32_16x16x32_bf16 v[148:151], a[184:187], v[72:75], v[148:151]
v_exp_f32 v92, v92
v_mfma_f32_16x16x32_bf16 v[148:151], a[188:191], v[76:79], v[148:151]
v_exp_f32 v93, v93
v_mfma_f32_16x16x32_bf16 v[152:155], a[196:199], v[76:79], v[152:155]
v_exp_f32 v94, v94
v_mfma_f32_16x16x32_bf16 v[152:155], a[192:195], v[72:75], v[152:155]
v_exp_f32 v95, v95
v_mfma_f32_16x16x32_bf16 v[156:159], a[200:203], v[72:75], v[156:159]
v_cvt_pk_bf16_f32 v72, v80, v81
v_cvt_pk_bf16_f32 v73, v82, v83
v_mfma_f32_16x16x32_bf16 v[156:159], a[204:207], v[76:79], v[156:159]
v_cvt_pk_bf16_f32 v74, v84, v85
v_cvt_pk_bf16_f32 v75, v86, v87
v_mfma_f32_16x16x32_bf16 v[80:83], a[80:83], a[48:51], v[64:67]
v_cvt_pk_bf16_f32 v76, v88, v89
v_cvt_pk_bf16_f32 v77, v90, v91
v_mfma_f32_16x16x32_bf16 v[80:83], a[84:87], a[52:55], v[80:83]
v_cvt_pk_bf16_f32 v78, v92, v93
v_cvt_pk_bf16_f32 v79, v94, v95
v_mfma_f32_16x16x32_bf16 v[80:83], a[88:91], a[56:59], v[80:83]
s_add_u32 m0, s21, 53248
v_cvt_pk_bf16_f32 v40, v28, v29
v_cvt_pk_bf16_f32 v41, v30, v31
v_mfma_f32_16x16x32_bf16 v[80:83], a[92:95], a[60:63], v[80:83]
buffer_load_dwordx4 v17, s[12:15], s20 offen nt lds
v_mfma_f32_16x16x32_bf16 v[84:87], a[108:111], a[60:63], v[64:67]
s_add_u32 s20, s20, 4096
v_lshlrev_b32 v28, 16, v42
v_and_b32 v29, s30, v42
v_mfma_f32_16x16x32_bf16 v[84:87], a[104:107], a[56:59], v[84:87]
v_lshlrev_b32 v30, 16, v43
v_and_b32 v31, s30, v43
v_mfma_f32_16x16x32_bf16 v[84:87], a[100:103], a[52:55], v[84:87]
v_mul_f32 v28, s26, v28
v_mul_f32 v29, s26, v29
v_mfma_f32_16x16x32_bf16 v[84:87], a[96:99], a[48:51], v[84:87]
v_mul_f32 v30, s26, v30
v_mul_f32 v31, s26, v31
v_mfma_f32_16x16x32_bf16 v[88:91], a[112:115], a[48:51], v[64:67]
v_cvt_pk_bf16_f32 v42, v28, v29
v_cvt_pk_bf16_f32 v43, v30, v31
v_mfma_f32_16x16x32_bf16 v[88:91], a[116:119], a[52:55], v[88:91]
s_add_u32 s36, s37, 17408
ds_write_b128 v22, v[40:43] offset:12288
v_mfma_f32_16x16x32_bf16 v[88:91], a[120:123], a[56:59], v[88:91]
buffer_load_dwordx4 v[40:43], v19, s[4:7], s36 offen nt
v_mfma_f32_16x16x32_bf16 v[88:91], a[124:127], a[60:63], v[88:91]
v_lshlrev_b32 v28, 16, v44
v_and_b32 v29, s30, v44
v_lshlrev_b32 v30, 16, v45
v_mfma_f32_16x16x32_bf16 v[92:95], a[140:143], a[60:63], v[64:67]
v_and_b32 v31, s30, v45
v_mul_f32 v28, s26, v28
v_mfma_f32_16x16x32_bf16 v[92:95], a[136:139], a[56:59], v[92:95]
v_mul_f32 v29, s26, v29
v_mul_f32 v30, s26, v30
v_mfma_f32_16x16x32_bf16 v[92:95], a[132:135], a[52:55], v[92:95]
v_exp_f32 v80, v80
v_mfma_f32_16x16x32_bf16 v[92:95], a[128:131], a[48:51], v[92:95]
v_exp_f32 v81, v81
v_smfmac_f32_16x16x64_bf16 a[216:219], a[228:231], v[72:79], v0
v_mul_f32 v31, s26, v31
v_mfma_f32_16x16x32_bf16 v[160:163], a[148:151], v[76:79], v[160:163]
v_exp_f32 v82, v82
v_mfma_f32_16x16x32_bf16 v[160:163], a[144:147], v[72:75], v[160:163]
v_exp_f32 v83, v83
v_mfma_f32_16x16x32_bf16 v[164:167], a[152:155], v[72:75], v[164:167]
v_exp_f32 v84, v84
v_mfma_f32_16x16x32_bf16 v[164:167], a[156:159], v[76:79], v[164:167]
v_exp_f32 v85, v85
v_mfma_f32_16x16x32_bf16 v[168:171], a[164:167], v[76:79], v[168:171]
v_exp_f32 v86, v86
v_mfma_f32_16x16x32_bf16 v[168:171], a[160:163], v[72:75], v[168:171]
v_exp_f32 v87, v87
v_mfma_f32_16x16x32_bf16 v[172:175], a[168:171], v[72:75], v[172:175]
v_exp_f32 v88, v88
v_mfma_f32_16x16x32_bf16 v[172:175], a[172:175], v[76:79], v[172:175]
v_exp_f32 v89, v89
v_mfma_f32_16x16x32_bf16 v[176:179], a[180:183], v[76:79], v[176:179]
v_exp_f32 v90, v90
v_mfma_f32_16x16x32_bf16 v[176:179], a[176:179], v[72:75], v[176:179]
v_exp_f32 v91, v91
v_mfma_f32_16x16x32_bf16 v[180:183], a[184:187], v[72:75], v[180:183]
v_exp_f32 v92, v92
v_mfma_f32_16x16x32_bf16 v[180:183], a[188:191], v[76:79], v[180:183]
v_exp_f32 v93, v93
v_mfma_f32_16x16x32_bf16 v[184:187], a[196:199], v[76:79], v[184:187]
v_exp_f32 v94, v94
v_mfma_f32_16x16x32_bf16 v[184:187], a[192:195], v[72:75], v[184:187]
s_waitcnt vmcnt(7) lgkmcnt(0)
v_exp_f32 v95, v95
v_mfma_f32_16x16x32_bf16 v[188:191], a[200:203], v[72:75], v[188:191]
s_barrier
v_cvt_pk_bf16_f32 v72, v80, v81
v_cvt_pk_bf16_f32 v73, v82, v83
v_mfma_f32_16x16x32_bf16 v[188:191], a[204:207], v[76:79], v[188:191]
v_cvt_pk_bf16_f32 v74, v84, v85
v_cvt_pk_bf16_f32 v75, v86, v87
v_mfma_f32_16x16x32_bf16 v[80:83], a[80:83], a[64:67], v[68:71]
v_cvt_pk_bf16_f32 v76, v88, v89
v_cvt_pk_bf16_f32 v77, v90, v91
v_mfma_f32_16x16x32_bf16 v[80:83], a[84:87], a[68:71], v[80:83]
v_cvt_pk_bf16_f32 v78, v92, v93
v_cvt_pk_bf16_f32 v79, v94, v95
v_mfma_f32_16x16x32_bf16 v[80:83], a[88:91], a[72:75], v[80:83]
s_add_u32 m0, s21, 16384
ds_read_b128 a[80:83], v4 offset:32768
ds_read_b128 a[84:87], v5 offset:32768
v_mfma_f32_16x16x32_bf16 v[80:83], a[92:95], a[76:79], v[80:83]
buffer_load_dwordx4 v16, s[8:11], s20 offen nt lds
v_mfma_f32_16x16x32_bf16 v[84:87], a[108:111], a[76:79], v[68:71]
ds_read_b128 a[88:91], v6 offset:32768
ds_read_b128 a[92:95], v7 offset:32768
v_mfma_f32_16x16x32_bf16 v[84:87], a[104:107], a[72:75], v[84:87]
v_cvt_pk_bf16_f32 v44, v28, v29
v_cvt_pk_bf16_f32 v45, v30, v31
v_mfma_f32_16x16x32_bf16 v[84:87], a[100:103], a[68:71], v[84:87]
ds_read_b128 a[108:111], v7 offset:36864
ds_read_b128 a[104:107], v6 offset:36864
v_mfma_f32_16x16x32_bf16 v[84:87], a[96:99], a[64:67], v[84:87]
v_exp_f32 v80, v80
v_mfma_f32_16x16x32_bf16 v[88:91], a[112:115], a[64:67], v[68:71]
v_exp_f32 v81, v81
v_mfma_f32_16x16x32_bf16 v[88:91], a[116:119], a[68:71], v[88:91]
ds_read_b128 a[100:103], v5 offset:36864
ds_read_b128 a[96:99], v4 offset:36864
v_mfma_f32_16x16x32_bf16 v[88:91], a[120:123], a[72:75], v[88:91]
v_exp_f32 v82, v82
v_mfma_f32_16x16x32_bf16 v[88:91], a[124:127], a[76:79], v[88:91]
v_exp_f32 v83, v83
v_mfma_f32_16x16x32_bf16 v[92:95], a[140:143], a[76:79], v[68:71]
v_exp_f32 v84, v84
v_mfma_f32_16x16x32_bf16 v[92:95], a[136:139], a[72:75], v[92:95]
s_add_u32 m0, s21, 57344
ds_read_b128 a[112:115], v4 offset:0
ds_read_b128 a[116:119], v5 offset:0
v_mfma_f32_16x16x32_bf16 v[92:95], a[132:135], a[68:71], v[92:95]
buffer_load_dwordx4 v17, s[12:15], s20 offen nt lds
v_mfma_f32_16x16x32_bf16 v[92:95], a[128:131], a[64:67], v[92:95]
s_add_u32 s20, s20, 4096
v_exp_f32 v85, v85
v_smfmac_f32_16x16x64_bf16 a[220:223], a[228:231], v[72:79], v0
v_lshlrev_b32 v28, 16, v46
v_mfma_f32_16x16x32_bf16 v[192:195], a[148:151], v[76:79], v[192:195]
ds_read_b128 a[120:123], v6 offset:0
ds_read_b128 a[124:127], v7 offset:0
v_mfma_f32_16x16x32_bf16 v[192:195], a[144:147], v[72:75], v[192:195]
v_exp_f32 v86, v86
v_mfma_f32_16x16x32_bf16 v[196:199], a[152:155], v[72:75], v[196:199]
v_exp_f32 v87, v87
v_mfma_f32_16x16x32_bf16 v[196:199], a[156:159], v[76:79], v[196:199]
ds_read_b128 a[140:143], v7 offset:4096
ds_read_b128 a[136:139], v6 offset:4096
v_mfma_f32_16x16x32_bf16 v[200:203], a[164:167], v[76:79], v[200:203]
v_exp_f32 v88, v88
v_mfma_f32_16x16x32_bf16 v[200:203], a[160:163], v[72:75], v[200:203]
v_exp_f32 v89, v89
v_mfma_f32_16x16x32_bf16 v[204:207], a[168:171], v[72:75], v[204:207]
s_add_u32 m0, s21, 20480
ds_read_b128 a[132:135], v5 offset:4096
ds_read_b128 a[128:131], v4 offset:4096
v_mfma_f32_16x16x32_bf16 v[204:207], a[172:175], v[76:79], v[204:207]
buffer_load_dwordx4 v16, s[8:11], s20 offen nt lds
v_mfma_f32_16x16x32_bf16 v[208:211], a[180:183], v[76:79], v[208:211]
v_exp_f32 v90, v90
v_mfma_f32_16x16x32_bf16 v[208:211], a[176:179], v[72:75], v[208:211]
v_exp_f32 v91, v91
v_mfma_f32_16x16x32_bf16 v[212:215], a[184:187], v[72:75], v[212:215]
v_exp_f32 v92, v92
v_mfma_f32_16x16x32_bf16 v[212:215], a[188:191], v[76:79], v[212:215]
v_exp_f32 v93, v93
v_mfma_f32_16x16x32_bf16 v[216:219], a[196:199], v[76:79], v[216:219]
v_exp_f32 v94, v94
v_mfma_f32_16x16x32_bf16 v[216:219], a[192:195], v[72:75], v[216:219]
s_waitcnt lgkmcnt(0)
v_exp_f32 v95, v95
v_mfma_f32_16x16x32_bf16 v[220:223], a[200:203], v[72:75], v[220:223]
v_cvt_pk_bf16_f32 v72, v80, v81
v_cvt_pk_bf16_f32 v73, v82, v83
v_mfma_f32_16x16x32_bf16 v[220:223], a[204:207], v[76:79], v[220:223]
v_cvt_pk_bf16_f32 v74, v84, v85
v_cvt_pk_bf16_f32 v75, v86, v87
v_mfma_f32_16x16x32_bf16 v[80:83], a[80:83], a[0:3], v[52:55]
v_cvt_pk_bf16_f32 v76, v88, v89
v_cvt_pk_bf16_f32 v77, v90, v91
v_mfma_f32_16x16x32_bf16 v[80:83], a[84:87], a[4:7], v[80:83]
v_cvt_pk_bf16_f32 v78, v92, v93
v_cvt_pk_bf16_f32 v79, v94, v95
v_mfma_f32_16x16x32_bf16 v[80:83], a[88:91], a[8:11], v[80:83]
s_add_u32 s29, s23, 13312
ds_read_b128 a[232:235], v22 offset:14336
v_mfma_f32_16x16x32_bf16 v[80:83], a[92:95], a[12:15], v[80:83]
buffer_store_dwordx4 a[236:239], v19, s[16:19], s29 offen nt
v_mfma_f32_16x16x32_bf16 v[84:87], a[108:111], a[12:15], v[52:55]
v_and_b32 v29, s30, v46
v_lshlrev_b32 v30, 16, v47
v_mfma_f32_16x16x32_bf16 v[84:87], a[104:107], a[8:11], v[84:87]
v_and_b32 v31, s30, v47
v_mul_f32 v28, s26, v28
v_mfma_f32_16x16x32_bf16 v[84:87], a[100:103], a[4:7], v[84:87]
v_mul_f32 v29, s26, v29
v_mul_f32 v30, s26, v30
v_mfma_f32_16x16x32_bf16 v[84:87], a[96:99], a[0:3], v[84:87]
v_exp_f32 v80, v80
v_mfma_f32_16x16x32_bf16 v[88:91], a[112:115], a[0:3], v[52:55]
v_exp_f32 v81, v81
v_mfma_f32_16x16x32_bf16 v[88:91], a[116:119], a[4:7], v[88:91]
v_exp_f32 v82, v82
v_mfma_f32_16x16x32_bf16 v[88:91], a[120:123], a[8:11], v[88:91]
v_exp_f32 v83, v83
v_mfma_f32_16x16x32_bf16 v[88:91], a[124:127], a[12:15], v[88:91]
v_exp_f32 v84, v84
v_mfma_f32_16x16x32_bf16 v[92:95], a[140:143], a[12:15], v[52:55]
v_exp_f32 v85, v85
v_mfma_f32_16x16x32_bf16 v[92:95], a[136:139], a[8:11], v[92:95]
v_exp_f32 v86, v86
v_mfma_f32_16x16x32_bf16 v[92:95], a[132:135], a[4:7], v[92:95]
v_exp_f32 v87, v87
v_mfma_f32_16x16x32_bf16 v[92:95], a[128:131], a[0:3], v[92:95]
v_exp_f32 v88, v88
v_smfmac_f32_16x16x64_bf16 a[224:227], a[228:231], v[72:79], v0
v_mul_f32 v31, s26, v31
v_mfma_f32_16x16x32_bf16 v[224:227], a[148:151], v[76:79], v[224:227]
v_exp_f32 v89, v89
v_mfma_f32_16x16x32_bf16 v[224:227], a[144:147], v[72:75], v[224:227]
s_add_u32 m0, s21, 61440
ds_read_b64_tr_b16 a[144:145], v8 offset:32768
ds_read_b64_tr_b16 a[146:147], v8 offset:36864
v_mfma_f32_16x16x32_bf16 v[228:231], a[152:155], v[72:75], v[228:231]
buffer_load_dwordx4 v17, s[12:15], s20 offen nt lds
v_mfma_f32_16x16x32_bf16 v[228:231], a[156:159], v[76:79], v[228:231]
s_add_u32 s20, s20, 4096
v_exp_f32 v90, v90
v_mfma_f32_16x16x32_bf16 v[232:235], a[164:167], v[76:79], v[232:235]
ds_read_b64_tr_b16 a[148:149], v8 offset:0
ds_read_b64_tr_b16 a[150:151], v8 offset:4096
v_mfma_f32_16x16x32_bf16 v[232:235], a[160:163], v[72:75], v[232:235]
v_exp_f32 v91, v91
v_mfma_f32_16x16x32_bf16 v[236:239], a[168:171], v[72:75], v[236:239]
ds_read_b64_tr_b16 a[152:153], v9 offset:32768
ds_read_b64_tr_b16 a[154:155], v9 offset:36864
v_mfma_f32_16x16x32_bf16 v[236:239], a[172:175], v[76:79], v[236:239]
v_exp_f32 v92, v92
v_mfma_f32_16x16x32_bf16 v[240:243], a[180:183], v[76:79], v[240:243]
ds_read_b64_tr_b16 a[156:157], v9 offset:0
ds_read_b64_tr_b16 a[158:159], v9 offset:4096
v_mfma_f32_16x16x32_bf16 v[240:243], a[176:179], v[72:75], v[240:243]
v_exp_f32 v93, v93
v_mfma_f32_16x16x32_bf16 v[244:247], a[184:187], v[72:75], v[244:247]
ds_read_b64_tr_b16 a[160:161], v10 offset:32768
ds_read_b64_tr_b16 a[162:163], v10 offset:36864
v_mfma_f32_16x16x32_bf16 v[244:247], a[188:191], v[76:79], v[244:247]
v_exp_f32 v94, v94
v_mfma_f32_16x16x32_bf16 v[248:251], a[196:199], v[76:79], v[248:251]
ds_read_b64_tr_b16 a[164:165], v10 offset:0
ds_read_b64_tr_b16 a[166:167], v10 offset:4096
v_mfma_f32_16x16x32_bf16 v[248:251], a[192:195], v[72:75], v[248:251]
v_exp_f32 v95, v95
v_mfma_f32_16x16x32_bf16 v[252:255], a[200:203], v[72:75], v[252:255]
v_cvt_pk_bf16_f32 v72, v80, v81
v_cvt_pk_bf16_f32 v73, v82, v83
v_mfma_f32_16x16x32_bf16 v[252:255], a[204:207], v[76:79], v[252:255]
v_cvt_pk_bf16_f32 v74, v84, v85
v_cvt_pk_bf16_f32 v75, v86, v87
v_mfma_f32_16x16x32_bf16 v[80:83], a[80:83], a[16:19], v[56:59]
v_cvt_pk_bf16_f32 v76, v88, v89
v_cvt_pk_bf16_f32 v77, v90, v91
v_mfma_f32_16x16x32_bf16 v[80:83], a[84:87], a[20:23], v[80:83]
v_cvt_pk_bf16_f32 v78, v92, v93
v_cvt_pk_bf16_f32 v79, v94, v95
v_mfma_f32_16x16x32_bf16 v[80:83], a[88:91], a[24:27], v[80:83]
s_add_u32 m0, s21, 24576
ds_read_b64_tr_b16 a[168:169], v11 offset:32768
ds_read_b64_tr_b16 a[170:171], v11 offset:36864
v_mfma_f32_16x16x32_bf16 v[80:83], a[92:95], a[28:31], v[80:83]
buffer_load_dwordx4 v16, s[8:11], s20 offen nt lds
v_mfma_f32_16x16x32_bf16 v[84:87], a[108:111], a[28:31], v[56:59]
ds_read_b64_tr_b16 a[172:173], v11 offset:0
ds_read_b64_tr_b16 a[174:175], v11 offset:4096
v_mfma_f32_16x16x32_bf16 v[84:87], a[104:107], a[24:27], v[84:87]
ds_read_b64_tr_b16 a[176:177], v12 offset:32768
ds_read_b64_tr_b16 a[178:179], v12 offset:36864
v_mfma_f32_16x16x32_bf16 v[84:87], a[100:103], a[20:23], v[84:87]
ds_read_b64_tr_b16 a[180:181], v12 offset:0
ds_read_b64_tr_b16 a[182:183], v12 offset:4096
v_mfma_f32_16x16x32_bf16 v[84:87], a[96:99], a[16:19], v[84:87]
v_exp_f32 v80, v80
v_mfma_f32_16x16x32_bf16 v[88:91], a[112:115], a[16:19], v[56:59]
v_exp_f32 v81, v81
v_mfma_f32_16x16x32_bf16 v[88:91], a[116:119], a[20:23], v[88:91]
ds_read_b64_tr_b16 a[184:185], v13 offset:32768
ds_read_b64_tr_b16 a[186:187], v13 offset:36864
v_mfma_f32_16x16x32_bf16 v[88:91], a[120:123], a[24:27], v[88:91]
v_exp_f32 v82, v82
v_mfma_f32_16x16x32_bf16 v[88:91], a[124:127], a[28:31], v[88:91]
v_exp_f32 v83, v83
v_mfma_f32_16x16x32_bf16 v[92:95], a[140:143], a[28:31], v[56:59]
ds_read_b64_tr_b16 a[188:189], v13 offset:0
ds_read_b64_tr_b16 a[190:191], v13 offset:4096
v_mfma_f32_16x16x32_bf16 v[92:95], a[136:139], a[24:27], v[92:95]
v_exp_f32 v84, v84
v_mfma_f32_16x16x32_bf16 v[92:95], a[132:135], a[20:23], v[92:95]
v_exp_f32 v85, v85
v_mfma_f32_16x16x32_bf16 v[92:95], a[128:131], a[16:19], v[92:95]
ds_read_b64_tr_b16 a[192:193], v14 offset:32768
ds_read_b64_tr_b16 a[194:195], v14 offset:36864
v_smfmac_f32_16x16x64_bf16 a[208:211], a[228:231], v[72:79], v0
s_waitcnt lgkmcnt(14)
v_cvt_pk_bf16_f32 v46, v28, v29
v_mfma_f32_16x16x32_bf16 v[96:99], a[148:151], v[76:79], v[96:99]
v_exp_f32 v86, v86
v_mfma_f32_16x16x32_bf16 v[96:99], a[144:147], v[72:75], v[96:99]
s_add_u32 m0, s21, 65536
ds_read_b64_tr_b16 a[196:197], v14 offset:0
ds_read_b64_tr_b16 a[198:199], v14 offset:4096
v_mfma_f32_16x16x32_bf16 v[100:103], a[152:155], v[72:75], v[100:103]
buffer_load_dwordx4 v17, s[12:15], s20 offen nt lds
v_mfma_f32_16x16x32_bf16 v[100:103], a[156:159], v[76:79], v[100:103]
s_add_u32 s20, s20, 4096
ds_read_b64_tr_b16 a[200:201], v15 offset:32768
ds_read_b64_tr_b16 a[202:203], v15 offset:36864
v_mfma_f32_16x16x32_bf16 v[104:107], a[164:167], v[76:79], v[104:107]
v_exp_f32 v87, v87
v_mfma_f32_16x16x32_bf16 v[104:107], a[160:163], v[72:75], v[104:107]
s_waitcnt lgkmcnt(4)
v_exp_f32 v88, v88
v_mfma_f32_16x16x32_bf16 v[108:111], a[168:171], v[72:75], v[108:111]
ds_read_b64_tr_b16 a[204:205], v15 offset:0
ds_read_b64_tr_b16 a[206:207], v15 offset:4096
v_mfma_f32_16x16x32_bf16 v[108:111], a[172:175], v[76:79], v[108:111]
v_exp_f32 v89, v89
v_mfma_f32_16x16x32_bf16 v[112:115], a[180:183], v[76:79], v[112:115]
v_exp_f32 v90, v90
v_mfma_f32_16x16x32_bf16 v[112:115], a[176:179], v[72:75], v[112:115]
v_exp_f32 v91, v91
v_mfma_f32_16x16x32_bf16 v[116:119], a[184:187], v[72:75], v[116:119]
v_exp_f32 v92, v92
v_mfma_f32_16x16x32_bf16 v[116:119], a[188:191], v[76:79], v[116:119]
s_waitcnt lgkmcnt(0)
v_exp_f32 v93, v93
v_mfma_f32_16x16x32_bf16 v[120:123], a[196:199], v[76:79], v[120:123]
v_exp_f32 v94, v94
v_mfma_f32_16x16x32_bf16 v[120:123], a[192:195], v[72:75], v[120:123]
v_exp_f32 v95, v95
v_mfma_f32_16x16x32_bf16 v[124:127], a[200:203], v[72:75], v[124:127]
v_cvt_pk_bf16_f32 v72, v80, v81
v_cvt_pk_bf16_f32 v73, v82, v83
v_mfma_f32_16x16x32_bf16 v[124:127], a[204:207], v[76:79], v[124:127]
v_cvt_pk_bf16_f32 v74, v84, v85
v_cvt_pk_bf16_f32 v75, v86, v87
v_mfma_f32_16x16x32_bf16 v[80:83], a[80:83], a[32:35], v[60:63]
v_cvt_pk_bf16_f32 v76, v88, v89
v_cvt_pk_bf16_f32 v77, v90, v91
v_mfma_f32_16x16x32_bf16 v[80:83], a[84:87], a[36:39], v[80:83]
v_cvt_pk_bf16_f32 v78, v92, v93
v_cvt_pk_bf16_f32 v79, v94, v95
v_mfma_f32_16x16x32_bf16 v[80:83], a[88:91], a[40:43], v[80:83]
s_add_u32 m0, s21, 28672
v_cvt_pk_bf16_f32 v47, v30, v31
v_mfma_f32_16x16x32_bf16 v[80:83], a[92:95], a[44:47], v[80:83]
buffer_load_dwordx4 v16, s[8:11], s20 offen nt lds
v_mfma_f32_16x16x32_bf16 v[84:87], a[108:111], a[44:47], v[60:63]
s_add_u32 s36, s37, 18432
ds_write_b128 v22, v[44:47] offset:13312
v_mfma_f32_16x16x32_bf16 v[84:87], a[104:107], a[40:43], v[84:87]
buffer_load_dwordx4 v[44:47], v20, s[4:7], s36 offen nt
v_mfma_f32_16x16x32_bf16 v[84:87], a[100:103], a[36:39], v[84:87]
v_lshlrev_b32 v28, 16, v48
v_and_b32 v29, s30, v48
v_lshlrev_b32 v30, 16, v49
v_mfma_f32_16x16x32_bf16 v[84:87], a[96:99], a[32:35], v[84:87]
v_and_b32 v31, s30, v49
v_mul_f32 v28, s26, v28
v_mfma_f32_16x16x32_bf16 v[88:91], a[112:115], a[32:35], v[60:63]
s_add_u32 s29, s23, 14336
ds_read_b128 a[236:239], v22 offset:15360
v_mfma_f32_16x16x32_bf16 v[88:91], a[116:119], a[36:39], v[88:91]
buffer_store_dwordx4 a[232:235], v20, s[16:19], s29 offen nt
v_mfma_f32_16x16x32_bf16 v[88:91], a[120:123], a[40:43], v[88:91]
v_mul_f32 v29, s26, v29
v_mul_f32 v30, s26, v30
v_mfma_f32_16x16x32_bf16 v[88:91], a[124:127], a[44:47], v[88:91]
v_mul_f32 v31, s26, v31
v_cvt_pk_bf16_f32 v48, v28, v29
v_mfma_f32_16x16x32_bf16 v[92:95], a[140:143], a[44:47], v[60:63]
v_cvt_pk_bf16_f32 v49, v30, v31
v_lshlrev_b32 v28, 16, v50
v_mfma_f32_16x16x32_bf16 v[92:95], a[136:139], a[40:43], v[92:95]
v_and_b32 v29, s30, v50
v_lshlrev_b32 v30, 16, v51
v_mfma_f32_16x16x32_bf16 v[92:95], a[132:135], a[36:39], v[92:95]
v_exp_f32 v80, v80
v_mfma_f32_16x16x32_bf16 v[92:95], a[128:131], a[32:35], v[92:95]
v_exp_f32 v81, v81
v_smfmac_f32_16x16x64_bf16 a[212:215], a[228:231], v[72:79], v0
v_and_b32 v31, s30, v51
v_mfma_f32_16x16x32_bf16 v[128:131], a[148:151], v[76:79], v[128:131]
v_exp_f32 v82, v82
v_mfma_f32_16x16x32_bf16 v[128:131], a[144:147], v[72:75], v[128:131]
v_exp_f32 v83, v83
v_mfma_f32_16x16x32_bf16 v[132:135], a[152:155], v[72:75], v[132:135]
v_exp_f32 v84, v84
v_mfma_f32_16x16x32_bf16 v[132:135], a[156:159], v[76:79], v[132:135]
v_exp_f32 v85, v85
v_mfma_f32_16x16x32_bf16 v[136:139], a[164:167], v[76:79], v[136:139]
v_exp_f32 v86, v86
v_mfma_f32_16x16x32_bf16 v[136:139], a[160:163], v[72:75], v[136:139]
v_exp_f32 v87, v87
v_mfma_f32_16x16x32_bf16 v[140:143], a[168:171], v[72:75], v[140:143]
v_exp_f32 v88, v88
v_mfma_f32_16x16x32_bf16 v[140:143], a[172:175], v[76:79], v[140:143]
v_exp_f32 v89, v89
v_mfma_f32_16x16x32_bf16 v[144:147], a[180:183], v[76:79], v[144:147]
v_exp_f32 v90, v90
v_mfma_f32_16x16x32_bf16 v[144:147], a[176:179], v[72:75], v[144:147]
v_exp_f32 v91, v91
v_mfma_f32_16x16x32_bf16 v[148:151], a[184:187], v[72:75], v[148:151]
v_exp_f32 v92, v92
v_mfma_f32_16x16x32_bf16 v[148:151], a[188:191], v[76:79], v[148:151]
v_exp_f32 v93, v93
v_mfma_f32_16x16x32_bf16 v[152:155], a[196:199], v[76:79], v[152:155]
v_exp_f32 v94, v94
v_mfma_f32_16x16x32_bf16 v[152:155], a[192:195], v[72:75], v[152:155]
v_exp_f32 v95, v95
v_mfma_f32_16x16x32_bf16 v[156:159], a[200:203], v[72:75], v[156:159]
v_cvt_pk_bf16_f32 v72, v80, v81
v_cvt_pk_bf16_f32 v73, v82, v83
v_mfma_f32_16x16x32_bf16 v[156:159], a[204:207], v[76:79], v[156:159]
v_cvt_pk_bf16_f32 v74, v84, v85
v_cvt_pk_bf16_f32 v75, v86, v87
v_mfma_f32_16x16x32_bf16 v[80:83], a[80:83], a[48:51], v[64:67]
v_cvt_pk_bf16_f32 v76, v88, v89
v_cvt_pk_bf16_f32 v77, v90, v91
v_mfma_f32_16x16x32_bf16 v[80:83], a[84:87], a[52:55], v[80:83]
v_cvt_pk_bf16_f32 v78, v92, v93
v_cvt_pk_bf16_f32 v79, v94, v95
v_mfma_f32_16x16x32_bf16 v[80:83], a[88:91], a[56:59], v[80:83]
s_add_u32 m0, s21, 69632
v_mul_f32 v28, s26, v28
v_mul_f32 v29, s26, v29
v_mfma_f32_16x16x32_bf16 v[80:83], a[92:95], a[60:63], v[80:83]
buffer_load_dwordx4 v17, s[12:15], s20 offen nt lds
v_mfma_f32_16x16x32_bf16 v[84:87], a[108:111], a[60:63], v[64:67]
s_add_u32 s20, s20, 4096
v_mul_f32 v30, s26, v30
v_mul_f32 v31, s26, v31
v_mfma_f32_16x16x32_bf16 v[84:87], a[104:107], a[56:59], v[84:87]
v_cvt_pk_bf16_f32 v50, v28, v29
v_cvt_pk_bf16_f32 v51, v30, v31
v_mfma_f32_16x16x32_bf16 v[84:87], a[100:103], a[52:55], v[84:87]
s_add_u32 s36, s37, 19456
ds_write_b128 v22, v[48:51] offset:14336
v_mfma_f32_16x16x32_bf16 v[84:87], a[96:99], a[48:51], v[84:87]
buffer_load_dwordx4 v[48:51], v21, s[4:7], s36 offen nt
v_mfma_f32_16x16x32_bf16 v[88:91], a[112:115], a[48:51], v[64:67]
s_add_u32 s22, s22, 20447232
v_lshlrev_b32 v28, 16, v32
v_and_b32 v29, s30, v32
v_lshlrev_b32 v30, 16, v33
v_mfma_f32_16x16x32_bf16 v[88:91], a[116:119], a[52:55], v[88:91]
s_add_u32 s37, s22, s24
s_waitcnt lgkmcnt(1)
v_and_b32 v31, s30, v33
v_mul_f32 v28, s26, v28
v_mfma_f32_16x16x32_bf16 v[88:91], a[120:123], a[56:59], v[88:91]
s_add_u32 s29, s23, 15360
ds_read_b128 a[232:235], v22 offset:16384
v_mfma_f32_16x16x32_bf16 v[88:91], a[124:127], a[60:63], v[88:91]
buffer_store_dwordx4 a[236:239], v21, s[16:19], s29 offen nt
v_mfma_f32_16x16x32_bf16 v[92:95], a[140:143], a[60:63], v[64:67]
v_mul_f32 v29, s26, v29
v_mul_f32 v30, s26, v30
v_mfma_f32_16x16x32_bf16 v[92:95], a[136:139], a[56:59], v[92:95]
v_mul_f32 v31, s26, v31
v_cvt_pk_bf16_f32 v32, v28, v29
v_mfma_f32_16x16x32_bf16 v[92:95], a[132:135], a[52:55], v[92:95]
v_exp_f32 v80, v80
v_mfma_f32_16x16x32_bf16 v[92:95], a[128:131], a[48:51], v[92:95]
v_exp_f32 v81, v81
v_smfmac_f32_16x16x64_bf16 a[216:219], a[228:231], v[72:79], v0
v_cvt_pk_bf16_f32 v33, v30, v31
v_mfma_f32_16x16x32_bf16 v[160:163], a[148:151], v[76:79], v[160:163]
v_exp_f32 v82, v82
v_mfma_f32_16x16x32_bf16 v[160:163], a[144:147], v[72:75], v[160:163]
v_exp_f32 v83, v83
v_mfma_f32_16x16x32_bf16 v[164:167], a[152:155], v[72:75], v[164:167]
v_exp_f32 v84, v84
v_mfma_f32_16x16x32_bf16 v[164:167], a[156:159], v[76:79], v[164:167]
v_exp_f32 v85, v85
v_mfma_f32_16x16x32_bf16 v[168:171], a[164:167], v[76:79], v[168:171]
v_exp_f32 v86, v86
v_mfma_f32_16x16x32_bf16 v[168:171], a[160:163], v[72:75], v[168:171]
v_exp_f32 v87, v87
v_mfma_f32_16x16x32_bf16 v[172:175], a[168:171], v[72:75], v[172:175]
v_exp_f32 v88, v88
v_mfma_f32_16x16x32_bf16 v[172:175], a[172:175], v[76:79], v[172:175]
v_exp_f32 v89, v89
v_mfma_f32_16x16x32_bf16 v[176:179], a[180:183], v[76:79], v[176:179]
v_exp_f32 v90, v90
v_mfma_f32_16x16x32_bf16 v[176:179], a[176:179], v[72:75], v[176:179]
v_exp_f32 v91, v91
v_mfma_f32_16x16x32_bf16 v[180:183], a[184:187], v[72:75], v[180:183]
v_exp_f32 v92, v92
v_mfma_f32_16x16x32_bf16 v[180:183], a[188:191], v[76:79], v[180:183]
v_exp_f32 v93, v93
v_mfma_f32_16x16x32_bf16 v[184:187], a[196:199], v[76:79], v[184:187]
v_exp_f32 v94, v94
v_mfma_f32_16x16x32_bf16 v[184:187], a[192:195], v[72:75], v[184:187]
s_waitcnt vmcnt(8) lgkmcnt(0)
v_exp_f32 v95, v95
v_mfma_f32_16x16x32_bf16 v[188:191], a[200:203], v[72:75], v[188:191]
s_barrier
v_cvt_pk_bf16_f32 v72, v80, v81
v_cvt_pk_bf16_f32 v73, v82, v83
v_mfma_f32_16x16x32_bf16 v[188:191], a[204:207], v[76:79], v[188:191]
v_cvt_pk_bf16_f32 v74, v84, v85
v_cvt_pk_bf16_f32 v75, v86, v87
v_mfma_f32_16x16x32_bf16 v[80:83], a[80:83], a[64:67], v[68:71]
v_cvt_pk_bf16_f32 v76, v88, v89
v_cvt_pk_bf16_f32 v77, v90, v91
v_mfma_f32_16x16x32_bf16 v[80:83], a[84:87], a[68:71], v[80:83]
v_cvt_pk_bf16_f32 v78, v92, v93
v_cvt_pk_bf16_f32 v79, v94, v95
v_mfma_f32_16x16x32_bf16 v[80:83], a[88:91], a[72:75], v[80:83]
s_add_u32 m0, s21, 32768
ds_read_b128 a[80:83], v4 offset:8192
ds_read_b128 a[84:87], v5 offset:8192
v_mfma_f32_16x16x32_bf16 v[80:83], a[92:95], a[76:79], v[80:83]
buffer_load_dwordx4 v16, s[8:11], s20 offen nt lds
v_mfma_f32_16x16x32_bf16 v[84:87], a[108:111], a[76:79], v[68:71]
ds_read_b128 a[88:91], v6 offset:8192
ds_read_b128 a[92:95], v7 offset:8192
v_mfma_f32_16x16x32_bf16 v[84:87], a[104:107], a[72:75], v[84:87]
v_lshlrev_b32 v28, 16, v34
v_and_b32 v29, s30, v34
v_mfma_f32_16x16x32_bf16 v[84:87], a[100:103], a[68:71], v[84:87]
ds_read_b128 a[108:111], v7 offset:12288
ds_read_b128 a[104:107], v6 offset:12288
v_mfma_f32_16x16x32_bf16 v[84:87], a[96:99], a[64:67], v[84:87]
v_exp_f32 v80, v80
v_mfma_f32_16x16x32_bf16 v[88:91], a[112:115], a[64:67], v[68:71]
v_exp_f32 v81, v81
v_mfma_f32_16x16x32_bf16 v[88:91], a[116:119], a[68:71], v[88:91]
ds_read_b128 a[100:103], v5 offset:12288
ds_read_b128 a[96:99], v4 offset:12288
v_mfma_f32_16x16x32_bf16 v[88:91], a[120:123], a[72:75], v[88:91]
v_exp_f32 v82, v82
v_mfma_f32_16x16x32_bf16 v[88:91], a[124:127], a[76:79], v[88:91]
v_exp_f32 v83, v83
v_mfma_f32_16x16x32_bf16 v[92:95], a[140:143], a[76:79], v[68:71]
v_exp_f32 v84, v84
v_mfma_f32_16x16x32_bf16 v[92:95], a[136:139], a[72:75], v[92:95]
s_add_u32 m0, s21, 73728
ds_read_b128 a[112:115], v4 offset:16384
ds_read_b128 a[116:119], v5 offset:16384
v_mfma_f32_16x16x32_bf16 v[92:95], a[132:135], a[68:71], v[92:95]
buffer_load_dwordx4 v17, s[12:15], s20 offen nt lds
v_mfma_f32_16x16x32_bf16 v[92:95], a[128:131], a[64:67], v[92:95]
s_add_u32 s20, s20, 4096
v_exp_f32 v85, v85
v_smfmac_f32_16x16x64_bf16 a[220:223], a[228:231], v[72:79], v0
v_lshlrev_b32 v30, 16, v35
v_mfma_f32_16x16x32_bf16 v[192:195], a[148:151], v[76:79], v[192:195]
ds_read_b128 a[120:123], v6 offset:16384
ds_read_b128 a[124:127], v7 offset:16384
v_mfma_f32_16x16x32_bf16 v[192:195], a[144:147], v[72:75], v[192:195]
v_exp_f32 v86, v86
v_mfma_f32_16x16x32_bf16 v[196:199], a[152:155], v[72:75], v[196:199]
v_exp_f32 v87, v87
v_mfma_f32_16x16x32_bf16 v[196:199], a[156:159], v[76:79], v[196:199]
ds_read_b128 a[140:143], v7 offset:20480
ds_read_b128 a[136:139], v6 offset:20480
v_mfma_f32_16x16x32_bf16 v[200:203], a[164:167], v[76:79], v[200:203]
v_exp_f32 v88, v88
v_mfma_f32_16x16x32_bf16 v[200:203], a[160:163], v[72:75], v[200:203]
v_exp_f32 v89, v89
v_mfma_f32_16x16x32_bf16 v[204:207], a[168:171], v[72:75], v[204:207]
s_add_u32 m0, s21, 36864
ds_read_b128 a[132:135], v5 offset:20480
ds_read_b128 a[128:131], v4 offset:20480
v_mfma_f32_16x16x32_bf16 v[204:207], a[172:175], v[76:79], v[204:207]
buffer_load_dwordx4 v16, s[8:11], s20 offen nt lds
v_mfma_f32_16x16x32_bf16 v[208:211], a[180:183], v[76:79], v[208:211]
v_exp_f32 v90, v90
v_mfma_f32_16x16x32_bf16 v[208:211], a[176:179], v[72:75], v[208:211]
v_exp_f32 v91, v91
v_mfma_f32_16x16x32_bf16 v[212:215], a[184:187], v[72:75], v[212:215]
v_exp_f32 v92, v92
v_mfma_f32_16x16x32_bf16 v[212:215], a[188:191], v[76:79], v[212:215]
v_exp_f32 v93, v93
v_mfma_f32_16x16x32_bf16 v[216:219], a[196:199], v[76:79], v[216:219]
v_exp_f32 v94, v94
v_mfma_f32_16x16x32_bf16 v[216:219], a[192:195], v[72:75], v[216:219]
s_waitcnt lgkmcnt(0)
v_exp_f32 v95, v95
v_mfma_f32_16x16x32_bf16 v[220:223], a[200:203], v[72:75], v[220:223]
v_cvt_pk_bf16_f32 v72, v80, v81
v_cvt_pk_bf16_f32 v73, v82, v83
v_mfma_f32_16x16x32_bf16 v[220:223], a[204:207], v[76:79], v[220:223]
v_cvt_pk_bf16_f32 v74, v84, v85
v_cvt_pk_bf16_f32 v75, v86, v87
v_mfma_f32_16x16x32_bf16 v[80:83], a[80:83], a[0:3], v[52:55]
v_cvt_pk_bf16_f32 v76, v88, v89
v_cvt_pk_bf16_f32 v77, v90, v91
v_mfma_f32_16x16x32_bf16 v[80:83], a[84:87], a[4:7], v[80:83]
v_cvt_pk_bf16_f32 v78, v92, v93
v_cvt_pk_bf16_f32 v79, v94, v95
v_mfma_f32_16x16x32_bf16 v[80:83], a[88:91], a[8:11], v[80:83]
v_and_b32 v31, s30, v35
v_mul_f32 v28, s26, v28
v_mfma_f32_16x16x32_bf16 v[80:83], a[92:95], a[12:15], v[80:83]
v_mul_f32 v29, s26, v29
v_mul_f32 v30, s26, v30
v_mfma_f32_16x16x32_bf16 v[84:87], a[108:111], a[12:15], v[52:55]
v_mul_f32 v31, s26, v31
v_cvt_pk_bf16_f32 v34, v28, v29
v_mfma_f32_16x16x32_bf16 v[84:87], a[104:107], a[8:11], v[84:87]
v_cvt_pk_bf16_f32 v35, v30, v31
v_mfma_f32_16x16x32_bf16 v[84:87], a[100:103], a[4:7], v[84:87]
ds_write_b128 v22, v[32:35] offset:15360
v_mfma_f32_16x16x32_bf16 v[84:87], a[96:99], a[0:3], v[84:87]
v_exp_f32 v80, v80
v_mfma_f32_16x16x32_bf16 v[88:91], a[112:115], a[0:3], v[52:55]
v_exp_f32 v81, v81
v_mfma_f32_16x16x32_bf16 v[88:91], a[116:119], a[4:7], v[88:91]
v_exp_f32 v82, v82
v_mfma_f32_16x16x32_bf16 v[88:91], a[120:123], a[8:11], v[88:91]
v_exp_f32 v83, v83
v_mfma_f32_16x16x32_bf16 v[88:91], a[124:127], a[12:15], v[88:91]
v_exp_f32 v84, v84
v_mfma_f32_16x16x32_bf16 v[92:95], a[140:143], a[12:15], v[52:55]
v_exp_f32 v85, v85
v_mfma_f32_16x16x32_bf16 v[92:95], a[136:139], a[8:11], v[92:95]
v_exp_f32 v86, v86
v_mfma_f32_16x16x32_bf16 v[92:95], a[132:135], a[4:7], v[92:95]
v_exp_f32 v87, v87
v_mfma_f32_16x16x32_bf16 v[92:95], a[128:131], a[0:3], v[92:95]
v_exp_f32 v88, v88
v_smfmac_f32_16x16x64_bf16 a[224:227], a[228:231], v[72:79], v0
v_lshlrev_b32 v28, 16, v36
v_mfma_f32_16x16x32_bf16 v[224:227], a[148:151], v[76:79], v[224:227]
v_exp_f32 v89, v89
v_mfma_f32_16x16x32_bf16 v[224:227], a[144:147], v[72:75], v[224:227]
s_add_u32 m0, s21, 77824
ds_read_b64_tr_b16 a[144:145], v8 offset:8192
ds_read_b64_tr_b16 a[146:147], v8 offset:12288
v_mfma_f32_16x16x32_bf16 v[228:231], a[152:155], v[72:75], v[228:231]
buffer_load_dwordx4 v17, s[12:15], s20 offen nt lds
v_mfma_f32_16x16x32_bf16 v[228:231], a[156:159], v[76:79], v[228:231]
s_add_u32 s20, s20, 20291584
v_exp_f32 v90, v90
v_mfma_f32_16x16x32_bf16 v[232:235], a[164:167], v[76:79], v[232:235]
ds_read_b64_tr_b16 a[148:149], v8 offset:16384
ds_read_b64_tr_b16 a[150:151], v8 offset:20480
v_mfma_f32_16x16x32_bf16 v[232:235], a[160:163], v[72:75], v[232:235]
v_exp_f32 v91, v91
v_mfma_f32_16x16x32_bf16 v[236:239], a[168:171], v[72:75], v[236:239]
ds_read_b64_tr_b16 a[152:153], v9 offset:8192
ds_read_b64_tr_b16 a[154:155], v9 offset:12288
v_mfma_f32_16x16x32_bf16 v[236:239], a[172:175], v[76:79], v[236:239]
v_exp_f32 v92, v92
v_mfma_f32_16x16x32_bf16 v[240:243], a[180:183], v[76:79], v[240:243]
ds_read_b64_tr_b16 a[156:157], v9 offset:16384
ds_read_b64_tr_b16 a[158:159], v9 offset:20480
v_mfma_f32_16x16x32_bf16 v[240:243], a[176:179], v[72:75], v[240:243]
v_exp_f32 v93, v93
v_mfma_f32_16x16x32_bf16 v[244:247], a[184:187], v[72:75], v[244:247]
ds_read_b64_tr_b16 a[160:161], v10 offset:8192
ds_read_b64_tr_b16 a[162:163], v10 offset:12288
v_mfma_f32_16x16x32_bf16 v[244:247], a[188:191], v[76:79], v[244:247]
v_exp_f32 v94, v94
v_mfma_f32_16x16x32_bf16 v[248:251], a[196:199], v[76:79], v[248:251]
ds_read_b64_tr_b16 a[164:165], v10 offset:16384
ds_read_b64_tr_b16 a[166:167], v10 offset:20480
v_mfma_f32_16x16x32_bf16 v[248:251], a[192:195], v[72:75], v[248:251]
v_exp_f32 v95, v95
v_mfma_f32_16x16x32_bf16 v[252:255], a[200:203], v[72:75], v[252:255]
v_cvt_pk_bf16_f32 v72, v80, v81
v_cvt_pk_bf16_f32 v73, v82, v83
v_mfma_f32_16x16x32_bf16 v[252:255], a[204:207], v[76:79], v[252:255]
v_cvt_pk_bf16_f32 v74, v84, v85
v_cvt_pk_bf16_f32 v75, v86, v87
v_mfma_f32_16x16x32_bf16 v[80:83], a[80:83], a[16:19], v[56:59]
v_cvt_pk_bf16_f32 v76, v88, v89
v_cvt_pk_bf16_f32 v77, v90, v91
v_mfma_f32_16x16x32_bf16 v[80:83], a[84:87], a[20:23], v[80:83]
v_cvt_pk_bf16_f32 v78, v92, v93
v_cvt_pk_bf16_f32 v79, v94, v95
v_mfma_f32_16x16x32_bf16 v[80:83], a[88:91], a[24:27], v[80:83]
s_add_u32 m0, s21, 0
ds_read_b64_tr_b16 a[168:169], v11 offset:8192
ds_read_b64_tr_b16 a[170:171], v11 offset:12288
v_mfma_f32_16x16x32_bf16 v[80:83], a[92:95], a[28:31], v[80:83]
buffer_load_dwordx4 v16, s[8:11], s20 offen nt lds
v_mfma_f32_16x16x32_bf16 v[84:87], a[108:111], a[28:31], v[56:59]
ds_read_b64_tr_b16 a[172:173], v11 offset:16384
ds_read_b64_tr_b16 a[174:175], v11 offset:20480
v_mfma_f32_16x16x32_bf16 v[84:87], a[104:107], a[24:27], v[84:87]
ds_read_b64_tr_b16 a[176:177], v12 offset:8192
ds_read_b64_tr_b16 a[178:179], v12 offset:12288
v_mfma_f32_16x16x32_bf16 v[84:87], a[100:103], a[20:23], v[84:87]
ds_read_b64_tr_b16 a[180:181], v12 offset:16384
ds_read_b64_tr_b16 a[182:183], v12 offset:20480
v_mfma_f32_16x16x32_bf16 v[84:87], a[96:99], a[16:19], v[84:87]
v_exp_f32 v80, v80
v_mfma_f32_16x16x32_bf16 v[88:91], a[112:115], a[16:19], v[56:59]
v_exp_f32 v81, v81
v_mfma_f32_16x16x32_bf16 v[88:91], a[116:119], a[20:23], v[88:91]
ds_read_b64_tr_b16 a[184:185], v13 offset:8192
ds_read_b64_tr_b16 a[186:187], v13 offset:12288
v_mfma_f32_16x16x32_bf16 v[88:91], a[120:123], a[24:27], v[88:91]
v_exp_f32 v82, v82
v_mfma_f32_16x16x32_bf16 v[88:91], a[124:127], a[28:31], v[88:91]
v_exp_f32 v83, v83
v_mfma_f32_16x16x32_bf16 v[92:95], a[140:143], a[28:31], v[56:59]
ds_read_b64_tr_b16 a[188:189], v13 offset:16384
ds_read_b64_tr_b16 a[190:191], v13 offset:20480
v_mfma_f32_16x16x32_bf16 v[92:95], a[136:139], a[24:27], v[92:95]
v_exp_f32 v84, v84
v_mfma_f32_16x16x32_bf16 v[92:95], a[132:135], a[20:23], v[92:95]
v_exp_f32 v85, v85
v_mfma_f32_16x16x32_bf16 v[92:95], a[128:131], a[16:19], v[92:95]
ds_read_b64_tr_b16 a[192:193], v14 offset:8192
ds_read_b64_tr_b16 a[194:195], v14 offset:12288
v_smfmac_f32_16x16x64_bf16 a[208:211], a[228:231], v[72:79], v0
s_waitcnt lgkmcnt(14)
v_and_b32 v29, s30, v36
v_mfma_f32_16x16x32_bf16 v[96:99], a[148:151], v[76:79], v[96:99]
v_exp_f32 v86, v86
v_mfma_f32_16x16x32_bf16 v[96:99], a[144:147], v[72:75], v[96:99]
s_add_u32 m0, s21, 40960
ds_read_b64_tr_b16 a[196:197], v14 offset:16384
ds_read_b64_tr_b16 a[198:199], v14 offset:20480
v_mfma_f32_16x16x32_bf16 v[100:103], a[152:155], v[72:75], v[100:103]
buffer_load_dwordx4 v17, s[12:15], s20 offen nt lds
v_mfma_f32_16x16x32_bf16 v[100:103], a[156:159], v[76:79], v[100:103]
s_add_u32 s20, s20, 4096
ds_read_b64_tr_b16 a[200:201], v15 offset:8192
ds_read_b64_tr_b16 a[202:203], v15 offset:12288
v_mfma_f32_16x16x32_bf16 v[104:107], a[164:167], v[76:79], v[104:107]
v_exp_f32 v87, v87
v_mfma_f32_16x16x32_bf16 v[104:107], a[160:163], v[72:75], v[104:107]
s_waitcnt lgkmcnt(4)
v_exp_f32 v88, v88
v_mfma_f32_16x16x32_bf16 v[108:111], a[168:171], v[72:75], v[108:111]
ds_read_b64_tr_b16 a[204:205], v15 offset:16384
ds_read_b64_tr_b16 a[206:207], v15 offset:20480
v_mfma_f32_16x16x32_bf16 v[108:111], a[172:175], v[76:79], v[108:111]
v_exp_f32 v89, v89
v_mfma_f32_16x16x32_bf16 v[112:115], a[180:183], v[76:79], v[112:115]
v_exp_f32 v90, v90
v_mfma_f32_16x16x32_bf16 v[112:115], a[176:179], v[72:75], v[112:115]
v_exp_f32 v91, v91
v_mfma_f32_16x16x32_bf16 v[116:119], a[184:187], v[72:75], v[116:119]
v_exp_f32 v92, v92
v_mfma_f32_16x16x32_bf16 v[116:119], a[188:191], v[76:79], v[116:119]
s_waitcnt lgkmcnt(0)
v_exp_f32 v93, v93
v_mfma_f32_16x16x32_bf16 v[120:123], a[196:199], v[76:79], v[120:123]
v_exp_f32 v94, v94
v_mfma_f32_16x16x32_bf16 v[120:123], a[192:195], v[72:75], v[120:123]
v_exp_f32 v95, v95
v_mfma_f32_16x16x32_bf16 v[124:127], a[200:203], v[72:75], v[124:127]
v_cvt_pk_bf16_f32 v72, v80, v81
v_cvt_pk_bf16_f32 v73, v82, v83
v_mfma_f32_16x16x32_bf16 v[124:127], a[204:207], v[76:79], v[124:127]
v_cvt_pk_bf16_f32 v74, v84, v85
v_cvt_pk_bf16_f32 v75, v86, v87
v_mfma_f32_16x16x32_bf16 v[80:83], a[80:83], a[32:35], v[60:63]
v_cvt_pk_bf16_f32 v76, v88, v89
v_cvt_pk_bf16_f32 v77, v90, v91
v_mfma_f32_16x16x32_bf16 v[80:83], a[84:87], a[36:39], v[80:83]
v_cvt_pk_bf16_f32 v78, v92, v93
v_cvt_pk_bf16_f32 v79, v94, v95
v_mfma_f32_16x16x32_bf16 v[80:83], a[88:91], a[40:43], v[80:83]
s_add_u32 m0, s21, 4096
v_lshlrev_b32 v30, 16, v37
v_and_b32 v31, s30, v37
v_mul_f32 v28, s26, v28
v_mfma_f32_16x16x32_bf16 v[80:83], a[92:95], a[44:47], v[80:83]
buffer_load_dwordx4 v16, s[8:11], s20 offen nt lds
v_mfma_f32_16x16x32_bf16 v[84:87], a[108:111], a[44:47], v[60:63]
v_mul_f32 v29, s26, v29
v_mul_f32 v30, s26, v30
v_mfma_f32_16x16x32_bf16 v[84:87], a[104:107], a[40:43], v[84:87]
v_mul_f32 v31, s26, v31
v_cvt_pk_bf16_f32 v36, v28, v29
v_mfma_f32_16x16x32_bf16 v[84:87], a[100:103], a[36:39], v[84:87]
s_add_u32 s29, s38, 16384
ds_read_b128 a[236:239], v22 offset:17408
v_mfma_f32_16x16x32_bf16 v[84:87], a[96:99], a[32:35], v[84:87]
buffer_store_dwordx4 a[232:235], v18, s[16:19], s29 offen nt
v_mfma_f32_16x16x32_bf16 v[88:91], a[112:115], a[32:35], v[60:63]
v_cvt_pk_bf16_f32 v37, v30, v31
v_lshlrev_b32 v28, 16, v38
v_mfma_f32_16x16x32_bf16 v[88:91], a[116:119], a[36:39], v[88:91]
v_and_b32 v29, s30, v38
v_lshlrev_b32 v30, 16, v39
v_mfma_f32_16x16x32_bf16 v[88:91], a[120:123], a[40:43], v[88:91]
v_and_b32 v31, s30, v39
v_mul_f32 v28, s26, v28
v_mfma_f32_16x16x32_bf16 v[88:91], a[124:127], a[44:47], v[88:91]
v_mul_f32 v29, s26, v29
v_mul_f32 v30, s26, v30
v_mfma_f32_16x16x32_bf16 v[92:95], a[140:143], a[44:47], v[60:63]
v_mul_f32 v31, s26, v31
v_cvt_pk_bf16_f32 v38, v28, v29
v_mfma_f32_16x16x32_bf16 v[92:95], a[136:139], a[40:43], v[92:95]
v_cvt_pk_bf16_f32 v39, v30, v31
v_mfma_f32_16x16x32_bf16 v[92:95], a[132:135], a[36:39], v[92:95]
v_exp_f32 v80, v80
v_mfma_f32_16x16x32_bf16 v[92:95], a[128:131], a[32:35], v[92:95]
v_exp_f32 v81, v81
v_smfmac_f32_16x16x64_bf16 a[212:215], a[228:231], v[72:79], v0
ds_write_b128 v22, v[36:39] offset:16384
v_mfma_f32_16x16x32_bf16 v[128:131], a[148:151], v[76:79], v[128:131]
v_exp_f32 v82, v82
v_mfma_f32_16x16x32_bf16 v[128:131], a[144:147], v[72:75], v[128:131]
v_exp_f32 v83, v83
v_mfma_f32_16x16x32_bf16 v[132:135], a[152:155], v[72:75], v[132:135]
v_exp_f32 v84, v84
v_mfma_f32_16x16x32_bf16 v[132:135], a[156:159], v[76:79], v[132:135]
v_exp_f32 v85, v85
v_mfma_f32_16x16x32_bf16 v[136:139], a[164:167], v[76:79], v[136:139]
v_exp_f32 v86, v86
v_mfma_f32_16x16x32_bf16 v[136:139], a[160:163], v[72:75], v[136:139]
v_exp_f32 v87, v87
v_mfma_f32_16x16x32_bf16 v[140:143], a[168:171], v[72:75], v[140:143]
v_exp_f32 v88, v88
v_mfma_f32_16x16x32_bf16 v[140:143], a[172:175], v[76:79], v[140:143]
v_exp_f32 v89, v89
v_mfma_f32_16x16x32_bf16 v[144:147], a[180:183], v[76:79], v[144:147]
v_exp_f32 v90, v90
v_mfma_f32_16x16x32_bf16 v[144:147], a[176:179], v[72:75], v[144:147]
v_exp_f32 v91, v91
v_mfma_f32_16x16x32_bf16 v[148:151], a[184:187], v[72:75], v[148:151]
v_exp_f32 v92, v92
v_mfma_f32_16x16x32_bf16 v[148:151], a[188:191], v[76:79], v[148:151]
v_exp_f32 v93, v93
v_mfma_f32_16x16x32_bf16 v[152:155], a[196:199], v[76:79], v[152:155]
v_exp_f32 v94, v94
v_mfma_f32_16x16x32_bf16 v[152:155], a[192:195], v[72:75], v[152:155]
v_exp_f32 v95, v95
v_mfma_f32_16x16x32_bf16 v[156:159], a[200:203], v[72:75], v[156:159]
v_cvt_pk_bf16_f32 v72, v80, v81
v_cvt_pk_bf16_f32 v73, v82, v83
v_mfma_f32_16x16x32_bf16 v[156:159], a[204:207], v[76:79], v[156:159]
v_cvt_pk_bf16_f32 v74, v84, v85
v_cvt_pk_bf16_f32 v75, v86, v87
v_mfma_f32_16x16x32_bf16 v[80:83], a[80:83], a[48:51], v[64:67]
v_cvt_pk_bf16_f32 v76, v88, v89
v_cvt_pk_bf16_f32 v77, v90, v91
v_mfma_f32_16x16x32_bf16 v[80:83], a[84:87], a[52:55], v[80:83]
v_cvt_pk_bf16_f32 v78, v92, v93
v_cvt_pk_bf16_f32 v79, v94, v95
v_mfma_f32_16x16x32_bf16 v[80:83], a[88:91], a[56:59], v[80:83]
s_add_u32 m0, s21, 45056
v_lshlrev_b32 v28, 16, v40
v_and_b32 v29, s30, v40
v_lshlrev_b32 v30, 16, v41
v_mfma_f32_16x16x32_bf16 v[80:83], a[92:95], a[60:63], v[80:83]
buffer_load_dwordx4 v17, s[12:15], s20 offen nt lds
v_mfma_f32_16x16x32_bf16 v[84:87], a[108:111], a[60:63], v[64:67]
s_add_u32 s20, s20, 4096
v_and_b32 v31, s30, v41
v_mul_f32 v28, s26, v28
v_mfma_f32_16x16x32_bf16 v[84:87], a[104:107], a[56:59], v[84:87]
s_waitcnt lgkmcnt(1)
v_mul_f32 v29, s26, v29
v_mul_f32 v30, s26, v30
v_mfma_f32_16x16x32_bf16 v[84:87], a[100:103], a[52:55], v[84:87]
s_add_u32 s29, s38, 17408
ds_read_b128 a[232:235], v22 offset:18432
v_mfma_f32_16x16x32_bf16 v[84:87], a[96:99], a[48:51], v[84:87]
buffer_store_dwordx4 a[236:239], v19, s[16:19], s29 offen nt
v_mfma_f32_16x16x32_bf16 v[88:91], a[112:115], a[48:51], v[64:67]
v_mul_f32 v31, s26, v31
v_cvt_pk_bf16_f32 v40, v28, v29
v_mfma_f32_16x16x32_bf16 v[88:91], a[116:119], a[52:55], v[88:91]
v_cvt_pk_bf16_f32 v41, v30, v31
v_lshlrev_b32 v28, 16, v42
v_mfma_f32_16x16x32_bf16 v[88:91], a[120:123], a[56:59], v[88:91]
v_and_b32 v29, s30, v42
v_lshlrev_b32 v30, 16, v43
v_mfma_f32_16x16x32_bf16 v[88:91], a[124:127], a[60:63], v[88:91]
v_and_b32 v31, s30, v43
v_mul_f32 v28, s26, v28
v_mfma_f32_16x16x32_bf16 v[92:95], a[140:143], a[60:63], v[64:67]
v_mul_f32 v29, s26, v29
v_mul_f32 v30, s26, v30
v_mfma_f32_16x16x32_bf16 v[92:95], a[136:139], a[56:59], v[92:95]
v_mul_f32 v31, s26, v31
v_cvt_pk_bf16_f32 v42, v28, v29
v_mfma_f32_16x16x32_bf16 v[92:95], a[132:135], a[52:55], v[92:95]
v_exp_f32 v80, v80
v_mfma_f32_16x16x32_bf16 v[92:95], a[128:131], a[48:51], v[92:95]
v_exp_f32 v81, v81
v_smfmac_f32_16x16x64_bf16 a[216:219], a[228:231], v[72:79], v0
v_cvt_pk_bf16_f32 v43, v30, v31
v_mfma_f32_16x16x32_bf16 v[160:163], a[148:151], v[76:79], v[160:163]
v_exp_f32 v82, v82
v_mfma_f32_16x16x32_bf16 v[160:163], a[144:147], v[72:75], v[160:163]
v_exp_f32 v83, v83
v_mfma_f32_16x16x32_bf16 v[164:167], a[152:155], v[72:75], v[164:167]
v_exp_f32 v84, v84
v_mfma_f32_16x16x32_bf16 v[164:167], a[156:159], v[76:79], v[164:167]
v_exp_f32 v85, v85
v_mfma_f32_16x16x32_bf16 v[168:171], a[164:167], v[76:79], v[168:171]
v_exp_f32 v86, v86
v_mfma_f32_16x16x32_bf16 v[168:171], a[160:163], v[72:75], v[168:171]
v_exp_f32 v87, v87
v_mfma_f32_16x16x32_bf16 v[172:175], a[168:171], v[72:75], v[172:175]
v_exp_f32 v88, v88
v_mfma_f32_16x16x32_bf16 v[172:175], a[172:175], v[76:79], v[172:175]
v_exp_f32 v89, v89
v_mfma_f32_16x16x32_bf16 v[176:179], a[180:183], v[76:79], v[176:179]
v_exp_f32 v90, v90
v_mfma_f32_16x16x32_bf16 v[176:179], a[176:179], v[72:75], v[176:179]
v_exp_f32 v91, v91
v_mfma_f32_16x16x32_bf16 v[180:183], a[184:187], v[72:75], v[180:183]
v_exp_f32 v92, v92
v_mfma_f32_16x16x32_bf16 v[180:183], a[188:191], v[76:79], v[180:183]
v_exp_f32 v93, v93
v_mfma_f32_16x16x32_bf16 v[184:187], a[196:199], v[76:79], v[184:187]
v_exp_f32 v94, v94
v_mfma_f32_16x16x32_bf16 v[184:187], a[192:195], v[72:75], v[184:187]
s_waitcnt vmcnt(6) lgkmcnt(0)
v_exp_f32 v95, v95
v_mfma_f32_16x16x32_bf16 v[188:191], a[200:203], v[72:75], v[188:191]
s_barrier
v_cvt_pk_bf16_f32 v72, v80, v81
v_cvt_pk_bf16_f32 v73, v82, v83
v_mfma_f32_16x16x32_bf16 v[188:191], a[204:207], v[76:79], v[188:191]
v_cvt_pk_bf16_f32 v74, v84, v85
v_cvt_pk_bf16_f32 v75, v86, v87
v_mfma_f32_16x16x32_bf16 v[80:83], a[80:83], a[64:67], v[68:71]
v_cvt_pk_bf16_f32 v76, v88, v89
v_cvt_pk_bf16_f32 v77, v90, v91
v_mfma_f32_16x16x32_bf16 v[80:83], a[84:87], a[68:71], v[80:83]
v_cvt_pk_bf16_f32 v78, v92, v93
v_cvt_pk_bf16_f32 v79, v94, v95
v_mfma_f32_16x16x32_bf16 v[80:83], a[88:91], a[72:75], v[80:83]
s_add_u32 m0, s21, 8192
ds_read_b128 a[80:83], v4 offset:24576
ds_read_b128 a[84:87], v5 offset:24576
v_mfma_f32_16x16x32_bf16 v[80:83], a[92:95], a[76:79], v[80:83]
buffer_load_dwordx4 v16, s[8:11], s20 offen nt lds
v_mfma_f32_16x16x32_bf16 v[84:87], a[108:111], a[76:79], v[68:71]
ds_read_b128 a[88:91], v6 offset:24576
ds_read_b128 a[92:95], v7 offset:24576
v_mfma_f32_16x16x32_bf16 v[84:87], a[104:107], a[72:75], v[84:87]
ds_write_b128 v22, v[40:43] offset:17408
v_mfma_f32_16x16x32_bf16 v[84:87], a[100:103], a[68:71], v[84:87]
ds_read_b128 a[108:111], v7 offset:28672
ds_read_b128 a[104:107], v6 offset:28672
v_mfma_f32_16x16x32_bf16 v[84:87], a[96:99], a[64:67], v[84:87]
v_lshlrev_b32 v28, 16, v44
v_and_b32 v29, s30, v44
v_lshlrev_b32 v30, 16, v45
v_mfma_f32_16x16x32_bf16 v[88:91], a[112:115], a[64:67], v[68:71]
v_exp_f32 v80, v80
v_mfma_f32_16x16x32_bf16 v[88:91], a[116:119], a[68:71], v[88:91]
ds_read_b128 a[100:103], v5 offset:28672
ds_read_b128 a[96:99], v4 offset:28672
v_mfma_f32_16x16x32_bf16 v[88:91], a[120:123], a[72:75], v[88:91]
v_exp_f32 v81, v81
v_mfma_f32_16x16x32_bf16 v[88:91], a[124:127], a[76:79], v[88:91]
v_exp_f32 v82, v82
v_mfma_f32_16x16x32_bf16 v[92:95], a[140:143], a[76:79], v[68:71]
v_exp_f32 v83, v83
v_mfma_f32_16x16x32_bf16 v[92:95], a[136:139], a[72:75], v[92:95]
s_add_u32 m0, s21, 49152
ds_read_b128 a[112:115], v4 offset:32768
ds_read_b128 a[116:119], v5 offset:32768
v_mfma_f32_16x16x32_bf16 v[92:95], a[132:135], a[68:71], v[92:95]
buffer_load_dwordx4 v17, s[12:15], s20 offen nt lds
v_mfma_f32_16x16x32_bf16 v[92:95], a[128:131], a[64:67], v[92:95]
s_add_u32 s20, s20, 4096
v_exp_f32 v84, v84
v_smfmac_f32_16x16x64_bf16 a[220:223], a[228:231], v[72:79], v0
v_and_b32 v31, s30, v45
v_mfma_f32_16x16x32_bf16 v[192:195], a[148:151], v[76:79], v[192:195]
ds_read_b128 a[120:123], v6 offset:32768
ds_read_b128 a[124:127], v7 offset:32768
v_mfma_f32_16x16x32_bf16 v[192:195], a[144:147], v[72:75], v[192:195]
v_exp_f32 v85, v85
v_mfma_f32_16x16x32_bf16 v[196:199], a[152:155], v[72:75], v[196:199]
v_exp_f32 v86, v86
v_mfma_f32_16x16x32_bf16 v[196:199], a[156:159], v[76:79], v[196:199]
ds_read_b128 a[140:143], v7 offset:36864
ds_read_b128 a[136:139], v6 offset:36864
v_mfma_f32_16x16x32_bf16 v[200:203], a[164:167], v[76:79], v[200:203]
v_exp_f32 v87, v87
v_mfma_f32_16x16x32_bf16 v[200:203], a[160:163], v[72:75], v[200:203]
v_exp_f32 v88, v88
v_mfma_f32_16x16x32_bf16 v[204:207], a[168:171], v[72:75], v[204:207]
ds_read_b128 a[132:135], v5 offset:36864
ds_read_b128 a[128:131], v4 offset:36864
v_mfma_f32_16x16x32_bf16 v[204:207], a[172:175], v[76:79], v[204:207]
v_exp_f32 v89, v89
v_mfma_f32_16x16x32_bf16 v[208:211], a[180:183], v[76:79], v[208:211]
v_exp_f32 v90, v90
v_mfma_f32_16x16x32_bf16 v[208:211], a[176:179], v[72:75], v[208:211]
v_exp_f32 v91, v91
v_mfma_f32_16x16x32_bf16 v[212:215], a[184:187], v[72:75], v[212:215]
v_exp_f32 v92, v92
v_mfma_f32_16x16x32_bf16 v[212:215], a[188:191], v[76:79], v[212:215]
v_exp_f32 v93, v93
v_mfma_f32_16x16x32_bf16 v[216:219], a[196:199], v[76:79], v[216:219]
v_exp_f32 v94, v94
v_mfma_f32_16x16x32_bf16 v[216:219], a[192:195], v[72:75], v[216:219]
s_waitcnt lgkmcnt(0)
v_exp_f32 v95, v95
v_mfma_f32_16x16x32_bf16 v[220:223], a[200:203], v[72:75], v[220:223]
v_cvt_pk_bf16_f32 v72, v80, v81
v_cvt_pk_bf16_f32 v73, v82, v83
v_mfma_f32_16x16x32_bf16 v[220:223], a[204:207], v[76:79], v[220:223]
v_cvt_pk_bf16_f32 v74, v84, v85
v_cvt_pk_bf16_f32 v75, v86, v87
v_mfma_f32_16x16x32_bf16 v[80:83], a[80:83], a[0:3], v[52:55]
v_cvt_pk_bf16_f32 v76, v88, v89
v_cvt_pk_bf16_f32 v77, v90, v91
v_mfma_f32_16x16x32_bf16 v[80:83], a[84:87], a[4:7], v[80:83]
v_cvt_pk_bf16_f32 v78, v92, v93
v_cvt_pk_bf16_f32 v79, v94, v95
v_mfma_f32_16x16x32_bf16 v[80:83], a[88:91], a[8:11], v[80:83]
s_add_u32 s29, s38, 18432
ds_read_b128 a[236:239], v22 offset:19456
v_mfma_f32_16x16x32_bf16 v[80:83], a[92:95], a[12:15], v[80:83]
buffer_store_dwordx4 a[232:235], v20, s[16:19], s29 offen nt
v_mfma_f32_16x16x32_bf16 v[84:87], a[108:111], a[12:15], v[52:55]
v_mul_f32 v28, s26, v28
v_mul_f32 v29, s26, v29
v_mfma_f32_16x16x32_bf16 v[84:87], a[104:107], a[8:11], v[84:87]
v_mul_f32 v30, s26, v30
v_mul_f32 v31, s26, v31
v_mfma_f32_16x16x32_bf16 v[84:87], a[100:103], a[4:7], v[84:87]
v_cvt_pk_bf16_f32 v44, v28, v29
v_cvt_pk_bf16_f32 v45, v30, v31
v_mfma_f32_16x16x32_bf16 v[84:87], a[96:99], a[0:3], v[84:87]
v_lshlrev_b32 v28, 16, v46
v_and_b32 v29, s30, v46
v_mfma_f32_16x16x32_bf16 v[88:91], a[112:115], a[0:3], v[52:55]
v_exp_f32 v80, v80
v_mfma_f32_16x16x32_bf16 v[88:91], a[116:119], a[4:7], v[88:91]
v_exp_f32 v81, v81
v_mfma_f32_16x16x32_bf16 v[88:91], a[120:123], a[8:11], v[88:91]
v_exp_f32 v82, v82
v_mfma_f32_16x16x32_bf16 v[88:91], a[124:127], a[12:15], v[88:91]
v_exp_f32 v83, v83
v_mfma_f32_16x16x32_bf16 v[92:95], a[140:143], a[12:15], v[52:55]
v_exp_f32 v84, v84
v_mfma_f32_16x16x32_bf16 v[92:95], a[136:139], a[8:11], v[92:95]
v_exp_f32 v85, v85
v_mfma_f32_16x16x32_bf16 v[92:95], a[132:135], a[4:7], v[92:95]
v_exp_f32 v86, v86
v_mfma_f32_16x16x32_bf16 v[92:95], a[128:131], a[0:3], v[92:95]
v_exp_f32 v87, v87
v_smfmac_f32_16x16x64_bf16 a[224:227], a[228:231], v[72:79], v0
v_lshlrev_b32 v30, 16, v47
v_mfma_f32_16x16x32_bf16 v[224:227], a[148:151], v[76:79], v[224:227]
v_exp_f32 v88, v88
v_mfma_f32_16x16x32_bf16 v[224:227], a[144:147], v[72:75], v[224:227]
ds_read_b64_tr_b16 a[144:145], v8 offset:24576
ds_read_b64_tr_b16 a[146:147], v8 offset:28672
v_mfma_f32_16x16x32_bf16 v[228:231], a[152:155], v[72:75], v[228:231]
v_exp_f32 v89, v89
v_mfma_f32_16x16x32_bf16 v[228:231], a[156:159], v[76:79], v[228:231]
v_exp_f32 v90, v90
v_mfma_f32_16x16x32_bf16 v[232:235], a[164:167], v[76:79], v[232:235]
ds_read_b64_tr_b16 a[148:149], v8 offset:32768
ds_read_b64_tr_b16 a[150:151], v8 offset:36864
v_mfma_f32_16x16x32_bf16 v[232:235], a[160:163], v[72:75], v[232:235]
v_exp_f32 v91, v91
v_mfma_f32_16x16x32_bf16 v[236:239], a[168:171], v[72:75], v[236:239]
ds_read_b64_tr_b16 a[152:153], v9 offset:24576
ds_read_b64_tr_b16 a[154:155], v9 offset:28672
v_mfma_f32_16x16x32_bf16 v[236:239], a[172:175], v[76:79], v[236:239]
v_exp_f32 v92, v92
v_mfma_f32_16x16x32_bf16 v[240:243], a[180:183], v[76:79], v[240:243]
ds_read_b64_tr_b16 a[156:157], v9 offset:32768
ds_read_b64_tr_b16 a[158:159], v9 offset:36864
v_mfma_f32_16x16x32_bf16 v[240:243], a[176:179], v[72:75], v[240:243]
v_exp_f32 v93, v93
v_mfma_f32_16x16x32_bf16 v[244:247], a[184:187], v[72:75], v[244:247]
ds_read_b64_tr_b16 a[160:161], v10 offset:24576
ds_read_b64_tr_b16 a[162:163], v10 offset:28672
v_mfma_f32_16x16x32_bf16 v[244:247], a[188:191], v[76:79], v[244:247]
v_exp_f32 v94, v94
v_mfma_f32_16x16x32_bf16 v[248:251], a[196:199], v[76:79], v[248:251]
ds_read_b64_tr_b16 a[164:165], v10 offset:32768
ds_read_b64_tr_b16 a[166:167], v10 offset:36864
v_mfma_f32_16x16x32_bf16 v[248:251], a[192:195], v[72:75], v[248:251]
v_exp_f32 v95, v95
v_mfma_f32_16x16x32_bf16 v[252:255], a[200:203], v[72:75], v[252:255]
v_cvt_pk_bf16_f32 v72, v80, v81
v_cvt_pk_bf16_f32 v73, v82, v83
v_mfma_f32_16x16x32_bf16 v[252:255], a[204:207], v[76:79], v[252:255]
v_cvt_pk_bf16_f32 v74, v84, v85
v_cvt_pk_bf16_f32 v75, v86, v87
v_mfma_f32_16x16x32_bf16 v[80:83], a[80:83], a[16:19], v[56:59]
v_cvt_pk_bf16_f32 v76, v88, v89
v_cvt_pk_bf16_f32 v77, v90, v91
v_mfma_f32_16x16x32_bf16 v[80:83], a[84:87], a[20:23], v[80:83]
v_cvt_pk_bf16_f32 v78, v92, v93
v_cvt_pk_bf16_f32 v79, v94, v95
v_mfma_f32_16x16x32_bf16 v[80:83], a[88:91], a[24:27], v[80:83]
s_add_u32 m0, s21, 16384
ds_read_b64_tr_b16 a[168:169], v11 offset:24576
ds_read_b64_tr_b16 a[170:171], v11 offset:28672
v_mfma_f32_16x16x32_bf16 v[80:83], a[92:95], a[28:31], v[80:83]
buffer_load_dwordx4 v16, s[8:11], s20 offen nt lds
v_mfma_f32_16x16x32_bf16 v[84:87], a[108:111], a[28:31], v[56:59]
ds_read_b64_tr_b16 a[172:173], v11 offset:32768
ds_read_b64_tr_b16 a[174:175], v11 offset:36864
v_mfma_f32_16x16x32_bf16 v[84:87], a[104:107], a[24:27], v[84:87]
ds_read_b64_tr_b16 a[176:177], v12 offset:24576
ds_read_b64_tr_b16 a[178:179], v12 offset:28672
v_mfma_f32_16x16x32_bf16 v[84:87], a[100:103], a[20:23], v[84:87]
ds_read_b64_tr_b16 a[180:181], v12 offset:32768
ds_read_b64_tr_b16 a[182:183], v12 offset:36864
v_mfma_f32_16x16x32_bf16 v[84:87], a[96:99], a[16:19], v[84:87]
v_exp_f32 v80, v80
v_mfma_f32_16x16x32_bf16 v[88:91], a[112:115], a[16:19], v[56:59]
v_exp_f32 v81, v81
v_mfma_f32_16x16x32_bf16 v[88:91], a[116:119], a[20:23], v[88:91]
ds_read_b64_tr_b16 a[184:185], v13 offset:24576
ds_read_b64_tr_b16 a[186:187], v13 offset:28672
v_mfma_f32_16x16x32_bf16 v[88:91], a[120:123], a[24:27], v[88:91]
v_exp_f32 v82, v82
v_mfma_f32_16x16x32_bf16 v[88:91], a[124:127], a[28:31], v[88:91]
v_exp_f32 v83, v83
v_mfma_f32_16x16x32_bf16 v[92:95], a[140:143], a[28:31], v[56:59]
ds_read_b64_tr_b16 a[188:189], v13 offset:32768
ds_read_b64_tr_b16 a[190:191], v13 offset:36864
v_mfma_f32_16x16x32_bf16 v[92:95], a[136:139], a[24:27], v[92:95]
v_exp_f32 v84, v84
v_mfma_f32_16x16x32_bf16 v[92:95], a[132:135], a[20:23], v[92:95]
v_exp_f32 v85, v85
v_mfma_f32_16x16x32_bf16 v[92:95], a[128:131], a[16:19], v[92:95]
ds_read_b64_tr_b16 a[192:193], v14 offset:24576
ds_read_b64_tr_b16 a[194:195], v14 offset:28672
v_smfmac_f32_16x16x64_bf16 a[208:211], a[228:231], v[72:79], v0
s_waitcnt lgkmcnt(14)
v_and_b32 v31, s30, v47
v_mfma_f32_16x16x32_bf16 v[96:99], a[148:151], v[76:79], v[96:99]
v_exp_f32 v86, v86
v_mfma_f32_16x16x32_bf16 v[96:99], a[144:147], v[72:75], v[96:99]
s_add_u32 m0, s21, 57344
ds_read_b64_tr_b16 a[196:197], v14 offset:32768
ds_read_b64_tr_b16 a[198:199], v14 offset:36864
v_mfma_f32_16x16x32_bf16 v[100:103], a[152:155], v[72:75], v[100:103]
buffer_load_dwordx4 v17, s[12:15], s20 offen nt lds
v_mfma_f32_16x16x32_bf16 v[100:103], a[156:159], v[76:79], v[100:103]
s_add_u32 s20, s20, 4096
ds_read_b64_tr_b16 a[200:201], v15 offset:24576
ds_read_b64_tr_b16 a[202:203], v15 offset:28672
v_mfma_f32_16x16x32_bf16 v[104:107], a[164:167], v[76:79], v[104:107]
v_exp_f32 v87, v87
v_mfma_f32_16x16x32_bf16 v[104:107], a[160:163], v[72:75], v[104:107]
s_waitcnt lgkmcnt(4)
v_exp_f32 v88, v88
v_mfma_f32_16x16x32_bf16 v[108:111], a[168:171], v[72:75], v[108:111]
ds_read_b64_tr_b16 a[204:205], v15 offset:32768
ds_read_b64_tr_b16 a[206:207], v15 offset:36864
v_mfma_f32_16x16x32_bf16 v[108:111], a[172:175], v[76:79], v[108:111]
v_exp_f32 v89, v89
v_mfma_f32_16x16x32_bf16 v[112:115], a[180:183], v[76:79], v[112:115]
v_exp_f32 v90, v90
v_mfma_f32_16x16x32_bf16 v[112:115], a[176:179], v[72:75], v[112:115]
v_exp_f32 v91, v91
v_mfma_f32_16x16x32_bf16 v[116:119], a[184:187], v[72:75], v[116:119]
v_exp_f32 v92, v92
v_mfma_f32_16x16x32_bf16 v[116:119], a[188:191], v[76:79], v[116:119]
s_waitcnt lgkmcnt(0)
v_exp_f32 v93, v93
v_mfma_f32_16x16x32_bf16 v[120:123], a[196:199], v[76:79], v[120:123]
v_exp_f32 v94, v94
v_mfma_f32_16x16x32_bf16 v[120:123], a[192:195], v[72:75], v[120:123]
v_exp_f32 v95, v95
v_mfma_f32_16x16x32_bf16 v[124:127], a[200:203], v[72:75], v[124:127]
s_add_u32 s27, s27, 1
v_cvt_pk_bf16_f32 v72, v80, v81
v_cvt_pk_bf16_f32 v73, v82, v83
v_mfma_f32_16x16x32_bf16 v[124:127], a[204:207], v[76:79], v[124:127]
s_cmp_lt_u32 s27, 4
v_cvt_pk_bf16_f32 v74, v84, v85
v_cvt_pk_bf16_f32 v75, v86, v87
s_cbranch_scc1 REST
v_mfma_f32_16x16x32_bf16 v[80:83], a[80:83], a[32:35], v[60:63]
v_cvt_pk_bf16_f32 v76, v88, v89
v_cvt_pk_bf16_f32 v77, v90, v91
v_mfma_f32_16x16x32_bf16 v[80:83], a[84:87], a[36:39], v[80:83]
v_cvt_pk_bf16_f32 v78, v92, v93
v_cvt_pk_bf16_f32 v79, v94, v95
v_mfma_f32_16x16x32_bf16 v[80:83], a[88:91], a[40:43], v[80:83]
v_xor_b32 v32, 0, v27
v_xor_b32 v33, 32, v27
v_xor_b32 v34, 64, v27
v_xor_b32 v35, 96, v27
v_mfma_f32_16x16x32_bf16 v[80:83], a[92:95], a[44:47], v[80:83]
v_xor_b32 v36, 128, v27
v_xor_b32 v37, 160, v27
v_xor_b32 v38, 192, v27
v_xor_b32 v39, 224, v27
v_mfma_f32_16x16x32_bf16 v[84:87], a[108:111], a[44:47], v[60:63]
s_mov_b32 s86, s33
s_or_b32 s87, s33, s24
v_accvgpr_read_b32 v3, a208
v_accvgpr_read_b32 v2, a209
v_mfma_f32_16x16x32_bf16 v[84:87], a[104:107], a[40:43], v[84:87]
v_accvgpr_write_b32 a208, 0
v_add_f32 v3, v3, v2
v_accvgpr_write_b32 a209, 0
v_cmp_ngt_f32 vcc, s31, v3
v_mfma_f32_16x16x32_bf16 v[84:87], a[100:103], a[36:39], v[84:87]
v_rcp_f32 v3, v3
v_mfma_f32_16x16x32_bf16 v[84:87], a[96:99], a[32:35], v[84:87]
v_mfma_f32_16x16x32_bf16 v[88:91], a[112:115], a[32:35], v[60:63]
v_pk_mul_f32 v[96:97], v[96:97], v[2:3] op_sel:[0,1] op_sel_hi:[1,1]
v_pk_mul_f32 v[98:99], v[98:99], v[2:3] op_sel:[0,1] op_sel_hi:[1,1]
v_pk_mul_f32 v[100:101], v[100:101], v[2:3] op_sel:[0,1] op_sel_hi:[1,1]
v_pk_mul_f32 v[102:103], v[102:103], v[2:3] op_sel:[0,1] op_sel_hi:[1,1]
v_pk_mul_f32 v[104:105], v[104:105], v[2:3] op_sel:[0,1] op_sel_hi:[1,1]
v_pk_mul_f32 v[106:107], v[106:107], v[2:3] op_sel:[0,1] op_sel_hi:[1,1]
v_pk_mul_f32 v[108:109], v[108:109], v[2:3] op_sel:[0,1] op_sel_hi:[1,1]
v_pk_mul_f32 v[110:111], v[110:111], v[2:3] op_sel:[0,1] op_sel_hi:[1,1]
v_pk_mul_f32 v[112:113], v[112:113], v[2:3] op_sel:[0,1] op_sel_hi:[1,1]
v_pk_mul_f32 v[114:115], v[114:115], v[2:3] op_sel:[0,1] op_sel_hi:[1,1]
v_pk_mul_f32 v[116:117], v[116:117], v[2:3] op_sel:[0,1] op_sel_hi:[1,1]
v_pk_mul_f32 v[118:119], v[118:119], v[2:3] op_sel:[0,1] op_sel_hi:[1,1]
v_pk_mul_f32 v[120:121], v[120:121], v[2:3] op_sel:[0,1] op_sel_hi:[1,1]
v_pk_mul_f32 v[122:123], v[122:123], v[2:3] op_sel:[0,1] op_sel_hi:[1,1]
v_pk_mul_f32 v[124:125], v[124:125], v[2:3] op_sel:[0,1] op_sel_hi:[1,1]
v_pk_mul_f32 v[126:127], v[126:127], v[2:3] op_sel:[0,1] op_sel_hi:[1,1]
v_mfma_f32_16x16x32_bf16 v[88:91], a[116:119], a[36:39], v[88:91]
v_mfma_f32_16x16x32_bf16 v[88:91], a[120:123], a[40:43], v[88:91]
v_mfma_f32_16x16x32_bf16 v[88:91], a[124:127], a[44:47], v[88:91]
v_cvt_pk_bf16_f32 v96, v96, v97
v_cvt_pk_bf16_f32 v97, v98, v99
v_mfma_f32_16x16x32_bf16 v[92:95], a[140:143], a[44:47], v[60:63]
ds_write_b64 v32, v[96:97] offset:0
s_or_b64 s[34:35], s[34:35], vcc
v_mfma_f32_16x16x32_bf16 v[92:95], a[136:139], a[40:43], v[92:95]
v_cvt_pk_bf16_f32 v100, v100, v101
v_cvt_pk_bf16_f32 v101, v102, v103
v_mfma_f32_16x16x32_bf16 v[92:95], a[132:135], a[36:39], v[92:95]
ds_write_b64 v33, v[100:101] offset:0
v_exp_f32 v80, v80
v_mfma_f32_16x16x32_bf16 v[92:95], a[128:131], a[32:35], v[92:95]
v_exp_f32 v81, v81
v_cvt_pk_bf16_f32 v104, v104, v105
v_cvt_pk_bf16_f32 v105, v106, v107
v_smfmac_f32_16x16x64_bf16 a[212:215], a[228:231], v[72:79], v0
ds_write_b64 v34, v[104:105] offset:0
v_cvt_pk_bf16_f32 v108, v108, v109
v_mfma_f32_16x16x32_bf16 v[128:131], a[148:151], v[76:79], v[128:131]
v_exp_f32 v82, v82
v_cvt_pk_bf16_f32 v109, v110, v111
v_mfma_f32_16x16x32_bf16 v[128:131], a[144:147], v[72:75], v[128:131]
v_exp_f32 v83, v83
v_mfma_f32_16x16x32_bf16 v[132:135], a[152:155], v[72:75], v[132:135]
ds_write_b64 v35, v[108:109] offset:0
v_exp_f32 v84, v84
v_cvt_pk_bf16_f32 v112, v112, v113
v_mfma_f32_16x16x32_bf16 v[132:135], a[156:159], v[76:79], v[132:135]
v_exp_f32 v85, v85
v_cvt_pk_bf16_f32 v113, v114, v115
v_mfma_f32_16x16x32_bf16 v[136:139], a[164:167], v[76:79], v[136:139]
v_exp_f32 v86, v86
v_mfma_f32_16x16x32_bf16 v[136:139], a[160:163], v[72:75], v[136:139]
ds_write_b64 v36, v[112:113] offset:0
v_exp_f32 v87, v87
v_cvt_pk_bf16_f32 v116, v116, v117
v_cvt_pk_bf16_f32 v117, v118, v119
v_mfma_f32_16x16x32_bf16 v[140:143], a[168:171], v[72:75], v[140:143]
v_exp_f32 v88, v88
v_mfma_f32_16x16x32_bf16 v[140:143], a[172:175], v[76:79], v[140:143]
v_exp_f32 v89, v89
v_mfma_f32_16x16x32_bf16 v[144:147], a[180:183], v[76:79], v[144:147]
ds_write_b64 v37, v[116:117] offset:0
v_exp_f32 v90, v90
v_cvt_pk_bf16_f32 v120, v120, v121
v_cvt_pk_bf16_f32 v121, v122, v123
v_mfma_f32_16x16x32_bf16 v[144:147], a[176:179], v[72:75], v[144:147]
v_exp_f32 v91, v91
v_mfma_f32_16x16x32_bf16 v[148:151], a[184:187], v[72:75], v[148:151]
ds_write_b64 v38, v[120:121] offset:0
v_exp_f32 v92, v92
v_cvt_pk_bf16_f32 v124, v124, v125
v_mfma_f32_16x16x32_bf16 v[148:151], a[188:191], v[76:79], v[148:151]
v_exp_f32 v93, v93
v_cvt_pk_bf16_f32 v125, v126, v127
v_mfma_f32_16x16x32_bf16 v[152:155], a[196:199], v[76:79], v[152:155]
v_exp_f32 v94, v94
v_mfma_f32_16x16x32_bf16 v[152:155], a[192:195], v[72:75], v[152:155]
ds_write_b64 v39, v[124:125] offset:0
v_exp_f32 v95, v95
v_mfma_f32_16x16x32_bf16 v[156:159], a[200:203], v[72:75], v[156:159]
v_cvt_pk_bf16_f32 v72, v80, v81
v_cvt_pk_bf16_f32 v73, v82, v83
v_mfma_f32_16x16x32_bf16 v[156:159], a[204:207], v[76:79], v[156:159]
v_cvt_pk_bf16_f32 v74, v84, v85
v_cvt_pk_bf16_f32 v75, v86, v87
v_mfma_f32_16x16x32_bf16 v[80:83], a[80:83], a[48:51], v[64:67]
v_cvt_pk_bf16_f32 v76, v88, v89
v_cvt_pk_bf16_f32 v77, v90, v91
v_mfma_f32_16x16x32_bf16 v[80:83], a[84:87], a[52:55], v[80:83]
v_cvt_pk_bf16_f32 v78, v92, v93
v_cvt_pk_bf16_f32 v79, v94, v95
v_mfma_f32_16x16x32_bf16 v[80:83], a[88:91], a[56:59], v[80:83]
ds_read_b128 a[0:3], v22 offset:0
ds_read_b128 a[4:7], v22 offset:1024
ds_read_b128 a[8:11], v22 offset:2048
ds_read_b128 a[12:15], v22 offset:3072
v_mfma_f32_16x16x32_bf16 v[80:83], a[92:95], a[60:63], v[80:83]
v_accvgpr_read_b32 v3, a212
v_accvgpr_read_b32 v2, a213
v_accvgpr_write_b32 a212, 0
v_add_f32 v3, v3, v2
v_mfma_f32_16x16x32_bf16 v[84:87], a[108:111], a[60:63], v[64:67]
v_accvgpr_write_b32 a213, 0
v_cmp_ngt_f32 vcc, s31, v3
v_rcp_f32 v3, v3
v_mfma_f32_16x16x32_bf16 v[84:87], a[104:107], a[56:59], v[84:87]
v_mfma_f32_16x16x32_bf16 v[84:87], a[100:103], a[52:55], v[84:87]
s_add_u32 s29, s38, 19456
v_mfma_f32_16x16x32_bf16 v[84:87], a[96:99], a[48:51], v[84:87]
buffer_store_dwordx4 a[236:239], v21, s[16:19], s29 offen nt
v_pk_mul_f32 v[128:129], v[128:129], v[2:3] op_sel:[0,1] op_sel_hi:[1,1]
v_pk_mul_f32 v[130:131], v[130:131], v[2:3] op_sel:[0,1] op_sel_hi:[1,1]
v_pk_mul_f32 v[132:133], v[132:133], v[2:3] op_sel:[0,1] op_sel_hi:[1,1]
v_pk_mul_f32 v[134:135], v[134:135], v[2:3] op_sel:[0,1] op_sel_hi:[1,1]
v_pk_mul_f32 v[136:137], v[136:137], v[2:3] op_sel:[0,1] op_sel_hi:[1,1]
v_pk_mul_f32 v[138:139], v[138:139], v[2:3] op_sel:[0,1] op_sel_hi:[1,1]
v_pk_mul_f32 v[140:141], v[140:141], v[2:3] op_sel:[0,1] op_sel_hi:[1,1]
v_pk_mul_f32 v[142:143], v[142:143], v[2:3] op_sel:[0,1] op_sel_hi:[1,1]
v_pk_mul_f32 v[144:145], v[144:145], v[2:3] op_sel:[0,1] op_sel_hi:[1,1]
v_pk_mul_f32 v[146:147], v[146:147], v[2:3] op_sel:[0,1] op_sel_hi:[1,1]
v_pk_mul_f32 v[148:149], v[148:149], v[2:3] op_sel:[0,1] op_sel_hi:[1,1]
v_pk_mul_f32 v[150:151], v[150:151], v[2:3] op_sel:[0,1] op_sel_hi:[1,1]
v_pk_mul_f32 v[152:153], v[152:153], v[2:3] op_sel:[0,1] op_sel_hi:[1,1]
v_pk_mul_f32 v[154:155], v[154:155], v[2:3] op_sel:[0,1] op_sel_hi:[1,1]
v_pk_mul_f32 v[156:157], v[156:157], v[2:3] op_sel:[0,1] op_sel_hi:[1,1]
v_pk_mul_f32 v[158:159], v[158:159], v[2:3] op_sel:[0,1] op_sel_hi:[1,1]
v_mfma_f32_16x16x32_bf16 v[88:91], a[112:115], a[48:51], v[64:67]
v_mfma_f32_16x16x32_bf16 v[88:91], a[116:119], a[52:55], v[88:91]
v_mfma_f32_16x16x32_bf16 v[88:91], a[120:123], a[56:59], v[88:91]
s_waitcnt lgkmcnt(0)
v_cvt_pk_bf16_f32 v128, v128, v129
v_cvt_pk_bf16_f32 v129, v130, v131
v_mfma_f32_16x16x32_bf16 v[88:91], a[124:127], a[60:63], v[88:91]
s_add_u32 s88, s86, 0
ds_write_b64 v32, v[128:129] offset:4096
s_or_b64 s[34:35], s[34:35], vcc
v_cvt_pk_bf16_f32 v132, v132, v133
v_cvt_pk_bf16_f32 v133, v134, v135
v_mfma_f32_16x16x32_bf16 v[92:95], a[140:143], a[60:63], v[64:67]
buffer_store_dwordx4 a[0:3], v18, s[16:19], s88 offen nt
v_mfma_f32_16x16x32_bf16 v[92:95], a[136:139], a[56:59], v[92:95]
ds_write_b64 v33, v[132:133] offset:4096
v_cvt_pk_bf16_f32 v136, v136, v137
v_cvt_pk_bf16_f32 v137, v138, v139
s_add_u32 s88, s86, 1024
v_mfma_f32_16x16x32_bf16 v[92:95], a[132:135], a[52:55], v[92:95]
v_exp_f32 v80, v80
v_mfma_f32_16x16x32_bf16 v[92:95], a[128:131], a[48:51], v[92:95]
ds_write_b64 v34, v[136:137] offset:4096
v_exp_f32 v81, v81
v_cvt_pk_bf16_f32 v140, v140, v141
v_smfmac_f32_16x16x64_bf16 a[216:219], a[228:231], v[72:79], v0
v_cvt_pk_bf16_f32 v141, v142, v143
buffer_store_dwordx4 a[4:7], v19, s[16:19], s88 offen nt
v_mfma_f32_16x16x32_bf16 v[160:163], a[148:151], v[76:79], v[160:163]
ds_write_b64 v35, v[140:141] offset:4096
v_exp_f32 v82, v82
v_cvt_pk_bf16_f32 v144, v144, v145
v_mfma_f32_16x16x32_bf16 v[160:163], a[144:147], v[72:75], v[160:163]
v_exp_f32 v83, v83
s_add_u32 s88, s86, 2048
v_cvt_pk_bf16_f32 v145, v146, v147
v_mfma_f32_16x16x32_bf16 v[164:167], a[152:155], v[72:75], v[164:167]
v_exp_f32 v84, v84
v_mfma_f32_16x16x32_bf16 v[164:167], a[156:159], v[76:79], v[164:167]
ds_write_b64 v36, v[144:145] offset:4096
v_exp_f32 v85, v85
v_cvt_pk_bf16_f32 v148, v148, v149
v_mfma_f32_16x16x32_bf16 v[168:171], a[164:167], v[76:79], v[168:171]
v_exp_f32 v86, v86
buffer_store_dwordx4 a[8:11], v20, s[16:19], s88 offen nt
v_mfma_f32_16x16x32_bf16 v[168:171], a[160:163], v[72:75], v[168:171]
v_exp_f32 v87, v87
v_cvt_pk_bf16_f32 v149, v150, v151
v_mfma_f32_16x16x32_bf16 v[172:175], a[168:171], v[72:75], v[172:175]
v_exp_f32 v88, v88
v_mfma_f32_16x16x32_bf16 v[172:175], a[172:175], v[76:79], v[172:175]
ds_write_b64 v37, v[148:149] offset:4096
v_exp_f32 v89, v89
v_cvt_pk_bf16_f32 v152, v152, v153
s_add_u32 s88, s86, 3072
v_mfma_f32_16x16x32_bf16 v[176:179], a[180:183], v[76:79], v[176:179]
v_exp_f32 v90, v90
v_cvt_pk_bf16_f32 v153, v154, v155
v_mfma_f32_16x16x32_bf16 v[176:179], a[176:179], v[72:75], v[176:179]
v_exp_f32 v91, v91
v_cvt_pk_bf16_f32 v156, v156, v157
v_mfma_f32_16x16x32_bf16 v[180:183], a[184:187], v[72:75], v[180:183]
ds_write_b64 v38, v[152:153] offset:4096
v_exp_f32 v92, v92
buffer_store_dwordx4 a[12:15], v21, s[16:19], s88 offen nt
v_mfma_f32_16x16x32_bf16 v[180:183], a[188:191], v[76:79], v[180:183]
v_exp_f32 v93, v93
v_cvt_pk_bf16_f32 v157, v158, v159
v_mfma_f32_16x16x32_bf16 v[184:187], a[196:199], v[76:79], v[184:187]
v_exp_f32 v94, v94
v_mfma_f32_16x16x32_bf16 v[184:187], a[192:195], v[72:75], v[184:187]
ds_write_b64 v39, v[156:157] offset:4096
v_exp_f32 v95, v95
v_mfma_f32_16x16x32_bf16 v[188:191], a[200:203], v[72:75], v[188:191]
v_cvt_pk_bf16_f32 v72, v80, v81
v_cvt_pk_bf16_f32 v73, v82, v83
v_mfma_f32_16x16x32_bf16 v[188:191], a[204:207], v[76:79], v[188:191]
v_cvt_pk_bf16_f32 v74, v84, v85
v_cvt_pk_bf16_f32 v75, v86, v87
v_mfma_f32_16x16x32_bf16 v[80:83], a[80:83], a[64:67], v[68:71]
v_cvt_pk_bf16_f32 v76, v88, v89
v_cvt_pk_bf16_f32 v77, v90, v91
v_mfma_f32_16x16x32_bf16 v[80:83], a[84:87], a[68:71], v[80:83]
v_cvt_pk_bf16_f32 v78, v92, v93
v_cvt_pk_bf16_f32 v79, v94, v95
v_mfma_f32_16x16x32_bf16 v[80:83], a[88:91], a[72:75], v[80:83]
ds_read_b128 a[16:19], v22 offset:4096
ds_read_b128 a[20:23], v22 offset:5120
ds_read_b128 a[24:27], v22 offset:6144
ds_read_b128 a[28:31], v22 offset:7168
v_mfma_f32_16x16x32_bf16 v[80:83], a[92:95], a[76:79], v[80:83]
v_accvgpr_read_b32 v3, a216
v_accvgpr_read_b32 v2, a217
v_accvgpr_write_b32 a216, 0
v_add_f32 v3, v3, v2
v_mfma_f32_16x16x32_bf16 v[84:87], a[108:111], a[76:79], v[68:71]
v_accvgpr_write_b32 a217, 0
v_cmp_ngt_f32 vcc, s31, v3
v_rcp_f32 v3, v3
v_mfma_f32_16x16x32_bf16 v[84:87], a[104:107], a[72:75], v[84:87]
v_mfma_f32_16x16x32_bf16 v[84:87], a[100:103], a[68:71], v[84:87]
v_mfma_f32_16x16x32_bf16 v[84:87], a[96:99], a[64:67], v[84:87]
v_pk_mul_f32 v[160:161], v[160:161], v[2:3] op_sel:[0,1] op_sel_hi:[1,1]
v_pk_mul_f32 v[162:163], v[162:163], v[2:3] op_sel:[0,1] op_sel_hi:[1,1]
v_pk_mul_f32 v[164:165], v[164:165], v[2:3] op_sel:[0,1] op_sel_hi:[1,1]
v_pk_mul_f32 v[166:167], v[166:167], v[2:3] op_sel:[0,1] op_sel_hi:[1,1]
v_pk_mul_f32 v[168:169], v[168:169], v[2:3] op_sel:[0,1] op_sel_hi:[1,1]
v_pk_mul_f32 v[170:171], v[170:171], v[2:3] op_sel:[0,1] op_sel_hi:[1,1]
v_pk_mul_f32 v[172:173], v[172:173], v[2:3] op_sel:[0,1] op_sel_hi:[1,1]
v_pk_mul_f32 v[174:175], v[174:175], v[2:3] op_sel:[0,1] op_sel_hi:[1,1]
v_pk_mul_f32 v[176:177], v[176:177], v[2:3] op_sel:[0,1] op_sel_hi:[1,1]
v_pk_mul_f32 v[178:179], v[178:179], v[2:3] op_sel:[0,1] op_sel_hi:[1,1]
v_pk_mul_f32 v[180:181], v[180:181], v[2:3] op_sel:[0,1] op_sel_hi:[1,1]
v_pk_mul_f32 v[182:183], v[182:183], v[2:3] op_sel:[0,1] op_sel_hi:[1,1]
v_pk_mul_f32 v[184:185], v[184:185], v[2:3] op_sel:[0,1] op_sel_hi:[1,1]
v_pk_mul_f32 v[186:187], v[186:187], v[2:3] op_sel:[0,1] op_sel_hi:[1,1]
v_pk_mul_f32 v[188:189], v[188:189], v[2:3] op_sel:[0,1] op_sel_hi:[1,1]
v_pk_mul_f32 v[190:191], v[190:191], v[2:3] op_sel:[0,1] op_sel_hi:[1,1]
v_mfma_f32_16x16x32_bf16 v[88:91], a[112:115], a[64:67], v[68:71]
v_mfma_f32_16x16x32_bf16 v[88:91], a[116:119], a[68:71], v[88:91]
s_waitcnt lgkmcnt(0)
v_cvt_pk_bf16_f32 v160, v160, v161
v_mfma_f32_16x16x32_bf16 v[88:91], a[120:123], a[72:75], v[88:91]
v_exp_f32 v80, v80
v_cvt_pk_bf16_f32 v161, v162, v163
v_mfma_f32_16x16x32_bf16 v[88:91], a[124:127], a[76:79], v[88:91]
v_exp_f32 v81, v81
v_mfma_f32_16x16x32_bf16 v[92:95], a[140:143], a[76:79], v[68:71]
ds_write_b64 v32, v[160:161] offset:8192
v_exp_f32 v82, v82
s_add_u32 s88, s86, 4096
s_or_b64 s[34:35], s[34:35], vcc
v_mfma_f32_16x16x32_bf16 v[92:95], a[136:139], a[72:75], v[92:95]
v_cvt_pk_bf16_f32 v164, v164, v165
v_cvt_pk_bf16_f32 v165, v166, v167
buffer_store_dwordx4 a[16:19], v18, s[16:19], s88 offen nt
v_mfma_f32_16x16x32_bf16 v[92:95], a[132:135], a[68:71], v[92:95]
ds_write_b64 v33, v[164:165] offset:8192
v_cvt_pk_bf16_f32 v168, v168, v169
v_mfma_f32_16x16x32_bf16 v[92:95], a[128:131], a[64:67], v[92:95]
v_exp_f32 v83, v83
v_cvt_pk_bf16_f32 v169, v170, v171
s_add_u32 s88, s86, 5120
v_smfmac_f32_16x16x64_bf16 a[220:223], a[228:231], v[72:79], v0
ds_write_b64 v34, v[168:169] offset:8192
v_cvt_pk_bf16_f32 v172, v172, v173
v_cvt_pk_bf16_f32 v173, v174, v175
v_mfma_f32_16x16x32_bf16 v[192:195], a[148:151], v[76:79], v[192:195]
buffer_store_dwordx4 a[20:23], v19, s[16:19], s88 offen nt
v_mfma_f32_16x16x32_bf16 v[192:195], a[144:147], v[72:75], v[192:195]
ds_write_b64 v35, v[172:173] offset:8192
v_exp_f32 v84, v84
v_cvt_pk_bf16_f32 v176, v176, v177
v_mfma_f32_16x16x32_bf16 v[196:199], a[152:155], v[72:75], v[196:199]
v_exp_f32 v85, v85
s_add_u32 s88, s86, 6144
v_cvt_pk_bf16_f32 v177, v178, v179
v_mfma_f32_16x16x32_bf16 v[196:199], a[156:159], v[76:79], v[196:199]
v_exp_f32 v86, v86
v_mfma_f32_16x16x32_bf16 v[200:203], a[164:167], v[76:79], v[200:203]
ds_write_b64 v36, v[176:177] offset:8192
v_exp_f32 v87, v87
v_cvt_pk_bf16_f32 v180, v180, v181
v_mfma_f32_16x16x32_bf16 v[200:203], a[160:163], v[72:75], v[200:203]
v_exp_f32 v88, v88
buffer_store_dwordx4 a[24:27], v20, s[16:19], s88 offen nt
v_mfma_f32_16x16x32_bf16 v[204:207], a[168:171], v[72:75], v[204:207]
v_exp_f32 v89, v89
v_cvt_pk_bf16_f32 v181, v182, v183
v_mfma_f32_16x16x32_bf16 v[204:207], a[172:175], v[76:79], v[204:207]
ds_write_b64 v37, v[180:181] offset:8192
v_cvt_pk_bf16_f32 v184, v184, v185
s_add_u32 s88, s86, 7168
v_mfma_f32_16x16x32_bf16 v[208:211], a[180:183], v[76:79], v[208:211]
v_exp_f32 v90, v90
v_cvt_pk_bf16_f32 v185, v186, v187
v_mfma_f32_16x16x32_bf16 v[208:211], a[176:179], v[72:75], v[208:211]
v_exp_f32 v91, v91
v_mfma_f32_16x16x32_bf16 v[212:215], a[184:187], v[72:75], v[212:215]
ds_write_b64 v38, v[184:185] offset:8192
v_exp_f32 v92, v92
v_cvt_pk_bf16_f32 v188, v188, v189
v_mfma_f32_16x16x32_bf16 v[212:215], a[188:191], v[76:79], v[212:215]
v_exp_f32 v93, v93
buffer_store_dwordx4 a[28:31], v21, s[16:19], s88 offen nt
v_cvt_pk_bf16_f32 v189, v190, v191
v_mfma_f32_16x16x32_bf16 v[216:219], a[196:199], v[76:79], v[216:219]
v_exp_f32 v94, v94
v_mfma_f32_16x16x32_bf16 v[216:219], a[192:195], v[72:75], v[216:219]
s_waitcnt lgkmcnt(0)
ds_write_b64 v39, v[188:189] offset:8192
v_exp_f32 v95, v95
v_mfma_f32_16x16x32_bf16 v[220:223], a[200:203], v[72:75], v[220:223]
v_cvt_pk_bf16_f32 v72, v80, v81
v_cvt_pk_bf16_f32 v73, v82, v83
v_mfma_f32_16x16x32_bf16 v[220:223], a[204:207], v[76:79], v[220:223]
v_cvt_pk_bf16_f32 v74, v84, v85
v_cvt_pk_bf16_f32 v75, v86, v87
v_cvt_pk_bf16_f32 v76, v88, v89
v_cvt_pk_bf16_f32 v77, v90, v91
v_cvt_pk_bf16_f32 v78, v92, v93
v_cvt_pk_bf16_f32 v79, v94, v95
s_nop 1
v_smfmac_f32_16x16x64_bf16 a[224:227], a[228:231], v[72:79], v0
ds_read_b128 a[32:35], v22 offset:8192
ds_read_b128 a[36:39], v22 offset:9216
ds_read_b128 a[40:43], v22 offset:10240
ds_read_b128 a[44:47], v22 offset:11264
v_accvgpr_read_b32 v3, a220
v_mfma_f32_16x16x32_bf16 v[224:227], a[148:151], v[76:79], v[224:227]
v_accvgpr_read_b32 v2, a221
v_accvgpr_write_b32 a220, 0
v_add_f32 v3, v3, v2
v_accvgpr_write_b32 a221, 0
v_cmp_ngt_f32 vcc, s31, v3
v_mfma_f32_16x16x32_bf16 v[224:227], a[144:147], v[72:75], v[224:227]
v_rcp_f32 v3, v3
v_mfma_f32_16x16x32_bf16 v[228:231], a[152:155], v[72:75], v[228:231]
v_mfma_f32_16x16x32_bf16 v[228:231], a[156:159], v[76:79], v[228:231]
v_pk_mul_f32 v[192:193], v[192:193], v[2:3] op_sel:[0,1] op_sel_hi:[1,1]
v_pk_mul_f32 v[194:195], v[194:195], v[2:3] op_sel:[0,1] op_sel_hi:[1,1]
v_pk_mul_f32 v[196:197], v[196:197], v[2:3] op_sel:[0,1] op_sel_hi:[1,1]
v_pk_mul_f32 v[198:199], v[198:199], v[2:3] op_sel:[0,1] op_sel_hi:[1,1]
v_pk_mul_f32 v[200:201], v[200:201], v[2:3] op_sel:[0,1] op_sel_hi:[1,1]
v_pk_mul_f32 v[202:203], v[202:203], v[2:3] op_sel:[0,1] op_sel_hi:[1,1]
v_pk_mul_f32 v[204:205], v[204:205], v[2:3] op_sel:[0,1] op_sel_hi:[1,1]
v_pk_mul_f32 v[206:207], v[206:207], v[2:3] op_sel:[0,1] op_sel_hi:[1,1]
v_pk_mul_f32 v[208:209], v[208:209], v[2:3] op_sel:[0,1] op_sel_hi:[1,1]
v_pk_mul_f32 v[210:211], v[210:211], v[2:3] op_sel:[0,1] op_sel_hi:[1,1]
v_pk_mul_f32 v[212:213], v[212:213], v[2:3] op_sel:[0,1] op_sel_hi:[1,1]
v_pk_mul_f32 v[214:215], v[214:215], v[2:3] op_sel:[0,1] op_sel_hi:[1,1]
v_pk_mul_f32 v[216:217], v[216:217], v[2:3] op_sel:[0,1] op_sel_hi:[1,1]
v_pk_mul_f32 v[218:219], v[218:219], v[2:3] op_sel:[0,1] op_sel_hi:[1,1]
v_pk_mul_f32 v[220:221], v[220:221], v[2:3] op_sel:[0,1] op_sel_hi:[1,1]
v_pk_mul_f32 v[222:223], v[222:223], v[2:3] op_sel:[0,1] op_sel_hi:[1,1]
v_mfma_f32_16x16x32_bf16 v[232:235], a[164:167], v[76:79], v[232:235]
v_mfma_f32_16x16x32_bf16 v[232:235], a[160:163], v[72:75], v[232:235]
s_waitcnt lgkmcnt(0)
v_cvt_pk_bf16_f32 v192, v192, v193
v_cvt_pk_bf16_f32 v193, v194, v195
v_mfma_f32_16x16x32_bf16 v[236:239], a[168:171], v[72:75], v[236:239]
s_add_u32 s88, s86, 8192
ds_write_b64 v32, v[192:193] offset:12288
s_or_b64 s[34:35], s[34:35], vcc
v_cvt_pk_bf16_f32 v196, v196, v197
v_cvt_pk_bf16_f32 v197, v198, v199
buffer_store_dwordx4 a[32:35], v18, s[16:19], s88 offen nt
v_mfma_f32_16x16x32_bf16 v[236:239], a[172:175], v[76:79], v[236:239]
ds_write_b64 v33, v[196:197] offset:12288
v_cvt_pk_bf16_f32 v200, v200, v201
v_mfma_f32_16x16x32_bf16 v[240:243], a[180:183], v[76:79], v[240:243]
v_cvt_pk_bf16_f32 v201, v202, v203
s_add_u32 s88, s86, 9216
v_mfma_f32_16x16x32_bf16 v[240:243], a[176:179], v[72:75], v[240:243]
ds_write_b64 v34, v[200:201] offset:12288
v_cvt_pk_bf16_f32 v204, v204, v205
v_cvt_pk_bf16_f32 v205, v206, v207
buffer_store_dwordx4 a[36:39], v19, s[16:19], s88 offen nt
v_mfma_f32_16x16x32_bf16 v[244:247], a[184:187], v[72:75], v[244:247]
ds_write_b64 v35, v[204:205] offset:12288
v_cvt_pk_bf16_f32 v208, v208, v209
s_add_u32 s88, s86, 10240
v_cvt_pk_bf16_f32 v209, v210, v211
v_mfma_f32_16x16x32_bf16 v[244:247], a[188:191], v[76:79], v[244:247]
ds_write_b64 v36, v[208:209] offset:12288
v_cvt_pk_bf16_f32 v212, v212, v213
buffer_store_dwordx4 a[40:43], v20, s[16:19], s88 offen nt
v_mfma_f32_16x16x32_bf16 v[248:251], a[196:199], v[76:79], v[248:251]
v_cvt_pk_bf16_f32 v213, v214, v215
v_mfma_f32_16x16x32_bf16 v[248:251], a[192:195], v[72:75], v[248:251]
ds_write_b64 v37, v[212:213] offset:12288
v_cvt_pk_bf16_f32 v216, v216, v217
s_add_u32 s88, s86, 11264
v_cvt_pk_bf16_f32 v217, v218, v219
v_mfma_f32_16x16x32_bf16 v[252:255], a[200:203], v[72:75], v[252:255]
ds_write_b64 v38, v[216:217] offset:12288
v_cvt_pk_bf16_f32 v220, v220, v221
buffer_store_dwordx4 a[44:47], v21, s[16:19], s88 offen nt
v_cvt_pk_bf16_f32 v221, v222, v223
v_mfma_f32_16x16x32_bf16 v[252:255], a[204:207], v[76:79], v[252:255]
ds_write_b64 v39, v[220:221] offset:12288
ds_read_b128 a[48:51], v22 offset:12288
ds_read_b128 a[52:55], v22 offset:13312
ds_read_b128 a[56:59], v22 offset:14336
ds_read_b128 a[60:63], v22 offset:15360
v_accvgpr_read_b32 v3, a224
v_accvgpr_read_b32 v2, a225
v_accvgpr_write_b32 a224, 0
v_add_f32 v3, v3, v2
v_accvgpr_write_b32 a225, 0
v_cmp_ngt_f32 vcc, s31, v3
v_rcp_f32 v3, v3
s_nop 0
v_pk_mul_f32 v[224:225], v[224:225], v[2:3] op_sel:[0,1] op_sel_hi:[1,1]
v_pk_mul_f32 v[226:227], v[226:227], v[2:3] op_sel:[0,1] op_sel_hi:[1,1]
v_pk_mul_f32 v[228:229], v[228:229], v[2:3] op_sel:[0,1] op_sel_hi:[1,1]
v_pk_mul_f32 v[230:231], v[230:231], v[2:3] op_sel:[0,1] op_sel_hi:[1,1]
v_pk_mul_f32 v[232:233], v[232:233], v[2:3] op_sel:[0,1] op_sel_hi:[1,1]
v_pk_mul_f32 v[234:235], v[234:235], v[2:3] op_sel:[0,1] op_sel_hi:[1,1]
v_pk_mul_f32 v[236:237], v[236:237], v[2:3] op_sel:[0,1] op_sel_hi:[1,1]
v_pk_mul_f32 v[238:239], v[238:239], v[2:3] op_sel:[0,1] op_sel_hi:[1,1]
v_pk_mul_f32 v[240:241], v[240:241], v[2:3] op_sel:[0,1] op_sel_hi:[1,1]
v_pk_mul_f32 v[242:243], v[242:243], v[2:3] op_sel:[0,1] op_sel_hi:[1,1]
v_pk_mul_f32 v[244:245], v[244:245], v[2:3] op_sel:[0,1] op_sel_hi:[1,1]
v_pk_mul_f32 v[246:247], v[246:247], v[2:3] op_sel:[0,1] op_sel_hi:[1,1]
v_pk_mul_f32 v[248:249], v[248:249], v[2:3] op_sel:[0,1] op_sel_hi:[1,1]
v_pk_mul_f32 v[250:251], v[250:251], v[2:3] op_sel:[0,1] op_sel_hi:[1,1]
v_pk_mul_f32 v[252:253], v[252:253], v[2:3] op_sel:[0,1] op_sel_hi:[1,1]
v_pk_mul_f32 v[254:255], v[254:255], v[2:3] op_sel:[0,1] op_sel_hi:[1,1]
s_waitcnt lgkmcnt(0)
v_cvt_pk_bf16_f32 v224, v224, v225
v_cvt_pk_bf16_f32 v225, v226, v227
ds_write_b64 v32, v[224:225] offset:16384
s_add_u32 s88, s86, 12288
s_or_b64 s[34:35], s[34:35], vcc
v_cvt_pk_bf16_f32 v228, v228, v229
v_cvt_pk_bf16_f32 v229, v230, v231
buffer_store_dwordx4 a[48:51], v18, s[16:19], s88 offen nt
ds_write_b64 v33, v[228:229] offset:16384
v_cvt_pk_bf16_f32 v232, v232, v233
v_cvt_pk_bf16_f32 v233, v234, v235
s_add_u32 s88, s86, 13312
ds_write_b64 v34, v[232:233] offset:16384
v_cvt_pk_bf16_f32 v236, v236, v237
v_cvt_pk_bf16_f32 v237, v238, v239
buffer_store_dwordx4 a[52:55], v19, s[16:19], s88 offen nt
ds_write_b64 v35, v[236:237] offset:16384
v_cvt_pk_bf16_f32 v240, v240, v241
s_add_u32 s88, s86, 14336
v_cvt_pk_bf16_f32 v241, v242, v243
ds_write_b64 v36, v[240:241] offset:16384
v_cvt_pk_bf16_f32 v244, v244, v245
buffer_store_dwordx4 a[56:59], v20, s[16:19], s88 offen nt
v_cvt_pk_bf16_f32 v245, v246, v247
ds_write_b64 v37, v[244:245] offset:16384
v_cvt_pk_bf16_f32 v248, v248, v249
s_add_u32 s88, s86, 15360
v_cvt_pk_bf16_f32 v249, v250, v251
ds_write_b64 v38, v[248:249] offset:16384
v_cvt_pk_bf16_f32 v252, v252, v253
buffer_store_dwordx4 a[60:63], v21, s[16:19], s88 offen nt
v_cvt_pk_bf16_f32 v253, v254, v255
ds_write_b64 v39, v[252:253] offset:16384
ds_read_b128 a[64:67], v22 offset:16384
ds_read_b128 a[68:71], v22 offset:17408
ds_read_b128 a[72:75], v22 offset:18432
ds_read_b128 a[76:79], v22 offset:19456
s_cmp_lg_u64 s[34:35], 0
s_addc_u32 s28, s28, s28
s_mov_b64 s[34:35], 0
s_waitcnt lgkmcnt(0)
s_add_u32 s88, s87, 16384
buffer_store_dwordx4 a[64:67], v18, s[16:19], s88 offen nt
s_add_u32 s88, s87, 17408
buffer_store_dwordx4 a[68:71], v19, s[16:19], s88 offen nt
s_add_u32 s88, s87, 18432
buffer_store_dwordx4 a[72:75], v20, s[16:19], s88 offen nt
s_add_u32 s88, s87, 19456
buffer_store_dwordx4 a[76:79], v21, s[16:19], s88 offen nt
CODE_END:
s_waitcnt vmcnt(0)
s_cmp_eq_u32 s28, 0
s_cbranch_scc1 END
v_mbcnt_lo_u32_b32 v0, -1, 0
v_mbcnt_hi_u32_b32 v0, -1, v0
v_lshrrev_b32 v1, 4, v0
v_and_b32 v2, 15, v0
v_lshlrev_b32 v16, 4, v1
v_lshl_add_u32 v16, v2, 8, v16
v_lshlrev_b32 v17, 1, v2
v_lshl_add_u32 v17, v1, 10, v17
FB_ITEM:
s_bitcmp1_b32 s28, 3
s_cbranch_scc0 FB_NEXT
s_mov_b32 s54, 0
FB_TILE:
s_lshl_b32 s36, s54, 12
s_add_u32 s36, s36, s39
s_cmp_eq_u32 s54, 4
s_cselect_b32 s29, s24, 0
s_add_u32 s36, s36, s29
s_waitcnt vmcnt(0)
buffer_load_dwordx4 v[32:35], v16, s[4:7], s36 offen offset:0
buffer_load_dwordx4 v[36:39], v16, s[4:7], s36 offen offset:64
buffer_load_dwordx4 v[40:43], v16, s[4:7], s36 offen offset:128
buffer_load_dwordx4 v[44:47], v16, s[4:7], s36 offen offset:192
s_waitcnt vmcnt(0)
v_lshlrev_b32 v28, 16, v32
v_and_b32 v29, s30, v32
v_lshlrev_b32 v30, 16, v33
v_and_b32 v31, s30, v33
v_mul_f32 v28, s26, v28
v_mul_f32 v29, s26, v29
v_mul_f32 v30, s26, v30
v_mul_f32 v31, s26, v31
v_cvt_pk_bf16_f32 v32, v28, v29
v_cvt_pk_bf16_f32 v33, v30, v31
v_lshlrev_b32 v28, 16, v34
v_and_b32 v29, s30, v34
v_lshlrev_b32 v30, 16, v35
v_and_b32 v31, s30, v35
v_mul_f32 v28, s26, v28
v_mul_f32 v29, s26, v29
v_mul_f32 v30, s26, v30
v_mul_f32 v31, s26, v31
v_cvt_pk_bf16_f32 v34, v28, v29
v_cvt_pk_bf16_f32 v35, v30, v31
v_lshlrev_b32 v28, 16, v36
v_and_b32 v29, s30, v36
v_lshlrev_b32 v30, 16, v37
v_and_b32 v31, s30, v37
v_mul_f32 v28, s26, v28
v_mul_f32 v29, s26, v29
v_mul_f32 v30, s26, v30
v_mul_f32 v31, s26, v31
v_cvt_pk_bf16_f32 v36, v28, v29
v_cvt_pk_bf16_f32 v37, v30, v31
v_lshlrev_b32 v28, 16, v38
v_and_b32 v29, s30, v38
v_lshlrev_b32 v30, 16, v39
v_and_b32 v31, s30, v39
v_mul_f32 v28, s26, v28
v_mul_f32 v29, s26, v29
v_mul_f32 v30, s26, v30
v_mul_f32 v31, s26, v31
v_cvt_pk_bf16_f32 v38, v28, v29
v_cvt_pk_bf16_f32 v39, v30, v31
v_lshlrev_b32 v28, 16, v40
v_and_b32 v29, s30, v40
v_lshlrev_b32 v30, 16, v41
v_and_b32 v31, s30, v41
v_mul_f32 v28, s26, v28
v_mul_f32 v29, s26, v29
v_mul_f32 v30, s26, v30
v_mul_f32 v31, s26, v31
v_cvt_pk_bf16_f32 v40, v28, v29
v_cvt_pk_bf16_f32 v41, v30, v31
v_lshlrev_b32 v28, 16, v42
v_and_b32 v29, s30, v42
v_lshlrev_b32 v30, 16, v43
v_and_b32 v31, s30, v43
v_mul_f32 v28, s26, v28
v_mul_f32 v29, s26, v29
v_mul_f32 v30, s26, v30
v_mul_f32 v31, s26, v31
v_cvt_pk_bf16_f32 v42, v28, v29
v_cvt_pk_bf16_f32 v43, v30, v31
v_lshlrev_b32 v28, 16, v44
v_and_b32 v29, s30, v44
v_lshlrev_b32 v30, 16, v45
v_and_b32 v31, s30, v45
v_mul_f32 v28, s26, v28
v_mul_f32 v29, s26, v29
v_mul_f32 v30, s26, v30
v_mul_f32 v31, s26, v31
v_cvt_pk_bf16_f32 v44, v28, v29
v_cvt_pk_bf16_f32 v45, v30, v31
v_lshlrev_b32 v28, 16, v46
v_and_b32 v29, s30, v46
v_lshlrev_b32 v30, 16, v47
v_and_b32 v31, s30, v47
v_mul_f32 v28, s26, v28
v_mul_f32 v29, s26, v29
v_mul_f32 v30, s26, v30
v_mul_f32 v31, s26, v31
v_cvt_pk_bf16_f32 v46, v28, v29
v_cvt_pk_bf16_f32 v47, v30, v31
v_mov_b32 v1, 0xff800000
s_mov_b32 s29, s53
s_mov_b32 s55, 39
FB_P1:
buffer_load_dwordx4 v[160:163], v16, s[8:11], s29 offen offset:0
buffer_load_dwordx4 v[164:167], v16, s[8:11], s29 offen offset:64
buffer_load_dwordx4 v[168:171], v16, s[8:11], s29 offen offset:128
buffer_load_dwordx4 v[172:175], v16, s[8:11], s29 offen offset:192
s_waitcnt vmcnt(0)
v_mfma_f32_16x16x32_bf16 v[80:83], v[160:163], v[32:35], 0
v_mfma_f32_16x16x32_bf16 v[80:83], v[164:167], v[36:39], v[80:83]
v_mfma_f32_16x16x32_bf16 v[80:83], v[168:171], v[40:43], v[80:83]
v_mfma_f32_16x16x32_bf16 v[80:83], v[172:175], v[44:47], v[80:83]
s_nop 7
v_max3_f32 v1, v1, v80, v81
v_max3_f32 v1, v1, v82, v83
s_add_u32 s29, s29, 4096
s_sub_u32 s55, s55, 1
s_cmp_lg_u32 s55, 0
s_cbranch_scc1 FB_P1
s_nop 7
v_mov_b32 v2, v1
s_nop 1
v_permlane16_swap_b32 v1, v2
v_max_f32 v1, v1, v2
v_mov_b32 v2, v1
s_nop 1
v_permlane32_swap_b32 v1, v2
v_max_f32 v1, v1, v2
v_sub_f32 v52, 0, v1
v_sub_f32 v53, 0, v1
v_sub_f32 v54, 0, v1
v_sub_f32 v55, 0, v1
v_mov_b32 v96, 0
v_mov_b32 v97, 0
v_mov_b32 v98, 0
v_mov_b32 v99, 0
v_mov_b32 v100, 0
v_mov_b32 v101, 0
v_mov_b32 v102, 0
v_mov_b32 v103, 0
v_mov_b32 v104, 0
v_mov_b32 v105, 0
v_mov_b32 v106, 0
v_mov_b32 v107, 0
v_mov_b32 v108, 0
v_mov_b32 v109, 0
v_mov_b32 v110, 0
v_mov_b32 v111, 0
v_mov_b32 v112, 0
v_mov_b32 v113, 0
v_mov_b32 v114, 0
v_mov_b32 v115, 0
v_mov_b32 v116, 0
v_mov_b32 v117, 0
v_mov_b32 v118, 0
v_mov_b32 v119, 0
v_mov_b32 v120, 0
v_mov_b32 v121, 0
v_mov_b32 v122, 0
v_mov_b32 v123, 0
v_mov_b32 v124, 0
v_mov_b32 v125, 0
v_mov_b32 v126, 0
v_mov_b32 v127, 0
v_accvgpr_write_b32 a208, 0
v_accvgpr_write_b32 a209, 0
v_accvgpr_write_b32 a210, 0
v_accvgpr_write_b32 a211, 0
s_mov_b32 s29, s53
s_mov_b32 s55, 39
FB_P2:
buffer_load_dwordx4 v[160:163], v16, s[8:11], s29 offen offset:0
buffer_load_dwordx4 v[164:167], v16, s[8:11], s29 offen offset:64
buffer_load_dwordx4 v[168:171], v16, s[8:11], s29 offen offset:128
buffer_load_dwordx4 v[172:175], v16, s[8:11], s29 offen offset:192
buffer_load_ushort v176, v17, s[12:15], s29 offen offset:0
buffer_load_ushort v177, v17, s[12:15], s29 offen offset:512
buffer_load_ushort v178, v17, s[12:15], s29 offen offset:32
buffer_load_ushort v179, v17, s[12:15], s29 offen offset:544
buffer_load_ushort v180, v17, s[12:15], s29 offen offset:64
buffer_load_ushort v181, v17, s[12:15], s29 offen offset:576
buffer_load_ushort v182, v17, s[12:15], s29 offen offset:96
buffer_load_ushort v183, v17, s[12:15], s29 offen offset:608
buffer_load_ushort v184, v17, s[12:15], s29 offen offset:128
buffer_load_ushort v185, v17, s[12:15], s29 offen offset:640
buffer_load_ushort v186, v17, s[12:15], s29 offen offset:160
buffer_load_ushort v187, v17, s[12:15], s29 offen offset:672
buffer_load_ushort v188, v17, s[12:15], s29 offen offset:192
buffer_load_ushort v189, v17, s[12:15], s29 offen offset:704
buffer_load_ushort v190, v17, s[12:15], s29 offen offset:224
buffer_load_ushort v191, v17, s[12:15], s29 offen offset:736
buffer_load_ushort v192, v17, s[12:15], s29 offen offset:256
buffer_load_ushort v193, v17, s[12:15], s29 offen offset:768
buffer_load_ushort v194, v17, s[12:15], s29 offen offset:288
buffer_load_ushort v195, v17, s[12:15], s29 offen offset:800
buffer_load_ushort v196, v17, s[12:15], s29 offen offset:320
buffer_load_ushort v197, v17, s[12:15], s29 offen offset:832
buffer_load_ushort v198, v17, s[12:15], s29 offen offset:352
buffer_load_ushort v199, v17, s[12:15], s29 offen offset:864
buffer_load_ushort v200, v17, s[12:15], s29 offen offset:384
buffer_load_ushort v201, v17, s[12:15], s29 offen offset:896
buffer_load_ushort v202, v17, s[12:15], s29 offen offset:416
buffer_load_ushort v203, v17, s[12:15], s29 offen offset:928
buffer_load_ushort v204, v17, s[12:15], s29 offen offset:448
buffer_load_ushort v205, v17, s[12:15], s29 offen offset:960
buffer_load_ushort v206, v17, s[12:15], s29 offen offset:480
buffer_load_ushort v207, v17, s[12:15], s29 offen offset:992
s_waitcnt vmcnt(0)
v_lshl_or_b32 v176, v192, 16, v176
v_lshl_or_b32 v177, v193, 16, v177
v_lshl_or_b32 v178, v194, 16, v178
v_lshl_or_b32 v179, v195, 16, v179
v_lshl_or_b32 v180, v196, 16, v180
v_lshl_or_b32 v181, v197, 16, v181
v_lshl_or_b32 v182, v198, 16, v182
v_lshl_or_b32 v183, v199, 16, v183
v_lshl_or_b32 v184, v200, 16, v184
v_lshl_or_b32 v185, v201, 16, v185
v_lshl_or_b32 v186, v202, 16, v186
v_lshl_or_b32 v187, v203, 16, v187
v_lshl_or_b32 v188, v204, 16, v188
v_lshl_or_b32 v189, v205, 16, v189
v_lshl_or_b32 v190, v206, 16, v190
v_lshl_or_b32 v191, v207, 16, v191
v_mfma_f32_16x16x32_bf16 v[80:83], v[160:163], v[32:35], v[52:55]
v_mfma_f32_16x16x32_bf16 v[80:83], v[164:167], v[36:39], v[80:83]
v_mfma_f32_16x16x32_bf16 v[80:83], v[168:171], v[40:43], v[80:83]
v_mfma_f32_16x16x32_bf16 v[80:83], v[172:175], v[44:47], v[80:83]
s_nop 7
v_exp_f32 v80, v80
v_exp_f32 v81, v81
v_exp_f32 v82, v82
v_exp_f32 v83, v83
v_cvt_pk_bf16_f32 v72, v80, v81
v_cvt_pk_bf16_f32 v73, v82, v83
s_nop 1
v_mfma_f32_16x16x16_bf16 v[96:99], v[176:177], v[72:73], v[96:99]
v_mfma_f32_16x16x16_bf16 v[100:103], v[178:179], v[72:73], v[100:103]
v_mfma_f32_16x16x16_bf16 v[104:107], v[180:181], v[72:73], v[104:107]
v_mfma_f32_16x16x16_bf16 v[108:111], v[182:183], v[72:73], v[108:111]
v_mfma_f32_16x16x16_bf16 v[112:115], v[184:185], v[72:73], v[112:115]
v_mfma_f32_16x16x16_bf16 v[116:119], v[186:187], v[72:73], v[116:119]
v_mfma_f32_16x16x16_bf16 v[120:123], v[188:189], v[72:73], v[120:123]
v_mfma_f32_16x16x16_bf16 v[124:127], v[190:191], v[72:73], v[124:127]
v_mfma_f32_16x16x16_bf16 a[208:211], a[228:229], v[72:73], a[208:211]
s_add_u32 s29, s29, 4096
s_sub_u32 s55, s55, 1
s_cmp_lg_u32 s55, 0
s_cbranch_scc1 FB_P2
s_nop 7
v_xor_b32 v32, 0, v27
v_xor_b32 v33, 32, v27
v_xor_b32 v34, 64, v27
v_xor_b32 v35, 96, v27
v_xor_b32 v36, 128, v27
v_xor_b32 v37, 160, v27
v_xor_b32 v38, 192, v27
v_xor_b32 v39, 224, v27
v_accvgpr_read_b32 v3, a208
v_rcp_f32 v3, v3
s_nop 0
v_pk_mul_f32 v[96:97], v[96:97], v[2:3] op_sel:[0,1] op_sel_hi:[1,1]
v_pk_mul_f32 v[98:99], v[98:99], v[2:3] op_sel:[0,1] op_sel_hi:[1,1]
v_pk_mul_f32 v[100:101], v[100:101], v[2:3] op_sel:[0,1] op_sel_hi:[1,1]
v_pk_mul_f32 v[102:103], v[102:103], v[2:3] op_sel:[0,1] op_sel_hi:[1,1]
v_pk_mul_f32 v[104:105], v[104:105], v[2:3] op_sel:[0,1] op_sel_hi:[1,1]
v_pk_mul_f32 v[106:107], v[106:107], v[2:3] op_sel:[0,1] op_sel_hi:[1,1]
v_pk_mul_f32 v[108:109], v[108:109], v[2:3] op_sel:[0,1] op_sel_hi:[1,1]
v_pk_mul_f32 v[110:111], v[110:111], v[2:3] op_sel:[0,1] op_sel_hi:[1,1]
v_pk_mul_f32 v[112:113], v[112:113], v[2:3] op_sel:[0,1] op_sel_hi:[1,1]
v_pk_mul_f32 v[114:115], v[114:115], v[2:3] op_sel:[0,1] op_sel_hi:[1,1]
v_pk_mul_f32 v[116:117], v[116:117], v[2:3] op_sel:[0,1] op_sel_hi:[1,1]
v_pk_mul_f32 v[118:119], v[118:119], v[2:3] op_sel:[0,1] op_sel_hi:[1,1]
v_pk_mul_f32 v[120:121], v[120:121], v[2:3] op_sel:[0,1] op_sel_hi:[1,1]
v_pk_mul_f32 v[122:123], v[122:123], v[2:3] op_sel:[0,1] op_sel_hi:[1,1]
v_pk_mul_f32 v[124:125], v[124:125], v[2:3] op_sel:[0,1] op_sel_hi:[1,1]
v_pk_mul_f32 v[126:127], v[126:127], v[2:3] op_sel:[0,1] op_sel_hi:[1,1]
v_cvt_pk_bf16_f32 v96, v96, v97
v_cvt_pk_bf16_f32 v97, v98, v99
ds_write_b64 v32, v[96:97] offset:0
v_cvt_pk_bf16_f32 v100, v100, v101
v_cvt_pk_bf16_f32 v101, v102, v103
ds_write_b64 v33, v[100:101] offset:0
v_cvt_pk_bf16_f32 v104, v104, v105
v_cvt_pk_bf16_f32 v105, v106, v107
ds_write_b64 v34, v[104:105] offset:0
v_cvt_pk_bf16_f32 v108, v108, v109
v_cvt_pk_bf16_f32 v109, v110, v111
ds_write_b64 v35, v[108:109] offset:0
v_cvt_pk_bf16_f32 v112, v112, v113
v_cvt_pk_bf16_f32 v113, v114, v115
ds_write_b64 v36, v[112:113] offset:0
v_cvt_pk_bf16_f32 v116, v116, v117
v_cvt_pk_bf16_f32 v117, v118, v119
ds_write_b64 v37, v[116:117] offset:0
v_cvt_pk_bf16_f32 v120, v120, v121
v_cvt_pk_bf16_f32 v121, v122, v123
ds_write_b64 v38, v[120:121] offset:0
v_cvt_pk_bf16_f32 v124, v124, v125
v_cvt_pk_bf16_f32 v125, v126, v127
ds_write_b64 v39, v[124:125] offset:0
ds_read_b128 a[0:3], v22 offset:0
ds_read_b128 a[4:7], v22 offset:1024
ds_read_b128 a[8:11], v22 offset:2048
ds_read_b128 a[12:15], v22 offset:3072
s_waitcnt vmcnt(0) lgkmcnt(0)
s_add_u32 s29, s36, 0
buffer_store_dwordx4 a[0:3], v18, s[16:19], s29 offen nt
s_add_u32 s29, s36, 1024
buffer_store_dwordx4 a[4:7], v19, s[16:19], s29 offen nt
s_add_u32 s29, s36, 2048
buffer_store_dwordx4 a[8:11], v20, s[16:19], s29 offen nt
s_add_u32 s29, s36, 3072
buffer_store_dwordx4 a[12:15], v21, s[16:19], s29 offen nt
s_add_u32 s54, s54, 1
s_cmp_lt_u32 s54, 5
s_cbranch_scc1 FB_TILE
FB_NEXT:
s_lshl_b32 s28, s28, 1
s_add_u32 s39, s39, 20447232
s_add_u32 s53, s53, 20447232
s_and_b32 s28, s28, 15
s_cbranch_scc1 FB_ITEM
END:
s_endpgm
.section .rodata,"a"
.p2align 6
.amdhsa_kernel standalone__gqa_softmax__near_ridge_kernel
  .amdhsa_next_free_vgpr 512
  .amdhsa_next_free_sgpr 102
  .amdhsa_accum_offset 256
  .amdhsa_group_segment_fixed_size 0
  .amdhsa_kernarg_size 48
  .amdhsa_user_sgpr_count 2
  .amdhsa_user_sgpr_kernarg_segment_ptr 1
  .amdhsa_system_sgpr_workgroup_id_x 1
.end_amdhsa_kernel
```
